```python
import torch

def _softmax(x, axis=-1):
    return torch.softmax(x, dim=axis)

def _gelu(x):
    return torch.nn.functional.gelu(x, approximate='tanh')

def _silu(x):
    return torch.nn.functional.silu(x)

def _sigmoid(x):
    return torch.sigmoid(x)

def _layernorm(x, axis=-1, eps=1e-05):
    m = x.mean(dim=axis, keepdim=True)
    v = x.var(dim=axis, keepdim=True, unbiased=False)
    return (x - m) / torch.sqrt(v + eps)

def _scatter_add(tgt, idx, src, axis=0):
    return tgt.clone().index_add_(axis, idx, src)

def _segment_sum(src, seg, n):
    out = torch.zeros((n,) + src.shape[1:], dtype=src.dtype)
    return out.index_add_(0, seg, src)

def _pad(x, pw):
    flat = tuple((v for pair in reversed(pw) for v in pair))
    return torch.nn.functional.pad(x, flat)
kernel_name = 'parallel_sum__memory_aug_recurrent_mem_tr__dense_activation_relu__prompt'

def setup_inputs():

    _w = lambda a: (lambda t: t.to(torch.bfloat16) if t.is_floating_point() else t)(torch.as_tensor(a))

    def _A_setup():
        B, S, Dm = (1, 2048, 512)
        H, Dh = (32, 128)
        M, seg = (8, 32)
        seg = min(seg, S)
        S = S // seg * seg
        return {'x': _w((lambda *s: torch.randn(*s, dtype=torch.bfloat16) * 0.05)(B, S, Dm)), 'mem0': _w((lambda *s: torch.randn(*s, dtype=torch.bfloat16) * 1.6)(B, M, Dm)), 'Wq': _w((lambda *s: torch.randn(*s, dtype=torch.bfloat16) * 0.8)(Dm, H, Dh) * Dm ** (-0.5)), 'Wk': _w((lambda *s: torch.randn(*s, dtype=torch.bfloat16) * 0.8)(Dm, H, Dh) * Dm ** (-0.5)), 'Wv': _w((lambda *s: torch.randn(*s, dtype=torch.bfloat16) * 1.6)(Dm, H, Dh) * Dm ** (-0.5)), 'Wo': _w((lambda *s: torch.randn(*s, dtype=torch.bfloat16) * 1.6)(H, Dh, Dm) * (H * Dh) ** (-0.5)), 'seg_len': seg}
    _A_in = _A_setup()

    def _B_setup():
        B, S, D, Dff = (1, 2048, 512, 1376)
        return {'x': _w((lambda *s: torch.randn(*s, dtype=torch.bfloat16) * 0.05)(B, S, D)), 'w1': _w((lambda *s: torch.randn(*s, dtype=torch.bfloat16) * 0.05)(D, Dff)), 'w2': _w((lambda *s: torch.randn(*s, dtype=torch.bfloat16) * 0.05)(Dff, D))}
    _B_in = _B_setup()
    return {'A_x': _A_in['x'], 'A_mem0': _A_in['mem0'], 'A_Wq': _A_in['Wq'], 'A_Wk': _A_in['Wk'], 'A_Wv': _A_in['Wv'], 'A_Wo': _A_in['Wo'], 'A_seg_len': _A_in['seg_len'], 'B_x': _B_in['x'], 'B_w1': _B_in['w1'], 'B_w2': _B_in['w2']}

def reference(A_x, A_mem0, A_Wq, A_Wk, A_Wv, A_Wo, A_seg_len, B_x, B_w1, B_w2):

    def _A_ref(x, mem0, Wq, Wk, Wv, Wo, seg_len):
        B, S, Dm = x.shape
        H, Dh = (Wq.shape[1], Wq.shape[2])
        M = mem0.shape[1]
        scale = Dh ** (-0.5)
        n_seg = S // seg_len
        L = M + seg_len
        idx = torch.arange(L)
        mask = (idx[:, None] < M) | (idx[:, None] >= idx[None, :])
        mem = mem0
        outs = []
        for s in range(n_seg):
            xs = x[:, s * seg_len:(s + 1) * seg_len, :].clone()
            h = torch.concatenate([mem, xs], axis=1)
            q = torch.einsum('btd,dhe->bhte', h, Wq)
            k = torch.einsum('btd,dhe->bhte', h, Wk)
            v = torch.einsum('btd,dhe->bhte', h, Wv)
            scores = torch.einsum('bhqe,bhke->bhqk', q, k) * scale
            scores = torch.where(mask[None, None], scores, -1000000000.0)
            p = _softmax(scores, axis=-1)
            o = torch.einsum('bhqk,bhke->bhqe', p, v)
            o = torch.einsum('bhte,hed->btd', o, Wo)
            mem = o[:, :M, :].clone()
            outs.append(o[:, M:, :])
        return torch.concatenate(outs, axis=1)

    def _B_ref(x, w1, w2):
        h = torch.einsum('bsd,df->bsf', x, w1)
        zero = torch.zeros_like(h)
        h = torch.maximum(h, zero)
        return torch.einsum('bsf,fd->bsd', h, w2)
    x = A_x
    xn = _layernorm(x, axis=-1)
    return x + _A_ref(xn, A_mem0, A_Wq, A_Wk, A_Wv, A_Wo, A_seg_len) + _B_ref(xn, B_w1, B_w2)
```

```asm
; @launch grid=(256,1,1) block=(256,1,1) lds=163840
.amdgcn_target "amdgcn-amd-amdhsa--gfx950"
.text
.globl parallel_sum__memory_aug_recurrent_mem_tr__dense_activation_relu__prompt_kernel
.p2align 8
.type parallel_sum__memory_aug_recurrent_mem_tr__dense_activation_relu__prompt_kernel,@function
parallel_sum__memory_aug_recurrent_mem_tr__dense_activation_relu__prompt_kernel:
s_load_dwordx2 s[4:5], s[0:1], 88
s_load_dwordx2 s[8:9], s[0:1], 96
s_load_dwordx2 s[76:77], s[0:1], 16
s_mov_b32 s78, 4194304
s_mov_b32 s79, 0x00020000
s_load_dwordx2 s[80:81], s[0:1], 24
s_mov_b32 s82, 4194304
s_mov_b32 s83, 0x00020000
s_load_dwordx2 s[92:93], s[0:1], 32
s_mov_b32 s94, 4194304
s_mov_b32 s95, 0x00020000
s_load_dwordx2 s[96:97], s[0:1], 40
s_mov_b32 s98, 4194304
s_mov_b32 s99, 0x00020000
s_load_dwordx2 s[84:85], s[0:1], 0
s_mov_b32 s86, 2097152
s_mov_b32 s87, 0x00020000
s_load_dwordx2 s[40:41], s[0:1], 64
s_mov_b32 s42, 1409024
s_mov_b32 s43, 0x00020000
s_mov_b32 s10, 268435456
s_mov_b32 s11, 0x00020000
s_getreg_b32 s16, hwreg(HW_REG_XCC_ID, 0, 4)
s_and_b32 s16, s16, 7
v_lshrrev_b32 v1, 6, v0
s_nop 0
v_readfirstlane_b32 s18, v1
s_lshl_b32 s46, s16, 2
s_add_u32 s46, s46, 192
s_mov_b32 s36, 0x20000
s_mov_b32 s50, 0x05040100
s_mov_b32 s51, 0x07060302
v_mov_b32 v1, s46
v_mov_b32 v2, 1
v_mov_b32 v4, 0
v_mov_b32 v18, 0
v_and_b32 v5, 63, v0
s_bfe_u32 s47, s2, 327683
s_lshl_b32 s48, s47, 2
s_add_u32 s48, s48, s18
s_waitcnt lgkmcnt(0)
s_cmp_lg_u32 s18, 0
s_cbranch_scc1 L_norank
s_mov_b64 exec, 1
global_atomic_add v3, v1, v2, s[4:5] sc0 sc1
s_mov_b64 exec, -1
L_norank:
s_cmp_eq_u32 s16, 0
s_cbranch_scc1 L_p_team
s_cmp_gt_u32 s16, 4
s_cbranch_scc1 L_p_og
v_lshrrev_b32 v6, 5, v5
v_and_b32 v7, 31, v5
v_lshlrev_b32 v6, 13, v6
v_lshl_add_u32 v17, v7, 6, v6
s_lshl_b32 s48, s48, 14
s_lshl_b32 s46, s16, 11
s_add_u32 s48, s48, s46
s_sub_u32 s48, s48, 2048
s_add_u32 s49, s48, 2097152
s_branch L_p_join
L_p_og:
s_sub_u32 s46, s16, 5
s_lshl_b32 s46, s46, 20
s_lshl_b32 s47, s48, 13
s_add_u32 s46, s46, s47
s_lshl_b32 s48, s48, 12
v_lshl_add_u32 v17, v5, 7, s46
v_lshl_add_u32 v18, v5, 6, s48
s_branch L_p_join
L_p_team:
v_lshrrev_b32 v6, 1, v5
v_and_b32 v7, 1, v5
v_lshlrev_b32 v6, 13, v6
v_lshl_add_u32 v17, v7, 6, v6
v_lshrrev_b32 v6, 2, v5
v_and_b32 v7, 3, v5
v_lshlrev_b32 v6, 10, v6
v_lshl_add_u32 v18, v7, 6, v6
s_lshl_b32 s38, s47, 8
s_lshr_b32 s46, s18, 1
s_lshl_b32 s46, s46, 7
s_add_u32 s38, s38, s46
s_lshl_b32 s46, s18, 20
s_add_u32 s38, s38, s46
s_lshl_b32 s39, s47, 17
s_lshl_b32 s46, s18, 8
s_add_u32 s39, s39, s46
L_p_join:
s_cmp_lg_u32 s18, 0
s_cbranch_scc1 L_norank2
s_mov_b64 exec, 1
s_waitcnt vmcnt(0)
ds_write_b32 v4, v3
s_mov_b64 exec, -1
s_waitcnt lgkmcnt(0)
L_norank2:
s_barrier
ds_read_b32 v3, v4
s_waitcnt lgkmcnt(0)
v_readfirstlane_b32 s17, v3
s_barrier
s_cmp_gt_u32 s17, 31
s_cbranch_scc1 L_exit
s_cmp_eq_u32 s16, 0
s_cbranch_scc1 L_team
s_cmp_gt_u32 s16, 4
s_cbranch_scc1 L_og
s_branch L_head
L_exit:
s_endpgm
L_team:
v_mov_b32 v21, v0
v_bfe_u32 v20, v21, 0, 6
v_lshlrev_b32 v0, 4, v20
s_mov_b32 s46, 32768
v_bfe_u32 v20, v21, 0, 6
v_lshl_add_u32 v1, v20, 4, s46
v_bfe_u32 v20, v21, 6, 2
v_lshl_add_u32 v1, v20, 15, v1
v_bfe_u32 v20, v21, 0, 6
v_lshlrev_b32 v2, 4, v20
v_bfe_u32 v20, v21, 6, 2
v_lshl_add_u32 v2, v20, 11, v2
v_xor_b32 v3, 2048, v2
v_xor_b32 v4, 4096, v2
v_xor_b32 v5, 6144, v2
v_bfe_u32 v20, v21, 1, 1
v_mul_u32_u24 v20, 0xAAAA, v20
v_add_u32 v6, 0x4444, v20
s_mov_b32 s46, 8192
v_bfe_u32 v20, v21, 7, 1
v_lshl_add_u32 v7, v20, 10, s46
v_bfe_u32 v20, v21, 2, 2
v_lshl_add_u32 v7, v20, 8, v7
v_bfe_u32 v20, v21, 6, 1
v_lshl_add_u32 v7, v20, 7, v7
v_bfe_u32 v20, v21, 4, 2
v_lshl_add_u32 v7, v20, 5, v7
v_bfe_u32 v20, v21, 0, 2
v_lshl_add_u32 v7, v20, 2, v7
s_mov_b32 s46, 10240
v_bfe_u32 v20, v21, 7, 1
v_lshl_add_u32 v8, v20, 10, s46
v_bfe_u32 v20, v21, 2, 2
v_lshl_add_u32 v8, v20, 8, v8
v_bfe_u32 v20, v21, 4, 2
v_lshl_add_u32 v8, v20, 6, v8
v_bfe_u32 v20, v21, 6, 1
v_lshl_add_u32 v8, v20, 5, v8
v_bfe_u32 v20, v21, 0, 2
v_lshl_add_u32 v8, v20, 2, v8
v_bfe_u32 v20, v21, 6, 2
v_lshlrev_b32 v9, 8, v20
v_bfe_u32 v20, v21, 5, 1
v_lshl_add_u32 v9, v20, 7, v9
v_bfe_u32 v20, v21, 0, 3
v_lshl_add_u32 v9, v20, 4, v9
v_bfe_u32 v20, v21, 4, 1
v_lshl_add_u32 v9, v20, 3, v9
v_bfe_u32 v20, v21, 3, 1
v_lshl_add_u32 v9, v20, 2, v9
v_bfe_u32 v20, v21, 6, 2
v_lshlrev_b32 v10, 9, v20
v_bfe_u32 v20, v21, 5, 1
v_lshl_add_u32 v10, v20, 8, v10
v_bfe_u32 v20, v21, 1, 2
v_lshl_add_u32 v10, v20, 6, v10
v_bfe_u32 v20, v21, 4, 1
v_lshl_add_u32 v10, v20, 5, v10
v_bfe_u32 v20, v21, 0, 1
v_lshl_add_u32 v10, v20, 4, v10
v_bfe_u32 v20, v21, 3, 1
v_lshl_add_u32 v10, v20, 11, v10
v_bfe_u32 v20, v21, 2, 2
v_lshlrev_b32 v11, 14, v20
v_bfe_u32 v20, v21, 4, 1
v_lshl_add_u32 v11, v20, 13, v11
v_bfe_u32 v20, v21, 5, 1
v_lshl_add_u32 v11, v20, 11, v11
v_bfe_u32 v20, v21, 0, 2
v_lshl_add_u32 v11, v20, 4, v11
v_bfe_u32 v20, v21, 2, 2
v_lshlrev_b32 v12, 28, v20
v_bfe_u32 v20, v21, 4, 1
v_lshl_add_u32 v12, v20, 5, v12
v_bfe_u32 v20, v21, 5, 1
v_lshl_add_u32 v12, v20, 4, v12
v_bfe_u32 v20, v21, 0, 2
v_lshl_add_u32 v12, v20, 2, v12
v_bfe_u32 v20, v21, 1, 1
v_lshlrev_b32 v13, 12, v20
v_bfe_u32 v20, v21, 3, 1
v_lshl_add_u32 v13, v20, 10, v13
v_bfe_u32 v20, v21, 4, 2
v_lshl_add_u32 v13, v20, 8, v13
v_bfe_u32 v20, v21, 6, 2
v_lshl_add_u32 v13, v20, 6, v13
v_bfe_u32 v20, v21, 2, 1
v_lshl_add_u32 v13, v20, 5, v13
v_bfe_u32 v20, v21, 0, 1
v_lshl_add_u32 v13, v20, 4, v13
v_bfe_u32 v20, v21, 0, 5
v_lshlrev_b32 v14, 7, v20
v_bfe_u32 v20, v21, 5, 1
v_lshl_add_u32 v14, v20, 6, v14
s_lshl_b32 s33, s17, 8
s_add_u32 s33, s33, 99614592
s_mov_b32 s60, 516
s_mov_b32 s61, 1
s_mov_b32 s37, 0x01010101
v_mov_b32 v15, 0
v_bfe_u32 v20, v21, 5, 1
v_lshlrev_b32 v26, 10, v20
v_bfe_u32 v20, v21, 0, 2
v_lshl_add_u32 v26, v20, 4, v26
v_bfe_u32 v20, v21, 4, 1
v_lshl_add_u32 v26, v20, 2, v26
v_bfe_u32 v20, v21, 4, 2
v_lshlrev_b32 v27, 17, v20
v_bfe_u32 v20, v21, 0, 4
v_lshl_add_u32 v27, v20, 2, v27
v_bfe_u32 v20, v21, 5, 1
v_lshlrev_b32 v28, 14, v20
v_bfe_u32 v20, v21, 4, 1
v_lshl_add_u32 v28, v20, 12, v28
v_bfe_u32 v20, v21, 0, 4
v_lshl_add_u32 v28, v20, 4, v28
v_bfe_u32 v20, v21, 2, 1
v_lshlrev_b32 v22, 1, v20
v_bfe_u32 v20, v21, 0, 1
v_lshl_add_u32 v22, v20, 0, v22
v_bfe_u32 v20, v21, 3, 1
v_lshlrev_b32 v23, 4, v20
v_mov_b32 v24, 0x3f80
v_lshlrev_b32 v23, v23, v24
v_cmp_eq_u32 vcc, 0, v22
s_nop 1
v_cndmask_b32 v32, 0, v23, vcc
v_cmp_eq_u32 vcc, 1, v22
s_nop 1
v_cndmask_b32 v33, 0, v23, vcc
v_cmp_eq_u32 vcc, 2, v22
s_nop 1
v_cndmask_b32 v34, 0, v23, vcc
v_cmp_eq_u32 vcc, 3, v22
s_nop 1
v_cndmask_b32 v35, 0, v23, vcc
ds_write_b128 v0, v[32:35] offset:17408
s_mov_b32 s52, 1035273459
s_mov_b32 s53, 1069066811
s_lshl_b32 s46, s18, 16
s_lshl_b32 s47, s17, 6
s_add_u32 s46, s46, s47
s_add_u32 s24, s46, 1048576
s_add_u32 s25, s46, 1052672
s_lshl_b32 s46, s17, 13
s_lshl_b32 s21, s18, 11
s_add_u32 s26, s46, 1048576
s_add_u32 s26, s26, s21
s_mul_i32 s29, s17, 2101248
s_add_u32 s29, s29, 16805888
s_add_u32 s30, s29, 8192
s_lshl_b32 s46, s18, 12
s_add_u32 s31, s29, s46
s_lshl_b32 s47, s18, 10
s_add_u32 s46, s29, s47
s_sub_u32 s35, s46, 12288
s_bfe_u32 s49, s17, 131075
s_lshl_b32 s23, s49, 11
s_bfe_u32 s49, s18, 65537
s_lshl_b32 s49, s49, 10
s_add_u32 s23, s23, s49
s_bfe_u32 s49, s17, 131073
s_lshl_b32 s49, s49, 8
s_add_u32 s23, s23, s49
s_bfe_u32 s49, s18, 65536
s_lshl_b32 s49, s49, 7
s_add_u32 s23, s23, s49
s_bfe_u32 s49, s17, 65536
s_lshl_b32 s49, s49, 6
s_add_u32 s23, s23, s49
s_add_u32 s22, s23, 8192
s_bfe_u32 s49, s17, 327680
s_lshl_b32 s46, s49, 8
s_bfe_u32 s49, s18, 131072
s_lshl_b32 s49, s49, 6
s_add_u32 s46, s46, s49
s_xor_b32 s49, s18, 0
s_lshl_b32 s49, s49, 20
s_add_u32 s54, s49, s46
s_xor_b32 s49, s18, 1
s_lshl_b32 s49, s49, 20
s_add_u32 s55, s49, s46
s_xor_b32 s49, s18, 2
s_lshl_b32 s49, s49, 20
s_add_u32 s56, s49, s46
s_xor_b32 s49, s18, 3
s_lshl_b32 s49, s49, 20
s_add_u32 s57, s49, s46
s_load_dwordx2 s[12:13], s[0:1], 8
s_mov_b32 s14, 8192
s_mov_b32 s15, 0x00020000
s_waitcnt lgkmcnt(0)
s_bfe_u32 s49, s18, 65536
s_lshl_b32 s46, s49, 12
s_bfe_u32 s49, s17, 65536
s_lshl_b32 s49, s49, 11
s_add_u32 s46, s46, s49
s_bfe_u32 s49, s17, 131075
s_lshl_b32 s49, s49, 8
s_add_u32 s46, s46, s49
s_bfe_u32 s49, s17, 131073
s_lshl_b32 s49, s49, 6
s_add_u32 s46, s46, s49
s_bfe_u32 s49, s18, 65537
s_lshl_b32 s49, s49, 3
s_add_u32 s46, s46, s49
buffer_load_dword v29, v26, s[12:15], s46 offen
v_mov_b32 v96, -1
v_mov_b32 v97, -1
v_mov_b32 v98, -1
v_mov_b32 v99, -1
buffer_store_dwordx4 v[96:99], v0, s[8:11], s26 offen offset:0
buffer_store_dwordx4 v[96:99], v0, s[8:11], s26 offen offset:1024
s_xor_b32 s26, s26, 262144
buffer_store_dwordx4 v[96:99], v0, s[8:11], s26 offen offset:0
buffer_store_dwordx4 v[96:99], v0, s[8:11], s26 offen offset:1024
s_xor_b32 s26, s26, 262144
buffer_store_dword v96, v12, s[8:11], s22 offen
v_bfe_u32 v16, v21, 4, 2
v_lshl_add_u32 v17, v16, 2, v21
v_and_b32 v17, 15, v17
v_lshlrev_b32 v17, 4, v17
v_lshl_add_u32 v27, v16, 17, v17
v_bfe_u32 v20, v21, 2, 4
v_lshlrev_b32 v26, 10, v20
v_bfe_u32 v20, v21, 0, 2
v_lshl_add_u32 v26, v20, 6, v26
s_lshl_b32 s48, s18, 15
s_add_u32 s48, s48, 32768
s_lshl_b32 s49, s18, 6
s_sub_u32 s49, s54, s49
v_sub_u32 v17, s18, v16
v_and_b32 v17, 3, v17
v_lshlrev_b32 v17, 6, v17
v_lshl_add_u32 v17, v16, 8, v17
v_bfe_u32 v20, v21, 0, 4
v_lshl_add_u32 v22, v20, 2, v17
v_bfe_u32 v20, v21, 6, 2
v_lshl_add_u32 v22, v20, 15, v22
v_xor_b32 v25, 98304, v22
v_add_u32 v25, 32768, v25
v_xor_b32 v24, 65536, v22
v_add_u32 v24, 32768, v24
v_xor_b32 v23, 32768, v22
v_add_u32 v23, 32768, v23
v_xor_b32 v22, 0, v22
v_add_u32 v22, 32768, v22
s_load_dwordx2 s[12:13], s[0:1], 16
s_mov_b32 s14, 4194304
s_mov_b32 s15, 0x00020000
s_waitcnt lgkmcnt(0)
s_add_u32 m0, s48, 0
s_add_u32 s46, s49, 0
buffer_load_dwordx4 v27, s[12:15], s46 offen lds
s_add_u32 m0, s48, 1024
s_add_u32 s46, s49, 8192
buffer_load_dwordx4 v27, s[12:15], s46 offen lds
s_add_u32 m0, s48, 2048
s_add_u32 s46, s49, 16384
buffer_load_dwordx4 v27, s[12:15], s46 offen lds
s_add_u32 m0, s48, 3072
s_add_u32 s46, s49, 24576
buffer_load_dwordx4 v27, s[12:15], s46 offen lds
s_add_u32 m0, s48, 4096
s_add_u32 s46, s49, 65536
buffer_load_dwordx4 v27, s[12:15], s46 offen lds
s_add_u32 m0, s48, 5120
s_add_u32 s46, s49, 73728
buffer_load_dwordx4 v27, s[12:15], s46 offen lds
s_add_u32 m0, s48, 6144
s_add_u32 s46, s49, 81920
buffer_load_dwordx4 v27, s[12:15], s46 offen lds
s_add_u32 m0, s48, 7168
s_add_u32 s46, s49, 90112
buffer_load_dwordx4 v27, s[12:15], s46 offen lds
s_add_u32 m0, s48, 8192
s_add_u32 s46, s49, 524288
buffer_load_dwordx4 v27, s[12:15], s46 offen lds
s_add_u32 m0, s48, 9216
s_add_u32 s46, s49, 532480
buffer_load_dwordx4 v27, s[12:15], s46 offen lds
s_add_u32 m0, s48, 10240
s_add_u32 s46, s49, 540672
buffer_load_dwordx4 v27, s[12:15], s46 offen lds
s_add_u32 m0, s48, 11264
s_add_u32 s46, s49, 548864
buffer_load_dwordx4 v27, s[12:15], s46 offen lds
s_add_u32 m0, s48, 12288
s_add_u32 s46, s49, 589824
buffer_load_dwordx4 v27, s[12:15], s46 offen lds
s_add_u32 m0, s48, 13312
s_add_u32 s46, s49, 598016
buffer_load_dwordx4 v27, s[12:15], s46 offen lds
s_add_u32 m0, s48, 14336
s_add_u32 s46, s49, 606208
buffer_load_dwordx4 v27, s[12:15], s46 offen lds
s_add_u32 m0, s48, 15360
s_add_u32 s46, s49, 614400
buffer_load_dwordx4 v27, s[12:15], s46 offen lds
s_add_u32 m0, s48, 16384
s_add_u32 s46, s49, 32768
buffer_load_dwordx4 v27, s[12:15], s46 offen lds
s_add_u32 m0, s48, 17408
s_add_u32 s46, s49, 40960
buffer_load_dwordx4 v27, s[12:15], s46 offen lds
s_add_u32 m0, s48, 18432
s_add_u32 s46, s49, 49152
buffer_load_dwordx4 v27, s[12:15], s46 offen lds
s_add_u32 m0, s48, 19456
s_add_u32 s46, s49, 57344
buffer_load_dwordx4 v27, s[12:15], s46 offen lds
s_add_u32 m0, s48, 20480
s_add_u32 s46, s49, 98304
buffer_load_dwordx4 v27, s[12:15], s46 offen lds
s_add_u32 m0, s48, 21504
s_add_u32 s46, s49, 106496
buffer_load_dwordx4 v27, s[12:15], s46 offen lds
s_add_u32 m0, s48, 22528
s_add_u32 s46, s49, 114688
buffer_load_dwordx4 v27, s[12:15], s46 offen lds
s_add_u32 m0, s48, 23552
s_add_u32 s46, s49, 122880
buffer_load_dwordx4 v27, s[12:15], s46 offen lds
s_add_u32 m0, s48, 24576
s_add_u32 s46, s49, 557056
buffer_load_dwordx4 v27, s[12:15], s46 offen lds
s_add_u32 m0, s48, 25600
s_add_u32 s46, s49, 565248
buffer_load_dwordx4 v27, s[12:15], s46 offen lds
s_add_u32 m0, s48, 26624
s_add_u32 s46, s49, 573440
buffer_load_dwordx4 v27, s[12:15], s46 offen lds
s_add_u32 m0, s48, 27648
s_add_u32 s46, s49, 581632
buffer_load_dwordx4 v27, s[12:15], s46 offen lds
s_add_u32 m0, s48, 28672
s_add_u32 s46, s49, 622592
buffer_load_dwordx4 v27, s[12:15], s46 offen lds
s_add_u32 m0, s48, 29696
s_add_u32 s46, s49, 630784
buffer_load_dwordx4 v27, s[12:15], s46 offen lds
s_add_u32 m0, s48, 30720
s_add_u32 s46, s49, 638976
buffer_load_dwordx4 v27, s[12:15], s46 offen lds
s_add_u32 m0, s48, 31744
s_add_u32 s46, s49, 647168
buffer_load_dwordx4 v27, s[12:15], s46 offen lds
s_waitcnt vmcnt(24)
buffer_store_dword v29, v12, s[8:11], s23 offen
s_barrier
ds_read2st64_b32 v[32:33], v22 offset0:0 offset1:4
ds_read2st64_b32 v[34:35], v22 offset0:8 offset1:12
ds_read2st64_b32 v[36:37], v22 offset0:16 offset1:20
ds_read2st64_b32 v[38:39], v22 offset0:24 offset1:28
ds_read2st64_b32 v[40:41], v23 offset0:0 offset1:4
ds_read2st64_b32 v[42:43], v23 offset0:8 offset1:12
ds_read2st64_b32 v[44:45], v23 offset0:16 offset1:20
ds_read2st64_b32 v[46:47], v23 offset0:24 offset1:28
ds_read2st64_b32 v[48:49], v24 offset0:0 offset1:4
ds_read2st64_b32 v[50:51], v24 offset0:8 offset1:12
ds_read2st64_b32 v[52:53], v24 offset0:16 offset1:20
ds_read2st64_b32 v[54:55], v24 offset0:24 offset1:28
ds_read2st64_b32 v[56:57], v25 offset0:0 offset1:4
ds_read2st64_b32 v[58:59], v25 offset0:8 offset1:12
ds_read2st64_b32 v[60:61], v25 offset0:16 offset1:20
ds_read2st64_b32 v[62:63], v25 offset0:24 offset1:28
s_waitcnt lgkmcnt(12)
v_perm_b32 v168, v33, v32, s50
v_perm_b32 v169, v35, v34, s50
v_perm_b32 v170, v37, v36, s50
v_perm_b32 v171, v39, v38, s50
v_perm_b32 v176, v33, v32, s51
v_perm_b32 v177, v35, v34, s51
v_perm_b32 v178, v37, v36, s51
v_perm_b32 v179, v39, v38, s51
s_waitcnt lgkmcnt(8)
v_perm_b32 v16, v41, v40, s50
v_perm_b32 v17, v43, v42, s50
v_perm_b32 v18, v45, v44, s50
v_perm_b32 v19, v47, v46, s50
v_accvgpr_write_b32 a40, v16
v_accvgpr_write_b32 a41, v17
v_accvgpr_write_b32 a42, v18
v_accvgpr_write_b32 a43, v19
v_perm_b32 v16, v41, v40, s51
v_perm_b32 v17, v43, v42, s51
v_perm_b32 v18, v45, v44, s51
v_perm_b32 v19, v47, v46, s51
v_accvgpr_write_b32 a48, v16
v_accvgpr_write_b32 a49, v17
v_accvgpr_write_b32 a50, v18
v_accvgpr_write_b32 a51, v19
s_waitcnt lgkmcnt(4)
v_perm_b32 v16, v49, v48, s50
v_perm_b32 v17, v51, v50, s50
v_perm_b32 v18, v53, v52, s50
v_perm_b32 v19, v55, v54, s50
v_accvgpr_write_b32 a72, v16
v_accvgpr_write_b32 a73, v17
v_accvgpr_write_b32 a74, v18
v_accvgpr_write_b32 a75, v19
v_perm_b32 v16, v49, v48, s51
v_perm_b32 v17, v51, v50, s51
v_perm_b32 v18, v53, v52, s51
v_perm_b32 v19, v55, v54, s51
v_accvgpr_write_b32 a80, v16
v_accvgpr_write_b32 a81, v17
v_accvgpr_write_b32 a82, v18
v_accvgpr_write_b32 a83, v19
s_waitcnt lgkmcnt(0)
v_perm_b32 v224, v57, v56, s50
v_perm_b32 v225, v59, v58, s50
v_perm_b32 v226, v61, v60, s50
v_perm_b32 v227, v63, v62, s50
v_perm_b32 v232, v57, v56, s51
v_perm_b32 v233, v59, v58, s51
v_perm_b32 v234, v61, v60, s51
v_perm_b32 v235, v63, v62, s51
s_waitcnt vmcnt(17)
s_barrier
ds_read2st64_b32 v[32:33], v22 offset0:32 offset1:36
ds_read2st64_b32 v[34:35], v22 offset0:40 offset1:44
ds_read2st64_b32 v[36:37], v22 offset0:48 offset1:52
ds_read2st64_b32 v[38:39], v22 offset0:56 offset1:60
ds_read2st64_b32 v[40:41], v23 offset0:32 offset1:36
ds_read2st64_b32 v[42:43], v23 offset0:40 offset1:44
ds_read2st64_b32 v[44:45], v23 offset0:48 offset1:52
ds_read2st64_b32 v[46:47], v23 offset0:56 offset1:60
ds_read2st64_b32 v[48:49], v24 offset0:32 offset1:36
ds_read2st64_b32 v[50:51], v24 offset0:40 offset1:44
ds_read2st64_b32 v[52:53], v24 offset0:48 offset1:52
ds_read2st64_b32 v[54:55], v24 offset0:56 offset1:60
ds_read2st64_b32 v[56:57], v25 offset0:32 offset1:36
ds_read2st64_b32 v[58:59], v25 offset0:40 offset1:44
ds_read2st64_b32 v[60:61], v25 offset0:48 offset1:52
ds_read2st64_b32 v[62:63], v25 offset0:56 offset1:60
s_load_dwordx2 s[12:13], s[0:1], 24
s_mov_b32 s14, 4194304
s_mov_b32 s15, 0x00020000
s_waitcnt lgkmcnt(0)
s_add_u32 m0, s48, 0
s_add_u32 s46, s49, 0
buffer_load_dwordx4 v27, s[12:15], s46 offen lds
s_add_u32 m0, s48, 1024
s_add_u32 s46, s49, 8192
buffer_load_dwordx4 v27, s[12:15], s46 offen lds
s_add_u32 m0, s48, 2048
s_add_u32 s46, s49, 16384
buffer_load_dwordx4 v27, s[12:15], s46 offen lds
s_add_u32 m0, s48, 3072
s_add_u32 s46, s49, 24576
buffer_load_dwordx4 v27, s[12:15], s46 offen lds
s_add_u32 m0, s48, 4096
s_add_u32 s46, s49, 65536
buffer_load_dwordx4 v27, s[12:15], s46 offen lds
s_add_u32 m0, s48, 5120
s_add_u32 s46, s49, 73728
buffer_load_dwordx4 v27, s[12:15], s46 offen lds
s_add_u32 m0, s48, 6144
s_add_u32 s46, s49, 81920
buffer_load_dwordx4 v27, s[12:15], s46 offen lds
s_add_u32 m0, s48, 7168
s_add_u32 s46, s49, 90112
buffer_load_dwordx4 v27, s[12:15], s46 offen lds
s_waitcnt lgkmcnt(12)
v_perm_b32 v172, v33, v32, s50
v_perm_b32 v173, v35, v34, s50
v_perm_b32 v174, v37, v36, s50
v_perm_b32 v175, v39, v38, s50
v_perm_b32 v180, v33, v32, s51
v_perm_b32 v181, v35, v34, s51
v_perm_b32 v182, v37, v36, s51
v_perm_b32 v183, v39, v38, s51
s_waitcnt lgkmcnt(8)
v_perm_b32 v16, v41, v40, s50
v_perm_b32 v17, v43, v42, s50
v_perm_b32 v18, v45, v44, s50
v_perm_b32 v19, v47, v46, s50
v_accvgpr_write_b32 a44, v16
v_accvgpr_write_b32 a45, v17
v_accvgpr_write_b32 a46, v18
v_accvgpr_write_b32 a47, v19
v_perm_b32 v16, v41, v40, s51
v_perm_b32 v17, v43, v42, s51
v_perm_b32 v18, v45, v44, s51
v_perm_b32 v19, v47, v46, s51
v_accvgpr_write_b32 a52, v16
v_accvgpr_write_b32 a53, v17
v_accvgpr_write_b32 a54, v18
v_accvgpr_write_b32 a55, v19
s_waitcnt lgkmcnt(4)
v_perm_b32 v16, v49, v48, s50
v_perm_b32 v17, v51, v50, s50
v_perm_b32 v18, v53, v52, s50
v_perm_b32 v19, v55, v54, s50
v_accvgpr_write_b32 a76, v16
v_accvgpr_write_b32 a77, v17
v_accvgpr_write_b32 a78, v18
v_accvgpr_write_b32 a79, v19
v_perm_b32 v16, v49, v48, s51
v_perm_b32 v17, v51, v50, s51
v_perm_b32 v18, v53, v52, s51
v_perm_b32 v19, v55, v54, s51
v_accvgpr_write_b32 a84, v16
v_accvgpr_write_b32 a85, v17
v_accvgpr_write_b32 a86, v18
v_accvgpr_write_b32 a87, v19
s_waitcnt lgkmcnt(0)
v_perm_b32 v228, v57, v56, s50
v_perm_b32 v229, v59, v58, s50
v_perm_b32 v230, v61, v60, s50
v_perm_b32 v231, v63, v62, s50
v_perm_b32 v236, v57, v56, s51
v_perm_b32 v237, v59, v58, s51
v_perm_b32 v238, v61, v60, s51
v_perm_b32 v239, v63, v62, s51
s_waitcnt vmcnt(17)
s_barrier
ds_read2st64_b32 v[32:33], v22 offset0:64 offset1:68
ds_read2st64_b32 v[34:35], v22 offset0:72 offset1:76
ds_read2st64_b32 v[36:37], v22 offset0:80 offset1:84
ds_read2st64_b32 v[38:39], v22 offset0:88 offset1:92
ds_read2st64_b32 v[40:41], v23 offset0:64 offset1:68
ds_read2st64_b32 v[42:43], v23 offset0:72 offset1:76
ds_read2st64_b32 v[44:45], v23 offset0:80 offset1:84
ds_read2st64_b32 v[46:47], v23 offset0:88 offset1:92
ds_read2st64_b32 v[48:49], v24 offset0:64 offset1:68
ds_read2st64_b32 v[50:51], v24 offset0:72 offset1:76
ds_read2st64_b32 v[52:53], v24 offset0:80 offset1:84
ds_read2st64_b32 v[54:55], v24 offset0:88 offset1:92
ds_read2st64_b32 v[56:57], v25 offset0:64 offset1:68
ds_read2st64_b32 v[58:59], v25 offset0:72 offset1:76
ds_read2st64_b32 v[60:61], v25 offset0:80 offset1:84
ds_read2st64_b32 v[62:63], v25 offset0:88 offset1:92
s_add_u32 m0, s48, 8192
s_add_u32 s46, s49, 524288
buffer_load_dwordx4 v27, s[12:15], s46 offen lds
s_add_u32 m0, s48, 9216
s_add_u32 s46, s49, 532480
buffer_load_dwordx4 v27, s[12:15], s46 offen lds
s_add_u32 m0, s48, 10240
s_add_u32 s46, s49, 540672
buffer_load_dwordx4 v27, s[12:15], s46 offen lds
s_add_u32 m0, s48, 11264
s_add_u32 s46, s49, 548864
buffer_load_dwordx4 v27, s[12:15], s46 offen lds
s_add_u32 m0, s48, 12288
s_add_u32 s46, s49, 589824
buffer_load_dwordx4 v27, s[12:15], s46 offen lds
s_add_u32 m0, s48, 13312
s_add_u32 s46, s49, 598016
buffer_load_dwordx4 v27, s[12:15], s46 offen lds
s_add_u32 m0, s48, 14336
s_add_u32 s46, s49, 606208
buffer_load_dwordx4 v27, s[12:15], s46 offen lds
s_add_u32 m0, s48, 15360
s_add_u32 s46, s49, 614400
buffer_load_dwordx4 v27, s[12:15], s46 offen lds
s_waitcnt lgkmcnt(12)
v_perm_b32 v184, v33, v32, s50
v_perm_b32 v185, v35, v34, s50
v_perm_b32 v186, v37, v36, s50
v_perm_b32 v187, v39, v38, s50
v_perm_b32 v192, v33, v32, s51
v_perm_b32 v193, v35, v34, s51
v_perm_b32 v194, v37, v36, s51
v_perm_b32 v195, v39, v38, s51
s_waitcnt lgkmcnt(8)
v_perm_b32 v16, v41, v40, s50
v_perm_b32 v17, v43, v42, s50
v_perm_b32 v18, v45, v44, s50
v_perm_b32 v19, v47, v46, s50
v_accvgpr_write_b32 a56, v16
v_accvgpr_write_b32 a57, v17
v_accvgpr_write_b32 a58, v18
v_accvgpr_write_b32 a59, v19
v_perm_b32 v16, v41, v40, s51
v_perm_b32 v17, v43, v42, s51
v_perm_b32 v18, v45, v44, s51
v_perm_b32 v19, v47, v46, s51
v_accvgpr_write_b32 a64, v16
v_accvgpr_write_b32 a65, v17
v_accvgpr_write_b32 a66, v18
v_accvgpr_write_b32 a67, v19
s_waitcnt lgkmcnt(4)
v_perm_b32 v16, v49, v48, s50
v_perm_b32 v17, v51, v50, s50
v_perm_b32 v18, v53, v52, s50
v_perm_b32 v19, v55, v54, s50
v_accvgpr_write_b32 a88, v16
v_accvgpr_write_b32 a89, v17
v_accvgpr_write_b32 a90, v18
v_accvgpr_write_b32 a91, v19
v_perm_b32 v16, v49, v48, s51
v_perm_b32 v17, v51, v50, s51
v_perm_b32 v18, v53, v52, s51
v_perm_b32 v19, v55, v54, s51
v_accvgpr_write_b32 a96, v16
v_accvgpr_write_b32 a97, v17
v_accvgpr_write_b32 a98, v18
v_accvgpr_write_b32 a99, v19
s_waitcnt lgkmcnt(0)
v_perm_b32 v240, v57, v56, s50
v_perm_b32 v241, v59, v58, s50
v_perm_b32 v242, v61, v60, s50
v_perm_b32 v243, v63, v62, s50
v_perm_b32 v248, v57, v56, s51
v_perm_b32 v249, v59, v58, s51
v_perm_b32 v250, v61, v60, s51
v_perm_b32 v251, v63, v62, s51
s_waitcnt vmcnt(17)
s_barrier
ds_read2st64_b32 v[32:33], v22 offset0:96 offset1:100
ds_read2st64_b32 v[34:35], v22 offset0:104 offset1:108
ds_read2st64_b32 v[36:37], v22 offset0:112 offset1:116
ds_read2st64_b32 v[38:39], v22 offset0:120 offset1:124
ds_read2st64_b32 v[40:41], v23 offset0:96 offset1:100
ds_read2st64_b32 v[42:43], v23 offset0:104 offset1:108
ds_read2st64_b32 v[44:45], v23 offset0:112 offset1:116
ds_read2st64_b32 v[46:47], v23 offset0:120 offset1:124
ds_read2st64_b32 v[48:49], v24 offset0:96 offset1:100
ds_read2st64_b32 v[50:51], v24 offset0:104 offset1:108
ds_read2st64_b32 v[52:53], v24 offset0:112 offset1:116
ds_read2st64_b32 v[54:55], v24 offset0:120 offset1:124
ds_read2st64_b32 v[56:57], v25 offset0:96 offset1:100
ds_read2st64_b32 v[58:59], v25 offset0:104 offset1:108
ds_read2st64_b32 v[60:61], v25 offset0:112 offset1:116
ds_read2st64_b32 v[62:63], v25 offset0:120 offset1:124
s_add_u32 m0, s48, 16384
s_add_u32 s46, s49, 32768
buffer_load_dwordx4 v27, s[12:15], s46 offen lds
s_add_u32 m0, s48, 17408
s_add_u32 s46, s49, 40960
buffer_load_dwordx4 v27, s[12:15], s46 offen lds
s_add_u32 m0, s48, 18432
s_add_u32 s46, s49, 49152
buffer_load_dwordx4 v27, s[12:15], s46 offen lds
s_add_u32 m0, s48, 19456
s_add_u32 s46, s49, 57344
buffer_load_dwordx4 v27, s[12:15], s46 offen lds
s_add_u32 m0, s48, 20480
s_add_u32 s46, s49, 98304
buffer_load_dwordx4 v27, s[12:15], s46 offen lds
s_add_u32 m0, s48, 21504
s_add_u32 s46, s49, 106496
buffer_load_dwordx4 v27, s[12:15], s46 offen lds
s_add_u32 m0, s48, 22528
s_add_u32 s46, s49, 114688
buffer_load_dwordx4 v27, s[12:15], s46 offen lds
s_add_u32 m0, s48, 23552
s_add_u32 s46, s49, 122880
buffer_load_dwordx4 v27, s[12:15], s46 offen lds
s_waitcnt lgkmcnt(12)
v_perm_b32 v188, v33, v32, s50
v_perm_b32 v189, v35, v34, s50
v_perm_b32 v190, v37, v36, s50
v_perm_b32 v191, v39, v38, s50
v_perm_b32 v196, v33, v32, s51
v_perm_b32 v197, v35, v34, s51
v_perm_b32 v198, v37, v36, s51
v_perm_b32 v199, v39, v38, s51
s_waitcnt lgkmcnt(8)
v_perm_b32 v16, v41, v40, s50
v_perm_b32 v17, v43, v42, s50
v_perm_b32 v18, v45, v44, s50
v_perm_b32 v19, v47, v46, s50
v_accvgpr_write_b32 a60, v16
v_accvgpr_write_b32 a61, v17
v_accvgpr_write_b32 a62, v18
v_accvgpr_write_b32 a63, v19
v_perm_b32 v16, v41, v40, s51
v_perm_b32 v17, v43, v42, s51
v_perm_b32 v18, v45, v44, s51
v_perm_b32 v19, v47, v46, s51
v_accvgpr_write_b32 a68, v16
v_accvgpr_write_b32 a69, v17
v_accvgpr_write_b32 a70, v18
v_accvgpr_write_b32 a71, v19
s_waitcnt lgkmcnt(4)
v_perm_b32 v16, v49, v48, s50
v_perm_b32 v17, v51, v50, s50
v_perm_b32 v18, v53, v52, s50
v_perm_b32 v19, v55, v54, s50
v_accvgpr_write_b32 a92, v16
v_accvgpr_write_b32 a93, v17
v_accvgpr_write_b32 a94, v18
v_accvgpr_write_b32 a95, v19
v_perm_b32 v16, v49, v48, s51
v_perm_b32 v17, v51, v50, s51
v_perm_b32 v18, v53, v52, s51
v_perm_b32 v19, v55, v54, s51
v_accvgpr_write_b32 a100, v16
v_accvgpr_write_b32 a101, v17
v_accvgpr_write_b32 a102, v18
v_accvgpr_write_b32 a103, v19
s_waitcnt lgkmcnt(0)
v_perm_b32 v244, v57, v56, s50
v_perm_b32 v245, v59, v58, s50
v_perm_b32 v246, v61, v60, s50
v_perm_b32 v247, v63, v62, s50
v_perm_b32 v252, v57, v56, s51
v_perm_b32 v253, v59, v58, s51
v_perm_b32 v254, v61, v60, s51
v_perm_b32 v255, v63, v62, s51
s_waitcnt vmcnt(16)
s_barrier
ds_read2st64_b32 v[32:33], v22 offset0:0 offset1:4
ds_read2st64_b32 v[34:35], v22 offset0:8 offset1:12
ds_read2st64_b32 v[36:37], v22 offset0:16 offset1:20
ds_read2st64_b32 v[38:39], v22 offset0:24 offset1:28
ds_read2st64_b32 v[40:41], v23 offset0:0 offset1:4
ds_read2st64_b32 v[42:43], v23 offset0:8 offset1:12
ds_read2st64_b32 v[44:45], v23 offset0:16 offset1:20
ds_read2st64_b32 v[46:47], v23 offset0:24 offset1:28
ds_read2st64_b32 v[48:49], v24 offset0:0 offset1:4
ds_read2st64_b32 v[50:51], v24 offset0:8 offset1:12
ds_read2st64_b32 v[52:53], v24 offset0:16 offset1:20
ds_read2st64_b32 v[54:55], v24 offset0:24 offset1:28
ds_read2st64_b32 v[56:57], v25 offset0:0 offset1:4
ds_read2st64_b32 v[58:59], v25 offset0:8 offset1:12
ds_read2st64_b32 v[60:61], v25 offset0:16 offset1:20
ds_read2st64_b32 v[62:63], v25 offset0:24 offset1:28
s_add_u32 m0, s48, 24576
s_add_u32 s46, s49, 557056
buffer_load_dwordx4 v27, s[12:15], s46 offen lds
s_add_u32 m0, s48, 25600
s_add_u32 s46, s49, 565248
buffer_load_dwordx4 v27, s[12:15], s46 offen lds
s_add_u32 m0, s48, 26624
s_add_u32 s46, s49, 573440
buffer_load_dwordx4 v27, s[12:15], s46 offen lds
s_add_u32 m0, s48, 27648
s_add_u32 s46, s49, 581632
buffer_load_dwordx4 v27, s[12:15], s46 offen lds
s_add_u32 m0, s48, 28672
s_add_u32 s46, s49, 622592
buffer_load_dwordx4 v27, s[12:15], s46 offen lds
s_add_u32 m0, s48, 29696
s_add_u32 s46, s49, 630784
buffer_load_dwordx4 v27, s[12:15], s46 offen lds
s_add_u32 m0, s48, 30720
s_add_u32 s46, s49, 638976
buffer_load_dwordx4 v27, s[12:15], s46 offen lds
s_add_u32 m0, s48, 31744
s_add_u32 s46, s49, 647168
buffer_load_dwordx4 v27, s[12:15], s46 offen lds
s_waitcnt lgkmcnt(12)
v_perm_b32 v200, v33, v32, s50
v_perm_b32 v201, v35, v34, s50
v_perm_b32 v202, v37, v36, s50
v_perm_b32 v203, v39, v38, s50
v_perm_b32 v208, v33, v32, s51
v_perm_b32 v209, v35, v34, s51
v_perm_b32 v210, v37, v36, s51
v_perm_b32 v211, v39, v38, s51
s_waitcnt lgkmcnt(8)
v_perm_b32 v16, v41, v40, s50
v_perm_b32 v17, v43, v42, s50
v_perm_b32 v18, v45, v44, s50
v_perm_b32 v19, v47, v46, s50
v_accvgpr_write_b32 a104, v16
v_accvgpr_write_b32 a105, v17
v_accvgpr_write_b32 a106, v18
v_accvgpr_write_b32 a107, v19
v_perm_b32 v16, v41, v40, s51
v_perm_b32 v17, v43, v42, s51
v_perm_b32 v18, v45, v44, s51
v_perm_b32 v19, v47, v46, s51
v_accvgpr_write_b32 a112, v16
v_accvgpr_write_b32 a113, v17
v_accvgpr_write_b32 a114, v18
v_accvgpr_write_b32 a115, v19
s_waitcnt lgkmcnt(4)
v_perm_b32 v16, v49, v48, s50
v_perm_b32 v17, v51, v50, s50
v_perm_b32 v18, v53, v52, s50
v_perm_b32 v19, v55, v54, s50
v_accvgpr_write_b32 a136, v16
v_accvgpr_write_b32 a137, v17
v_accvgpr_write_b32 a138, v18
v_accvgpr_write_b32 a139, v19
v_perm_b32 v16, v49, v48, s51
v_perm_b32 v17, v51, v50, s51
v_perm_b32 v18, v53, v52, s51
v_perm_b32 v19, v55, v54, s51
v_accvgpr_write_b32 a144, v16
v_accvgpr_write_b32 a145, v17
v_accvgpr_write_b32 a146, v18
v_accvgpr_write_b32 a147, v19
s_waitcnt lgkmcnt(0)
v_perm_b32 v16, v57, v56, s50
v_perm_b32 v17, v59, v58, s50
v_perm_b32 v18, v61, v60, s50
v_perm_b32 v19, v63, v62, s50
v_accvgpr_write_b32 a168, v16
v_accvgpr_write_b32 a169, v17
v_accvgpr_write_b32 a170, v18
v_accvgpr_write_b32 a171, v19
v_perm_b32 v16, v57, v56, s51
v_perm_b32 v17, v59, v58, s51
v_perm_b32 v18, v61, v60, s51
v_perm_b32 v19, v63, v62, s51
v_accvgpr_write_b32 a176, v16
v_accvgpr_write_b32 a177, v17
v_accvgpr_write_b32 a178, v18
v_accvgpr_write_b32 a179, v19
s_waitcnt vmcnt(16)
s_barrier
s_cmp_lg_u32 s18, 0
s_cbranch_scc1 L_t_noarr
s_mov_b64 exec, 1
v_mov_b32 v30, 1
v_mov_b32 v31, 0
global_atomic_add v31, v30, s[4:5] sc1
s_mov_b64 exec, -1
L_t_noarr:
ds_read2st64_b32 v[32:33], v22 offset0:32 offset1:36
ds_read2st64_b32 v[34:35], v22 offset0:40 offset1:44
ds_read2st64_b32 v[36:37], v22 offset0:48 offset1:52
ds_read2st64_b32 v[38:39], v22 offset0:56 offset1:60
ds_read2st64_b32 v[40:41], v23 offset0:32 offset1:36
ds_read2st64_b32 v[42:43], v23 offset0:40 offset1:44
ds_read2st64_b32 v[44:45], v23 offset0:48 offset1:52
ds_read2st64_b32 v[46:47], v23 offset0:56 offset1:60
ds_read2st64_b32 v[48:49], v24 offset0:32 offset1:36
ds_read2st64_b32 v[50:51], v24 offset0:40 offset1:44
ds_read2st64_b32 v[52:53], v24 offset0:48 offset1:52
ds_read2st64_b32 v[54:55], v24 offset0:56 offset1:60
ds_read2st64_b32 v[56:57], v25 offset0:32 offset1:36
ds_read2st64_b32 v[58:59], v25 offset0:40 offset1:44
ds_read2st64_b32 v[60:61], v25 offset0:48 offset1:52
ds_read2st64_b32 v[62:63], v25 offset0:56 offset1:60
s_load_dwordx2 s[12:13], s[0:1], 32
s_mov_b32 s14, 4194304
s_mov_b32 s15, 0x00020000
s_waitcnt lgkmcnt(0)
s_add_u32 m0, s48, 0
s_add_u32 s46, s49, 0
buffer_load_dwordx4 v27, s[12:15], s46 offen lds
s_add_u32 m0, s48, 1024
s_add_u32 s46, s49, 8192
buffer_load_dwordx4 v27, s[12:15], s46 offen lds
s_add_u32 m0, s48, 2048
s_add_u32 s46, s49, 16384
buffer_load_dwordx4 v27, s[12:15], s46 offen lds
s_add_u32 m0, s48, 3072
s_add_u32 s46, s49, 24576
buffer_load_dwordx4 v27, s[12:15], s46 offen lds
s_add_u32 m0, s48, 4096
s_add_u32 s46, s49, 65536
buffer_load_dwordx4 v27, s[12:15], s46 offen lds
s_add_u32 m0, s48, 5120
s_add_u32 s46, s49, 73728
buffer_load_dwordx4 v27, s[12:15], s46 offen lds
s_add_u32 m0, s48, 6144
s_add_u32 s46, s49, 81920
buffer_load_dwordx4 v27, s[12:15], s46 offen lds
s_add_u32 m0, s48, 7168
s_add_u32 s46, s49, 90112
buffer_load_dwordx4 v27, s[12:15], s46 offen lds
s_waitcnt lgkmcnt(12)
v_perm_b32 v204, v33, v32, s50
v_perm_b32 v205, v35, v34, s50
v_perm_b32 v206, v37, v36, s50
v_perm_b32 v207, v39, v38, s50
v_perm_b32 v212, v33, v32, s51
v_perm_b32 v213, v35, v34, s51
v_perm_b32 v214, v37, v36, s51
v_perm_b32 v215, v39, v38, s51
s_waitcnt lgkmcnt(8)
v_perm_b32 v16, v41, v40, s50
v_perm_b32 v17, v43, v42, s50
v_perm_b32 v18, v45, v44, s50
v_perm_b32 v19, v47, v46, s50
v_accvgpr_write_b32 a108, v16
v_accvgpr_write_b32 a109, v17
v_accvgpr_write_b32 a110, v18
v_accvgpr_write_b32 a111, v19
v_perm_b32 v16, v41, v40, s51
v_perm_b32 v17, v43, v42, s51
v_perm_b32 v18, v45, v44, s51
v_perm_b32 v19, v47, v46, s51
v_accvgpr_write_b32 a116, v16
v_accvgpr_write_b32 a117, v17
v_accvgpr_write_b32 a118, v18
v_accvgpr_write_b32 a119, v19
s_waitcnt lgkmcnt(4)
v_perm_b32 v16, v49, v48, s50
v_perm_b32 v17, v51, v50, s50
v_perm_b32 v18, v53, v52, s50
v_perm_b32 v19, v55, v54, s50
v_accvgpr_write_b32 a140, v16
v_accvgpr_write_b32 a141, v17
v_accvgpr_write_b32 a142, v18
v_accvgpr_write_b32 a143, v19
v_perm_b32 v16, v49, v48, s51
v_perm_b32 v17, v51, v50, s51
v_perm_b32 v18, v53, v52, s51
v_perm_b32 v19, v55, v54, s51
v_accvgpr_write_b32 a148, v16
v_accvgpr_write_b32 a149, v17
v_accvgpr_write_b32 a150, v18
v_accvgpr_write_b32 a151, v19
s_waitcnt lgkmcnt(0)
v_perm_b32 v16, v57, v56, s50
v_perm_b32 v17, v59, v58, s50
v_perm_b32 v18, v61, v60, s50
v_perm_b32 v19, v63, v62, s50
v_accvgpr_write_b32 a172, v16
v_accvgpr_write_b32 a173, v17
v_accvgpr_write_b32 a174, v18
v_accvgpr_write_b32 a175, v19
v_perm_b32 v16, v57, v56, s51
v_perm_b32 v17, v59, v58, s51
v_perm_b32 v18, v61, v60, s51
v_perm_b32 v19, v63, v62, s51
v_accvgpr_write_b32 a180, v16
v_accvgpr_write_b32 a181, v17
v_accvgpr_write_b32 a182, v18
v_accvgpr_write_b32 a183, v19
s_waitcnt vmcnt(16)
s_barrier
ds_read2st64_b32 v[32:33], v22 offset0:64 offset1:68
ds_read2st64_b32 v[34:35], v22 offset0:72 offset1:76
ds_read2st64_b32 v[36:37], v22 offset0:80 offset1:84
ds_read2st64_b32 v[38:39], v22 offset0:88 offset1:92
ds_read2st64_b32 v[40:41], v23 offset0:64 offset1:68
ds_read2st64_b32 v[42:43], v23 offset0:72 offset1:76
ds_read2st64_b32 v[44:45], v23 offset0:80 offset1:84
ds_read2st64_b32 v[46:47], v23 offset0:88 offset1:92
ds_read2st64_b32 v[48:49], v24 offset0:64 offset1:68
ds_read2st64_b32 v[50:51], v24 offset0:72 offset1:76
ds_read2st64_b32 v[52:53], v24 offset0:80 offset1:84
ds_read2st64_b32 v[54:55], v24 offset0:88 offset1:92
ds_read2st64_b32 v[56:57], v25 offset0:64 offset1:68
ds_read2st64_b32 v[58:59], v25 offset0:72 offset1:76
ds_read2st64_b32 v[60:61], v25 offset0:80 offset1:84
ds_read2st64_b32 v[62:63], v25 offset0:88 offset1:92
s_add_u32 m0, s48, 8192
s_add_u32 s46, s49, 524288
buffer_load_dwordx4 v27, s[12:15], s46 offen lds
s_add_u32 m0, s48, 9216
s_add_u32 s46, s49, 532480
buffer_load_dwordx4 v27, s[12:15], s46 offen lds
s_add_u32 m0, s48, 10240
s_add_u32 s46, s49, 540672
buffer_load_dwordx4 v27, s[12:15], s46 offen lds
s_add_u32 m0, s48, 11264
s_add_u32 s46, s49, 548864
buffer_load_dwordx4 v27, s[12:15], s46 offen lds
s_add_u32 m0, s48, 12288
s_add_u32 s46, s49, 589824
buffer_load_dwordx4 v27, s[12:15], s46 offen lds
s_add_u32 m0, s48, 13312
s_add_u32 s46, s49, 598016
buffer_load_dwordx4 v27, s[12:15], s46 offen lds
s_add_u32 m0, s48, 14336
s_add_u32 s46, s49, 606208
buffer_load_dwordx4 v27, s[12:15], s46 offen lds
s_add_u32 m0, s48, 15360
s_add_u32 s46, s49, 614400
buffer_load_dwordx4 v27, s[12:15], s46 offen lds
s_waitcnt lgkmcnt(12)
v_perm_b32 v216, v33, v32, s50
v_perm_b32 v217, v35, v34, s50
v_perm_b32 v218, v37, v36, s50
v_perm_b32 v219, v39, v38, s50
v_perm_b32 v16, v33, v32, s51
v_perm_b32 v17, v35, v34, s51
v_perm_b32 v18, v37, v36, s51
v_perm_b32 v19, v39, v38, s51
v_accvgpr_write_b32 a0, v16
v_accvgpr_write_b32 a1, v17
v_accvgpr_write_b32 a2, v18
v_accvgpr_write_b32 a3, v19
s_waitcnt lgkmcnt(8)
v_perm_b32 v16, v41, v40, s50
v_perm_b32 v17, v43, v42, s50
v_perm_b32 v18, v45, v44, s50
v_perm_b32 v19, v47, v46, s50
v_accvgpr_write_b32 a120, v16
v_accvgpr_write_b32 a121, v17
v_accvgpr_write_b32 a122, v18
v_accvgpr_write_b32 a123, v19
v_perm_b32 v16, v41, v40, s51
v_perm_b32 v17, v43, v42, s51
v_perm_b32 v18, v45, v44, s51
v_perm_b32 v19, v47, v46, s51
v_accvgpr_write_b32 a128, v16
v_accvgpr_write_b32 a129, v17
v_accvgpr_write_b32 a130, v18
v_accvgpr_write_b32 a131, v19
s_waitcnt lgkmcnt(4)
v_perm_b32 v16, v49, v48, s50
v_perm_b32 v17, v51, v50, s50
v_perm_b32 v18, v53, v52, s50
v_perm_b32 v19, v55, v54, s50
v_accvgpr_write_b32 a152, v16
v_accvgpr_write_b32 a153, v17
v_accvgpr_write_b32 a154, v18
v_accvgpr_write_b32 a155, v19
v_perm_b32 v16, v49, v48, s51
v_perm_b32 v17, v51, v50, s51
v_perm_b32 v18, v53, v52, s51
v_perm_b32 v19, v55, v54, s51
v_accvgpr_write_b32 a160, v16
v_accvgpr_write_b32 a161, v17
v_accvgpr_write_b32 a162, v18
v_accvgpr_write_b32 a163, v19
s_waitcnt lgkmcnt(0)
v_perm_b32 v16, v57, v56, s50
v_perm_b32 v17, v59, v58, s50
v_perm_b32 v18, v61, v60, s50
v_perm_b32 v19, v63, v62, s50
v_accvgpr_write_b32 a184, v16
v_accvgpr_write_b32 a185, v17
v_accvgpr_write_b32 a186, v18
v_accvgpr_write_b32 a187, v19
v_perm_b32 v16, v57, v56, s51
v_perm_b32 v17, v59, v58, s51
v_perm_b32 v18, v61, v60, s51
v_perm_b32 v19, v63, v62, s51
v_accvgpr_write_b32 a192, v16
v_accvgpr_write_b32 a193, v17
v_accvgpr_write_b32 a194, v18
v_accvgpr_write_b32 a195, v19
s_waitcnt vmcnt(16)
s_barrier
ds_read2st64_b32 v[32:33], v22 offset0:96 offset1:100
ds_read2st64_b32 v[34:35], v22 offset0:104 offset1:108
ds_read2st64_b32 v[36:37], v22 offset0:112 offset1:116
ds_read2st64_b32 v[38:39], v22 offset0:120 offset1:124
ds_read2st64_b32 v[40:41], v23 offset0:96 offset1:100
ds_read2st64_b32 v[42:43], v23 offset0:104 offset1:108
ds_read2st64_b32 v[44:45], v23 offset0:112 offset1:116
ds_read2st64_b32 v[46:47], v23 offset0:120 offset1:124
ds_read2st64_b32 v[48:49], v24 offset0:96 offset1:100
ds_read2st64_b32 v[50:51], v24 offset0:104 offset1:108
ds_read2st64_b32 v[52:53], v24 offset0:112 offset1:116
ds_read2st64_b32 v[54:55], v24 offset0:120 offset1:124
ds_read2st64_b32 v[56:57], v25 offset0:96 offset1:100
ds_read2st64_b32 v[58:59], v25 offset0:104 offset1:108
ds_read2st64_b32 v[60:61], v25 offset0:112 offset1:116
ds_read2st64_b32 v[62:63], v25 offset0:120 offset1:124
s_add_u32 m0, s48, 16384
s_add_u32 s46, s49, 32768
buffer_load_dwordx4 v27, s[12:15], s46 offen lds
s_add_u32 m0, s48, 17408
s_add_u32 s46, s49, 40960
buffer_load_dwordx4 v27, s[12:15], s46 offen lds
s_add_u32 m0, s48, 18432
s_add_u32 s46, s49, 49152
buffer_load_dwordx4 v27, s[12:15], s46 offen lds
s_add_u32 m0, s48, 19456
s_add_u32 s46, s49, 57344
buffer_load_dwordx4 v27, s[12:15], s46 offen lds
s_add_u32 m0, s48, 20480
s_add_u32 s46, s49, 98304
buffer_load_dwordx4 v27, s[12:15], s46 offen lds
s_add_u32 m0, s48, 21504
s_add_u32 s46, s49, 106496
buffer_load_dwordx4 v27, s[12:15], s46 offen lds
s_add_u32 m0, s48, 22528
s_add_u32 s46, s49, 114688
buffer_load_dwordx4 v27, s[12:15], s46 offen lds
s_add_u32 m0, s48, 23552
s_add_u32 s46, s49, 122880
buffer_load_dwordx4 v27, s[12:15], s46 offen lds
s_waitcnt lgkmcnt(12)
v_perm_b32 v220, v33, v32, s50
v_perm_b32 v221, v35, v34, s50
v_perm_b32 v222, v37, v36, s50
v_perm_b32 v223, v39, v38, s50
v_perm_b32 v16, v33, v32, s51
v_perm_b32 v17, v35, v34, s51
v_perm_b32 v18, v37, v36, s51
v_perm_b32 v19, v39, v38, s51
v_accvgpr_write_b32 a4, v16
v_accvgpr_write_b32 a5, v17
v_accvgpr_write_b32 a6, v18
v_accvgpr_write_b32 a7, v19
s_waitcnt lgkmcnt(8)
v_perm_b32 v16, v41, v40, s50
v_perm_b32 v17, v43, v42, s50
v_perm_b32 v18, v45, v44, s50
v_perm_b32 v19, v47, v46, s50
v_accvgpr_write_b32 a124, v16
v_accvgpr_write_b32 a125, v17
v_accvgpr_write_b32 a126, v18
v_accvgpr_write_b32 a127, v19
v_perm_b32 v16, v41, v40, s51
v_perm_b32 v17, v43, v42, s51
v_perm_b32 v18, v45, v44, s51
v_perm_b32 v19, v47, v46, s51
v_accvgpr_write_b32 a132, v16
v_accvgpr_write_b32 a133, v17
v_accvgpr_write_b32 a134, v18
v_accvgpr_write_b32 a135, v19
s_waitcnt lgkmcnt(4)
v_perm_b32 v16, v49, v48, s50
v_perm_b32 v17, v51, v50, s50
v_perm_b32 v18, v53, v52, s50
v_perm_b32 v19, v55, v54, s50
v_accvgpr_write_b32 a156, v16
v_accvgpr_write_b32 a157, v17
v_accvgpr_write_b32 a158, v18
v_accvgpr_write_b32 a159, v19
v_perm_b32 v16, v49, v48, s51
v_perm_b32 v17, v51, v50, s51
v_perm_b32 v18, v53, v52, s51
v_perm_b32 v19, v55, v54, s51
v_accvgpr_write_b32 a164, v16
v_accvgpr_write_b32 a165, v17
v_accvgpr_write_b32 a166, v18
v_accvgpr_write_b32 a167, v19
s_waitcnt lgkmcnt(0)
v_perm_b32 v16, v57, v56, s50
v_perm_b32 v17, v59, v58, s50
v_perm_b32 v18, v61, v60, s50
v_perm_b32 v19, v63, v62, s50
v_accvgpr_write_b32 a188, v16
v_accvgpr_write_b32 a189, v17
v_accvgpr_write_b32 a190, v18
v_accvgpr_write_b32 a191, v19
v_perm_b32 v16, v57, v56, s51
v_perm_b32 v17, v59, v58, s51
v_perm_b32 v18, v61, v60, s51
v_perm_b32 v19, v63, v62, s51
v_accvgpr_write_b32 a196, v16
v_accvgpr_write_b32 a197, v17
v_accvgpr_write_b32 a198, v18
v_accvgpr_write_b32 a199, v19
s_waitcnt vmcnt(16)
s_barrier
ds_read2st64_b32 v[32:33], v22 offset0:0 offset1:4
ds_read2st64_b32 v[34:35], v22 offset0:8 offset1:12
ds_read2st64_b32 v[36:37], v22 offset0:16 offset1:20
ds_read2st64_b32 v[38:39], v22 offset0:24 offset1:28
ds_read2st64_b32 v[40:41], v23 offset0:0 offset1:4
ds_read2st64_b32 v[42:43], v23 offset0:8 offset1:12
ds_read2st64_b32 v[44:45], v23 offset0:16 offset1:20
ds_read2st64_b32 v[46:47], v23 offset0:24 offset1:28
ds_read2st64_b32 v[48:49], v24 offset0:0 offset1:4
ds_read2st64_b32 v[50:51], v24 offset0:8 offset1:12
ds_read2st64_b32 v[52:53], v24 offset0:16 offset1:20
ds_read2st64_b32 v[54:55], v24 offset0:24 offset1:28
ds_read2st64_b32 v[56:57], v25 offset0:0 offset1:4
ds_read2st64_b32 v[58:59], v25 offset0:8 offset1:12
ds_read2st64_b32 v[60:61], v25 offset0:16 offset1:20
ds_read2st64_b32 v[62:63], v25 offset0:24 offset1:28
s_add_u32 m0, s48, 24576
s_add_u32 s46, s49, 557056
buffer_load_dwordx4 v27, s[12:15], s46 offen lds
s_add_u32 m0, s48, 25600
s_add_u32 s46, s49, 565248
buffer_load_dwordx4 v27, s[12:15], s46 offen lds
s_add_u32 m0, s48, 26624
s_add_u32 s46, s49, 573440
buffer_load_dwordx4 v27, s[12:15], s46 offen lds
s_add_u32 m0, s48, 27648
s_add_u32 s46, s49, 581632
buffer_load_dwordx4 v27, s[12:15], s46 offen lds
s_add_u32 m0, s48, 28672
s_add_u32 s46, s49, 622592
buffer_load_dwordx4 v27, s[12:15], s46 offen lds
s_add_u32 m0, s48, 29696
s_add_u32 s46, s49, 630784
buffer_load_dwordx4 v27, s[12:15], s46 offen lds
s_add_u32 m0, s48, 30720
s_add_u32 s46, s49, 638976
buffer_load_dwordx4 v27, s[12:15], s46 offen lds
s_add_u32 m0, s48, 31744
s_add_u32 s46, s49, 647168
buffer_load_dwordx4 v27, s[12:15], s46 offen lds
s_load_dwordx2 s[12:13], s[0:1], 40
s_mov_b32 s14, 4194304
s_mov_b32 s15, 0x00020000
s_waitcnt lgkmcnt(0)
s_lshl_b32 s47, s17, 17
s_lshl_b32 s46, s18, 8
s_add_u32 s47, s47, s46
s_add_u32 s46, s47, 0
buffer_load_dwordx4 v[64:67], v28, s[12:15], s46 offen
s_add_u32 s46, s47, 1024
buffer_load_dwordx4 v[68:71], v28, s[12:15], s46 offen
s_add_u32 s46, s47, 8192
buffer_load_dwordx4 v[72:75], v28, s[12:15], s46 offen
s_add_u32 s46, s47, 9216
buffer_load_dwordx4 v[76:79], v28, s[12:15], s46 offen
s_add_u32 s46, s47, 2048
buffer_load_dwordx4 v[80:83], v28, s[12:15], s46 offen
s_add_u32 s46, s47, 3072
buffer_load_dwordx4 v[84:87], v28, s[12:15], s46 offen
s_add_u32 s46, s47, 10240
buffer_load_dwordx4 v[88:91], v28, s[12:15], s46 offen
s_add_u32 s46, s47, 11264
buffer_load_dwordx4 v[92:95], v28, s[12:15], s46 offen
s_add_u32 s46, s47, 32768
buffer_load_dwordx4 v[96:99], v28, s[12:15], s46 offen
s_add_u32 s46, s47, 33792
buffer_load_dwordx4 v[100:103], v28, s[12:15], s46 offen
s_add_u32 s46, s47, 40960
buffer_load_dwordx4 v[104:107], v28, s[12:15], s46 offen
s_add_u32 s46, s47, 41984
buffer_load_dwordx4 v[108:111], v28, s[12:15], s46 offen
s_add_u32 s46, s47, 34816
buffer_load_dwordx4 v[112:115], v28, s[12:15], s46 offen
s_add_u32 s46, s47, 35840
buffer_load_dwordx4 v[116:119], v28, s[12:15], s46 offen
s_add_u32 s46, s47, 43008
buffer_load_dwordx4 v[120:123], v28, s[12:15], s46 offen
s_add_u32 s46, s47, 44032
buffer_load_dwordx4 v[124:127], v28, s[12:15], s46 offen
s_add_u32 s46, s47, 65536
buffer_load_dword v15, v26, s[12:15], s46 offen
s_add_u32 s46, s47, 81920
buffer_load_dword v15, v26, s[12:15], s46 offen
s_add_u32 s46, s47, 98304
buffer_load_dword v15, v26, s[12:15], s46 offen
s_add_u32 s46, s47, 114688
buffer_load_dword v15, v26, s[12:15], s46 offen
s_waitcnt lgkmcnt(12)
v_perm_b32 v16, v33, v32, s50
v_perm_b32 v17, v35, v34, s50
v_perm_b32 v18, v37, v36, s50
v_perm_b32 v19, v39, v38, s50
v_accvgpr_write_b32 a8, v16
v_accvgpr_write_b32 a9, v17
v_accvgpr_write_b32 a10, v18
v_accvgpr_write_b32 a11, v19
v_perm_b32 v16, v33, v32, s51
v_perm_b32 v17, v35, v34, s51
v_perm_b32 v18, v37, v36, s51
v_perm_b32 v19, v39, v38, s51
v_accvgpr_write_b32 a16, v16
v_accvgpr_write_b32 a17, v17
v_accvgpr_write_b32 a18, v18
v_accvgpr_write_b32 a19, v19
s_waitcnt lgkmcnt(8)
v_perm_b32 v16, v41, v40, s50
v_perm_b32 v17, v43, v42, s50
v_perm_b32 v18, v45, v44, s50
v_perm_b32 v19, v47, v46, s50
v_accvgpr_write_b32 a200, v16
v_accvgpr_write_b32 a201, v17
v_accvgpr_write_b32 a202, v18
v_accvgpr_write_b32 a203, v19
v_perm_b32 v16, v41, v40, s51
v_perm_b32 v17, v43, v42, s51
v_perm_b32 v18, v45, v44, s51
v_perm_b32 v19, v47, v46, s51
v_accvgpr_write_b32 a208, v16
v_accvgpr_write_b32 a209, v17
v_accvgpr_write_b32 a210, v18
v_accvgpr_write_b32 a211, v19
s_waitcnt lgkmcnt(4)
v_perm_b32 v16, v49, v48, s50
v_perm_b32 v17, v51, v50, s50
v_perm_b32 v18, v53, v52, s50
v_perm_b32 v19, v55, v54, s50
v_accvgpr_write_b32 a232, v16
v_accvgpr_write_b32 a233, v17
v_accvgpr_write_b32 a234, v18
v_accvgpr_write_b32 a235, v19
v_perm_b32 v16, v49, v48, s51
v_perm_b32 v17, v51, v50, s51
v_perm_b32 v18, v53, v52, s51
v_perm_b32 v19, v55, v54, s51
v_accvgpr_write_b32 a240, v16
v_accvgpr_write_b32 a241, v17
v_accvgpr_write_b32 a242, v18
v_accvgpr_write_b32 a243, v19
s_waitcnt lgkmcnt(0)
v_perm_b32 v136, v57, v56, s50
v_perm_b32 v137, v59, v58, s50
v_perm_b32 v138, v61, v60, s50
v_perm_b32 v139, v63, v62, s50
v_perm_b32 v144, v57, v56, s51
v_perm_b32 v145, v59, v58, s51
v_perm_b32 v146, v61, v60, s51
v_perm_b32 v147, v63, v62, s51
s_waitcnt vmcnt(36)
s_barrier
ds_read2st64_b32 v[32:33], v22 offset0:32 offset1:36
ds_read2st64_b32 v[34:35], v22 offset0:40 offset1:44
ds_read2st64_b32 v[36:37], v22 offset0:48 offset1:52
ds_read2st64_b32 v[38:39], v22 offset0:56 offset1:60
ds_read2st64_b32 v[40:41], v23 offset0:32 offset1:36
ds_read2st64_b32 v[42:43], v23 offset0:40 offset1:44
ds_read2st64_b32 v[44:45], v23 offset0:48 offset1:52
ds_read2st64_b32 v[46:47], v23 offset0:56 offset1:60
ds_read2st64_b32 v[48:49], v24 offset0:32 offset1:36
ds_read2st64_b32 v[50:51], v24 offset0:40 offset1:44
ds_read2st64_b32 v[52:53], v24 offset0:48 offset1:52
ds_read2st64_b32 v[54:55], v24 offset0:56 offset1:60
ds_read2st64_b32 v[56:57], v25 offset0:32 offset1:36
ds_read2st64_b32 v[58:59], v25 offset0:40 offset1:44
ds_read2st64_b32 v[60:61], v25 offset0:48 offset1:52
ds_read2st64_b32 v[62:63], v25 offset0:56 offset1:60
s_waitcnt lgkmcnt(12)
v_perm_b32 v16, v33, v32, s50
v_perm_b32 v17, v35, v34, s50
v_perm_b32 v18, v37, v36, s50
v_perm_b32 v19, v39, v38, s50
v_accvgpr_write_b32 a12, v16
v_accvgpr_write_b32 a13, v17
v_accvgpr_write_b32 a14, v18
v_accvgpr_write_b32 a15, v19
v_perm_b32 v16, v33, v32, s51
v_perm_b32 v17, v35, v34, s51
v_perm_b32 v18, v37, v36, s51
v_perm_b32 v19, v39, v38, s51
v_accvgpr_write_b32 a20, v16
v_accvgpr_write_b32 a21, v17
v_accvgpr_write_b32 a22, v18
v_accvgpr_write_b32 a23, v19
s_waitcnt lgkmcnt(8)
v_perm_b32 v16, v41, v40, s50
v_perm_b32 v17, v43, v42, s50
v_perm_b32 v18, v45, v44, s50
v_perm_b32 v19, v47, v46, s50
v_accvgpr_write_b32 a204, v16
v_accvgpr_write_b32 a205, v17
v_accvgpr_write_b32 a206, v18
v_accvgpr_write_b32 a207, v19
v_perm_b32 v16, v41, v40, s51
v_perm_b32 v17, v43, v42, s51
v_perm_b32 v18, v45, v44, s51
v_perm_b32 v19, v47, v46, s51
v_accvgpr_write_b32 a212, v16
v_accvgpr_write_b32 a213, v17
v_accvgpr_write_b32 a214, v18
v_accvgpr_write_b32 a215, v19
s_waitcnt lgkmcnt(4)
v_perm_b32 v16, v49, v48, s50
v_perm_b32 v17, v51, v50, s50
v_perm_b32 v18, v53, v52, s50
v_perm_b32 v19, v55, v54, s50
v_accvgpr_write_b32 a236, v16
v_accvgpr_write_b32 a237, v17
v_accvgpr_write_b32 a238, v18
v_accvgpr_write_b32 a239, v19
v_perm_b32 v16, v49, v48, s51
v_perm_b32 v17, v51, v50, s51
v_perm_b32 v18, v53, v52, s51
v_perm_b32 v19, v55, v54, s51
v_accvgpr_write_b32 a244, v16
v_accvgpr_write_b32 a245, v17
v_accvgpr_write_b32 a246, v18
v_accvgpr_write_b32 a247, v19
s_waitcnt lgkmcnt(0)
v_perm_b32 v140, v57, v56, s50
v_perm_b32 v141, v59, v58, s50
v_perm_b32 v142, v61, v60, s50
v_perm_b32 v143, v63, v62, s50
v_perm_b32 v148, v57, v56, s51
v_perm_b32 v149, v59, v58, s51
v_perm_b32 v150, v61, v60, s51
v_perm_b32 v151, v63, v62, s51
s_waitcnt vmcnt(28)
s_barrier
ds_read2st64_b32 v[32:33], v22 offset0:64 offset1:68
ds_read2st64_b32 v[34:35], v22 offset0:72 offset1:76
ds_read2st64_b32 v[36:37], v22 offset0:80 offset1:84
ds_read2st64_b32 v[38:39], v22 offset0:88 offset1:92
ds_read2st64_b32 v[40:41], v23 offset0:64 offset1:68
ds_read2st64_b32 v[42:43], v23 offset0:72 offset1:76
ds_read2st64_b32 v[44:45], v23 offset0:80 offset1:84
ds_read2st64_b32 v[46:47], v23 offset0:88 offset1:92
ds_read2st64_b32 v[48:49], v24 offset0:64 offset1:68
ds_read2st64_b32 v[50:51], v24 offset0:72 offset1:76
ds_read2st64_b32 v[52:53], v24 offset0:80 offset1:84
ds_read2st64_b32 v[54:55], v24 offset0:88 offset1:92
ds_read2st64_b32 v[56:57], v25 offset0:64 offset1:68
ds_read2st64_b32 v[58:59], v25 offset0:72 offset1:76
ds_read2st64_b32 v[60:61], v25 offset0:80 offset1:84
ds_read2st64_b32 v[62:63], v25 offset0:88 offset1:92
s_waitcnt lgkmcnt(12)
v_perm_b32 v16, v33, v32, s50
v_perm_b32 v17, v35, v34, s50
v_perm_b32 v18, v37, v36, s50
v_perm_b32 v19, v39, v38, s50
v_accvgpr_write_b32 a24, v16
v_accvgpr_write_b32 a25, v17
v_accvgpr_write_b32 a26, v18
v_accvgpr_write_b32 a27, v19
v_perm_b32 v16, v33, v32, s51
v_perm_b32 v17, v35, v34, s51
v_perm_b32 v18, v37, v36, s51
v_perm_b32 v19, v39, v38, s51
v_accvgpr_write_b32 a32, v16
v_accvgpr_write_b32 a33, v17
v_accvgpr_write_b32 a34, v18
v_accvgpr_write_b32 a35, v19
s_waitcnt lgkmcnt(8)
v_perm_b32 v16, v41, v40, s50
v_perm_b32 v17, v43, v42, s50
v_perm_b32 v18, v45, v44, s50
v_perm_b32 v19, v47, v46, s50
v_accvgpr_write_b32 a216, v16
v_accvgpr_write_b32 a217, v17
v_accvgpr_write_b32 a218, v18
v_accvgpr_write_b32 a219, v19
v_perm_b32 v16, v41, v40, s51
v_perm_b32 v17, v43, v42, s51
v_perm_b32 v18, v45, v44, s51
v_perm_b32 v19, v47, v46, s51
v_accvgpr_write_b32 a224, v16
v_accvgpr_write_b32 a225, v17
v_accvgpr_write_b32 a226, v18
v_accvgpr_write_b32 a227, v19
s_waitcnt lgkmcnt(4)
v_perm_b32 v16, v49, v48, s50
v_perm_b32 v17, v51, v50, s50
v_perm_b32 v18, v53, v52, s50
v_perm_b32 v19, v55, v54, s50
v_accvgpr_write_b32 a248, v16
v_accvgpr_write_b32 a249, v17
v_accvgpr_write_b32 a250, v18
v_accvgpr_write_b32 a251, v19
v_perm_b32 v128, v49, v48, s51
v_perm_b32 v129, v51, v50, s51
v_perm_b32 v130, v53, v52, s51
v_perm_b32 v131, v55, v54, s51
s_waitcnt lgkmcnt(0)
v_perm_b32 v152, v57, v56, s50
v_perm_b32 v153, v59, v58, s50
v_perm_b32 v154, v61, v60, s50
v_perm_b32 v155, v63, v62, s50
v_perm_b32 v160, v57, v56, s51
v_perm_b32 v161, v59, v58, s51
v_perm_b32 v162, v61, v60, s51
v_perm_b32 v163, v63, v62, s51
s_waitcnt vmcnt(20)
s_barrier
ds_read2st64_b32 v[32:33], v22 offset0:96 offset1:100
ds_read2st64_b32 v[34:35], v22 offset0:104 offset1:108
ds_read2st64_b32 v[36:37], v22 offset0:112 offset1:116
ds_read2st64_b32 v[38:39], v22 offset0:120 offset1:124
ds_read2st64_b32 v[40:41], v23 offset0:96 offset1:100
ds_read2st64_b32 v[42:43], v23 offset0:104 offset1:108
ds_read2st64_b32 v[44:45], v23 offset0:112 offset1:116
ds_read2st64_b32 v[46:47], v23 offset0:120 offset1:124
ds_read2st64_b32 v[48:49], v24 offset0:96 offset1:100
ds_read2st64_b32 v[50:51], v24 offset0:104 offset1:108
ds_read2st64_b32 v[52:53], v24 offset0:112 offset1:116
ds_read2st64_b32 v[54:55], v24 offset0:120 offset1:124
ds_read2st64_b32 v[56:57], v25 offset0:96 offset1:100
ds_read2st64_b32 v[58:59], v25 offset0:104 offset1:108
ds_read2st64_b32 v[60:61], v25 offset0:112 offset1:116
ds_read2st64_b32 v[62:63], v25 offset0:120 offset1:124
s_waitcnt lgkmcnt(12)
v_perm_b32 v16, v33, v32, s50
v_perm_b32 v17, v35, v34, s50
v_perm_b32 v18, v37, v36, s50
v_perm_b32 v19, v39, v38, s50
v_accvgpr_write_b32 a28, v16
v_accvgpr_write_b32 a29, v17
v_accvgpr_write_b32 a30, v18
v_accvgpr_write_b32 a31, v19
v_perm_b32 v16, v33, v32, s51
v_perm_b32 v17, v35, v34, s51
v_perm_b32 v18, v37, v36, s51
v_perm_b32 v19, v39, v38, s51
v_accvgpr_write_b32 a36, v16
v_accvgpr_write_b32 a37, v17
v_accvgpr_write_b32 a38, v18
v_accvgpr_write_b32 a39, v19
s_waitcnt lgkmcnt(8)
v_perm_b32 v16, v41, v40, s50
v_perm_b32 v17, v43, v42, s50
v_perm_b32 v18, v45, v44, s50
v_perm_b32 v19, v47, v46, s50
v_accvgpr_write_b32 a220, v16
v_accvgpr_write_b32 a221, v17
v_accvgpr_write_b32 a222, v18
v_accvgpr_write_b32 a223, v19
v_perm_b32 v16, v41, v40, s51
v_perm_b32 v17, v43, v42, s51
v_perm_b32 v18, v45, v44, s51
v_perm_b32 v19, v47, v46, s51
v_accvgpr_write_b32 a228, v16
v_accvgpr_write_b32 a229, v17
v_accvgpr_write_b32 a230, v18
v_accvgpr_write_b32 a231, v19
s_waitcnt lgkmcnt(4)
v_perm_b32 v16, v49, v48, s50
v_perm_b32 v17, v51, v50, s50
v_perm_b32 v18, v53, v52, s50
v_perm_b32 v19, v55, v54, s50
v_accvgpr_write_b32 a252, v16
v_accvgpr_write_b32 a253, v17
v_accvgpr_write_b32 a254, v18
v_accvgpr_write_b32 a255, v19
v_perm_b32 v132, v49, v48, s51
v_perm_b32 v133, v51, v50, s51
v_perm_b32 v134, v53, v52, s51
v_perm_b32 v135, v55, v54, s51
s_waitcnt lgkmcnt(0)
v_perm_b32 v156, v57, v56, s50
v_perm_b32 v157, v59, v58, s50
v_perm_b32 v158, v61, v60, s50
v_perm_b32 v159, v63, v62, s50
v_perm_b32 v164, v57, v56, s51
v_perm_b32 v165, v59, v58, s51
v_perm_b32 v166, v61, v60, s51
v_perm_b32 v167, v63, v62, s51
s_barrier
ds_write_b128 v1, v[168:171] offset:0
ds_write_b128 v1, v[172:175] offset:1024
ds_write_b128 v1, v[176:179] offset:2048
ds_write_b128 v1, v[180:183] offset:3072
ds_write_b128 v1, v[184:187] offset:4096
ds_write_b128 v1, v[188:191] offset:5120
ds_write_b128 v1, v[192:195] offset:6144
ds_write_b128 v1, v[196:199] offset:7168
ds_write_b128 v1, v[200:203] offset:8192
ds_write_b128 v1, v[204:207] offset:9216
ds_write_b128 v1, v[208:211] offset:10240
ds_write_b128 v1, v[212:215] offset:11264
ds_write_b128 v1, v[216:219] offset:12288
ds_write_b128 v1, v[220:223] offset:13312
ds_write_b128 v1, v[224:227] offset:14336
ds_write_b128 v1, v[228:231] offset:15360
ds_write_b128 v1, v[232:235] offset:16384
ds_write_b128 v1, v[236:239] offset:17408
ds_write_b128 v1, v[240:243] offset:18432
ds_write_b128 v1, v[244:247] offset:19456
ds_write_b128 v1, v[248:251] offset:20480
ds_write_b128 v1, v[252:255] offset:21504
s_waitcnt vmcnt(4)
s_waitcnt lgkmcnt(0)
v_perm_b32 v32, v68, v64, s50
v_perm_b32 v33, v76, v72, s50
v_perm_b32 v34, v84, v80, s50
v_perm_b32 v35, v92, v88, s50
v_perm_b32 v36, v100, v96, s50
v_perm_b32 v37, v108, v104, s50
v_perm_b32 v38, v116, v112, s50
v_perm_b32 v39, v124, v120, s50
ds_write_b128 v1, v[32:35] offset:22528
ds_write_b128 v1, v[36:39] offset:23552
v_perm_b32 v40, v68, v64, s51
v_perm_b32 v41, v76, v72, s51
v_perm_b32 v42, v84, v80, s51
v_perm_b32 v43, v92, v88, s51
v_perm_b32 v44, v100, v96, s51
v_perm_b32 v45, v108, v104, s51
v_perm_b32 v46, v116, v112, s51
v_perm_b32 v47, v124, v120, s51
ds_write_b128 v1, v[40:43] offset:24576
ds_write_b128 v1, v[44:47] offset:25600
v_perm_b32 v168, v69, v65, s50
v_perm_b32 v169, v77, v73, s50
v_perm_b32 v170, v85, v81, s50
v_perm_b32 v171, v93, v89, s50
v_perm_b32 v172, v101, v97, s50
v_perm_b32 v173, v109, v105, s50
v_perm_b32 v174, v117, v113, s50
v_perm_b32 v175, v125, v121, s50
v_perm_b32 v176, v69, v65, s51
v_perm_b32 v177, v77, v73, s51
v_perm_b32 v178, v85, v81, s51
v_perm_b32 v179, v93, v89, s51
v_perm_b32 v180, v101, v97, s51
v_perm_b32 v181, v109, v105, s51
v_perm_b32 v182, v117, v113, s51
v_perm_b32 v183, v125, v121, s51
v_perm_b32 v200, v70, v66, s50
v_perm_b32 v201, v78, v74, s50
v_perm_b32 v202, v86, v82, s50
v_perm_b32 v203, v94, v90, s50
v_perm_b32 v204, v102, v98, s50
v_perm_b32 v205, v110, v106, s50
v_perm_b32 v206, v118, v114, s50
v_perm_b32 v207, v126, v122, s50
v_perm_b32 v208, v70, v66, s51
v_perm_b32 v209, v78, v74, s51
v_perm_b32 v210, v86, v82, s51
v_perm_b32 v211, v94, v90, s51
v_perm_b32 v212, v102, v98, s51
v_perm_b32 v213, v110, v106, s51
v_perm_b32 v214, v118, v114, s51
v_perm_b32 v215, v126, v122, s51
v_perm_b32 v232, v71, v67, s50
v_perm_b32 v233, v79, v75, s50
v_perm_b32 v234, v87, v83, s50
v_perm_b32 v235, v95, v91, s50
v_perm_b32 v236, v103, v99, s50
v_perm_b32 v237, v111, v107, s50
v_perm_b32 v238, v119, v115, s50
v_perm_b32 v239, v127, v123, s50
v_perm_b32 v240, v71, v67, s51
v_perm_b32 v241, v79, v75, s51
v_perm_b32 v242, v87, v83, s51
v_perm_b32 v243, v95, v91, s51
v_perm_b32 v244, v103, v99, s51
v_perm_b32 v245, v111, v107, s51
v_perm_b32 v246, v119, v115, s51
v_perm_b32 v247, v127, v123, s51
s_add_u32 s46, s47, 65536
buffer_load_dwordx4 v[64:67], v28, s[12:15], s46 offen
s_add_u32 s46, s47, 66560
buffer_load_dwordx4 v[68:71], v28, s[12:15], s46 offen
s_add_u32 s46, s47, 73728
buffer_load_dwordx4 v[72:75], v28, s[12:15], s46 offen
s_add_u32 s46, s47, 74752
buffer_load_dwordx4 v[76:79], v28, s[12:15], s46 offen
s_add_u32 s46, s47, 67584
buffer_load_dwordx4 v[80:83], v28, s[12:15], s46 offen
s_add_u32 s46, s47, 68608
buffer_load_dwordx4 v[84:87], v28, s[12:15], s46 offen
s_add_u32 s46, s47, 75776
buffer_load_dwordx4 v[88:91], v28, s[12:15], s46 offen
s_add_u32 s46, s47, 76800
buffer_load_dwordx4 v[92:95], v28, s[12:15], s46 offen
s_add_u32 s46, s47, 98304
buffer_load_dwordx4 v[96:99], v28, s[12:15], s46 offen
s_add_u32 s46, s47, 99328
buffer_load_dwordx4 v[100:103], v28, s[12:15], s46 offen
s_add_u32 s46, s47, 106496
buffer_load_dwordx4 v[104:107], v28, s[12:15], s46 offen
s_add_u32 s46, s47, 107520
buffer_load_dwordx4 v[108:111], v28, s[12:15], s46 offen
s_add_u32 s46, s47, 100352
buffer_load_dwordx4 v[112:115], v28, s[12:15], s46 offen
s_add_u32 s46, s47, 101376
buffer_load_dwordx4 v[116:119], v28, s[12:15], s46 offen
s_add_u32 s46, s47, 108544
buffer_load_dwordx4 v[120:123], v28, s[12:15], s46 offen
s_add_u32 s46, s47, 109568
buffer_load_dwordx4 v[124:127], v28, s[12:15], s46 offen
s_waitcnt vmcnt(0)
s_waitcnt lgkmcnt(0)
v_perm_b32 v32, v68, v64, s50
v_perm_b32 v33, v76, v72, s50
v_perm_b32 v34, v84, v80, s50
v_perm_b32 v35, v92, v88, s50
v_perm_b32 v36, v100, v96, s50
v_perm_b32 v37, v108, v104, s50
v_perm_b32 v38, v116, v112, s50
v_perm_b32 v39, v124, v120, s50
ds_write_b128 v1, v[32:35] offset:26624
ds_write_b128 v1, v[36:39] offset:27648
v_perm_b32 v40, v68, v64, s51
v_perm_b32 v41, v76, v72, s51
v_perm_b32 v42, v84, v80, s51
v_perm_b32 v43, v92, v88, s51
v_perm_b32 v44, v100, v96, s51
v_perm_b32 v45, v108, v104, s51
v_perm_b32 v46, v116, v112, s51
v_perm_b32 v47, v124, v120, s51
ds_write_b128 v1, v[40:43] offset:28672
ds_write_b128 v1, v[44:47] offset:29696
v_perm_b32 v184, v69, v65, s50
v_perm_b32 v185, v77, v73, s50
v_perm_b32 v186, v85, v81, s50
v_perm_b32 v187, v93, v89, s50
v_perm_b32 v188, v101, v97, s50
v_perm_b32 v189, v109, v105, s50
v_perm_b32 v190, v117, v113, s50
v_perm_b32 v191, v125, v121, s50
v_perm_b32 v192, v69, v65, s51
v_perm_b32 v193, v77, v73, s51
v_perm_b32 v194, v85, v81, s51
v_perm_b32 v195, v93, v89, s51
v_perm_b32 v196, v101, v97, s51
v_perm_b32 v197, v109, v105, s51
v_perm_b32 v198, v117, v113, s51
v_perm_b32 v199, v125, v121, s51
v_perm_b32 v216, v70, v66, s50
v_perm_b32 v217, v78, v74, s50
v_perm_b32 v218, v86, v82, s50
v_perm_b32 v219, v94, v90, s50
v_perm_b32 v220, v102, v98, s50
v_perm_b32 v221, v110, v106, s50
v_perm_b32 v222, v118, v114, s50
v_perm_b32 v223, v126, v122, s50
v_perm_b32 v224, v70, v66, s51
v_perm_b32 v225, v78, v74, s51
v_perm_b32 v226, v86, v82, s51
v_perm_b32 v227, v94, v90, s51
v_perm_b32 v228, v102, v98, s51
v_perm_b32 v229, v110, v106, s51
v_perm_b32 v230, v118, v114, s51
v_perm_b32 v231, v126, v122, s51
v_perm_b32 v248, v71, v67, s50
v_perm_b32 v249, v79, v75, s50
v_perm_b32 v250, v87, v83, s50
v_perm_b32 v251, v95, v91, s50
v_perm_b32 v252, v103, v99, s50
v_perm_b32 v253, v111, v107, s50
v_perm_b32 v254, v119, v115, s50
v_perm_b32 v255, v127, v123, s50
v_perm_b32 v40, v71, v67, s51
v_perm_b32 v41, v79, v75, s51
v_perm_b32 v42, v87, v83, s51
v_perm_b32 v43, v95, v91, s51
v_perm_b32 v44, v103, v99, s51
v_perm_b32 v45, v111, v107, s51
v_perm_b32 v46, v119, v115, s51
v_perm_b32 v47, v127, v123, s51
ds_write_b128 v1, v[40:43] offset:30720
ds_write_b128 v1, v[44:47] offset:31744
s_waitcnt vmcnt(0)
s_waitcnt lgkmcnt(0)
s_cmp_lg_u32 s18, 0
s_cbranch_scc1 L_t_arm_ok
v_mov_b32 v34, 0
L_t_arm:
global_load_dwordx2 v[32:33], v34, s[4:5] sc1
s_waitcnt vmcnt(0)
v_cmp_gt_u32 vcc, 32, v32
s_cbranch_vccnz L_t_arm_re
v_cmp_gt_u32 vcc, 144, v33
s_cbranch_vccnz L_t_arm_re
L_t_arm_ok:
s_barrier
s_sub_u32 s32, s31, 28672
s_mov_b32 s20, 0
L_t_f0:
s_lshl_b32 s46, s20, 2
s_add_u32 s46, s46, s33
s_sub_u32 s46, s46, s32
s_add_u32 s46, s46, 0
v_mov_b32 v88, v14
s_mov_b32 exec_lo, 0
v_lshrrev_b32 v88, 2, v0
v_add_u32 v88, s46, v88
buffer_load_dword v15, v88, s[8:11], s32 offen sc1
s_mov_b32 exec_lo, -1
s_waitcnt vmcnt(0)
v_cmp_eq_u32 s[62:63], s37, v15
s_nop 4
s_bitcmp1_b32 s63, 0
s_cbranch_scc0 L_t_f0_re
L_t_f0_ok:
s_lshr_b64 s[62:63], s[62:63], 33
s_bitset1_b64 s[62:63], 63
s_andn2_b64 s[64:65], s[62:63], s[60:61]
s_mov_b32 s66, 0
s_add_u32 s32, s31, 28672
buffer_load_dword v15, v14, s[8:11], s31 offen sc1
s_mov_b32 s20, 0
v_mov_b64 v[92:93], 0
v_mov_b64 v[94:95], 0
v_mov_b64 v[48:49], 0
v_mov_b64 v[50:51], 0
v_mov_b64 v[52:53], 0
v_mov_b64 v[54:55], 0
v_mov_b64 v[56:57], 0
v_mov_b64 v[58:59], 0
v_mov_b64 v[60:61], 0
v_mov_b64 v[62:63], 0
v_mov_b64 v[64:65], 0
v_mov_b64 v[66:67], 0
v_mov_b64 v[68:69], 0
v_mov_b64 v[70:71], 0
v_mov_b64 v[80:81], -1
ds_read_b128 v[24:27], v1 offset:0
ds_read_b128 v[28:31], v1 offset:1024
ds_read_b128 v[32:35], v1 offset:2048
ds_read_b128 v[36:39], v1 offset:3072
ds_read_b128 v[40:43], v1 offset:4096
ds_read_b128 v[44:47], v1 offset:5120
ds_read_b128 v[96:99], v1 offset:6144
ds_read_b128 v[100:103], v1 offset:7168
ds_read_b128 v[104:107], v1 offset:8192
ds_read_b128 v[108:111], v1 offset:9216
ds_read_b128 v[112:115], v1 offset:10240
ds_read_b128 v[116:119], v1 offset:11264
ds_read_b128 v[120:123], v1 offset:12288
ds_read_b128 v[124:127], v1 offset:13312
.p2align 6
L_t_pre:
buffer_load_dwordx4 v[16:19], v0, s[8:11], s21 offen offset:0 sc1
buffer_load_dwordx4 v[20:23], v0, s[8:11], s21 offen offset:1024 sc1
L_t_ring:
s_waitcnt vmcnt(1)
s_waitcnt lgkmcnt(0)
ds_write_b128 v2, v[16:19] offset:0
v_smfmac_f32_16x16x64_bf16 v[48:51], v[16:19], v[24:31], v6
v_max3_u32 v88, v16, v17, v18
v_max_u32 v88, v88, v19
s_waitcnt vmcnt(0)
ds_write_b128 v2, v[20:23] offset:1024
v_smfmac_f32_16x16x64_bf16 v[52:55], v[16:19], v[32:39], v6
v_max3_u32 v88, v88, v20, v21
v_max3_u32 v88, v88, v22, v23
v_cmp_eq_u32 vcc, -1, v88
s_cbranch_vccnz L_t_ring_re
L_t_ring_ok:
buffer_store_dword v80, v12, s[8:11], s22 offen
buffer_load_dwordx4 v[72:75], v13, s[8:11], s29 offen sc1
buffer_load_dwordx4 v[76:79], v13, s[8:11], s30 offen sc1
v_smfmac_f32_16x16x64_bf16 v[48:51], v[20:23], v[40:47], v6
buffer_load_dwordx4 v[80:83], v0, s[8:11], s31 offen offset:2048 sc1
buffer_load_dwordx4 v[84:87], v0, s[8:11], s31 offen offset:3072 sc1
v_smfmac_f32_16x16x64_bf16 v[52:55], v[20:23], v[96:103], v6
s_waitcnt lgkmcnt(0)
s_barrier
ds_read_b128 v[24:27], v3 offset:0
ds_read_b128 v[28:31], v3 offset:1024
L_t_fl:
s_bitcmp1_b64 s[64:65], s20
s_cbranch_scc0 L_t_fl_re
L_t_fl_ok:
buffer_load_dword v15, v14, s[8:11], s32 offen sc1
L_t_fl_ok2:
v_smfmac_f32_16x16x64_bf16 v[56:59], v[16:19], v[104:111], v6
ds_read_b128 v[32:35], v4 offset:0
ds_read_b128 v[36:39], v4 offset:1024
v_smfmac_f32_16x16x64_bf16 v[60:63], v[16:19], v[112:119], v6
ds_read_b128 v[40:43], v5 offset:0
ds_read_b128 v[44:47], v5 offset:1024
v_smfmac_f32_16x16x64_bf16 v[56:59], v[20:23], v[120:127], v6
buffer_store_dwordx4 v[92:95], v0, s[8:11], s35 offen sc1
s_add_u32 s35, s35, 28672
v_smfmac_f32_16x16x64_bf16 v[60:63], v[20:23], a[0:7], v6
ds_read_b128 v[96:99], v1 offset:14336
v_smfmac_f32_16x16x64_bf16 v[64:67], v[16:19], a[8:15], v6
ds_read_b128 v[100:103], v1 offset:15360
v_smfmac_f32_16x16x64_bf16 v[68:71], v[16:19], a[16:23], v6
ds_read_b128 v[104:107], v1 offset:16384
s_add_u32 s32, s32, 28672
s_xor_b32 s21, s21, 8192
v_smfmac_f32_16x16x64_bf16 v[64:67], v[20:23], a[24:31], v6
ds_read_b128 v[108:111], v1 offset:17408
s_add_u32 s29, s29, 28672
s_add_u32 s30, s30, 28672
v_smfmac_f32_16x16x64_bf16 v[68:71], v[20:23], a[32:39], v6
ds_read_b128 v[112:115], v1 offset:18432
s_add_u32 s31, s31, 28672
s_waitcnt lgkmcnt(10)
v_smfmac_f32_16x16x64_bf16 v[48:51], v[24:27], a[40:47], v6
ds_read_b128 v[116:119], v1 offset:19456
v_smfmac_f32_16x16x64_bf16 v[52:55], v[24:27], a[48:55], v6
ds_read_b128 v[120:123], v1 offset:20480
s_waitcnt lgkmcnt(11)
v_smfmac_f32_16x16x64_bf16 v[48:51], v[28:31], a[56:63], v6
ds_read_b128 v[124:127], v1 offset:21504
v_smfmac_f32_16x16x64_bf16 v[52:55], v[28:31], a[64:71], v6
s_waitcnt lgkmcnt(11)
v_smfmac_f32_16x16x64_bf16 v[48:51], v[32:35], a[72:79], v6
v_smfmac_f32_16x16x64_bf16 v[52:55], v[32:35], a[80:87], v6
s_waitcnt lgkmcnt(10)
v_smfmac_f32_16x16x64_bf16 v[48:51], v[36:39], a[88:95], v6
v_smfmac_f32_16x16x64_bf16 v[52:55], v[36:39], a[96:103], v6
s_waitcnt lgkmcnt(6)
v_smfmac_f32_16x16x64_bf16 v[48:51], v[40:43], v[96:103], v6
s_waitcnt lgkmcnt(4)
v_smfmac_f32_16x16x64_bf16 v[52:55], v[40:43], v[104:111], v6
s_waitcnt lgkmcnt(2)
v_smfmac_f32_16x16x64_bf16 v[48:51], v[44:47], v[112:119], v6
s_waitcnt lgkmcnt(0)
v_smfmac_f32_16x16x64_bf16 v[52:55], v[44:47], v[120:127], v6
v_smfmac_f32_16x16x64_bf16 v[56:59], v[24:27], a[104:111], v6
ds_read_b128 v[96:99], v1 offset:22528
v_smfmac_f32_16x16x64_bf16 v[60:63], v[24:27], a[112:119], v6
v_add_f32 v48, v48, v50
v_add_f32 v49, v49, v51
s_nop 0
v_add_f32 v52, v52, v54
v_smfmac_f32_16x16x64_bf16 v[56:59], v[28:31], a[120:127], v6
v_add_f32 v53, v53, v55
v_cvt_pk_bf16_f32 v50, v48, v52
v_cvt_pk_bf16_f32 v51, v49, v53
ds_write2_b32 v7, v50, v51 offset0:0 offset1:4
v_smfmac_f32_16x16x64_bf16 v[60:63], v[28:31], a[128:135], v6
ds_read_b128 v[100:103], v1 offset:23552
v_smfmac_f32_16x16x64_bf16 v[56:59], v[32:35], a[136:143], v6
ds_read_b128 v[104:107], v1 offset:24576
v_smfmac_f32_16x16x64_bf16 v[60:63], v[32:35], a[144:151], v6
v_smfmac_f32_16x16x64_bf16 v[56:59], v[36:39], a[152:159], v6
s_waitcnt lgkmcnt(2)
s_barrier
ds_read_b128 v[48:51], v0 offset:8192
ds_read_b128 v[52:55], v0 offset:9216
v_smfmac_f32_16x16x64_bf16 v[60:63], v[36:39], a[160:167], v6
ds_read_b128 v[108:111], v1 offset:25600
v_smfmac_f32_16x16x64_bf16 v[56:59], v[40:43], a[168:175], v6
ds_read_b128 v[112:115], v1 offset:26624
v_smfmac_f32_16x16x64_bf16 v[60:63], v[40:43], a[176:183], v6
ds_read_b128 v[116:119], v1 offset:27648
v_smfmac_f32_16x16x64_bf16 v[56:59], v[44:47], a[184:191], v6
ds_read_b128 v[120:123], v1 offset:28672
v_smfmac_f32_16x16x64_bf16 v[60:63], v[44:47], a[192:199], v6
ds_read_b128 v[124:127], v1 offset:29696
s_waitcnt vmcnt(4)
s_waitcnt lgkmcnt(6)
v_mfma_f32_16x16x32_bf16 v[88:91], v[72:75], v[48:51], 0
s_waitcnt lgkmcnt(5)
v_mfma_f32_16x16x32_bf16 v[88:91], v[76:79], v[52:55], v[88:91]
v_add_f32 v56, v56, v58
v_add_f32 v57, v57, v59
v_add_f32 v60, v60, v62
v_add_f32 v61, v61, v63
v_cvt_pk_bf16_f32 v92, v56, v60
v_cvt_pk_bf16_f32 v93, v57, v61
ds_write2_b32 v8, v92, v93 offset0:0 offset1:4
s_nop 0
v_add_f32_dpp v88, v90, v88 row_ror:8 row_mask:0xf bank_mask:0x3
s_nop 1
v_add_f32_dpp v88, v89, v91 row_ror:8 row_mask:0xf bank_mask:0xc
v_cvt_pk_bf16_f32 v88, 0, v88
v_mul_f32 v88, s52, v88
v_cvt_pk_bf16_f32 v88, 0, v88
ds_write_b32 v9, v88 offset:12288
v_smfmac_f32_16x16x64_bf16 v[64:67], v[24:27], a[200:207], v6
v_smfmac_f32_16x16x64_bf16 v[68:71], v[24:27], a[208:215], v6
s_waitcnt lgkmcnt(1)
s_barrier
ds_read_b128 v[56:59], v0 offset:10240
ds_read_b128 v[60:63], v0 offset:11264
v_smfmac_f32_16x16x64_bf16 v[64:67], v[28:31], a[216:223], v6
s_waitcnt lgkmcnt(2)
s_barrier
ds_read_b128 v[76:79], v0 offset:12288
v_mov_b32 v89, 0
v_mov_b32 v90, 0
v_smfmac_f32_16x16x64_bf16 v[68:71], v[28:31], a[224:231], v6
v_smfmac_f32_16x16x64_bf16 v[64:67], v[32:35], a[232:239], v6
v_smfmac_f32_16x16x64_bf16 v[68:71], v[32:35], a[240:247], v6
s_waitcnt lgkmcnt(2)
v_mfma_f32_16x16x32_bf16 v[72:75], v[56:59], v[48:51], 0
s_waitcnt lgkmcnt(1)
v_mfma_f32_16x16x32_bf16 v[72:75], v[60:63], v[52:55], v[72:75]
v_smfmac_f32_16x16x64_bf16 v[64:67], v[36:39], a[248:255], v6
s_waitcnt lgkmcnt(0)
v_max3_f32 v56, v76, v77, v78
v_smfmac_f32_16x16x64_bf16 v[68:71], v[36:39], v[128:135], v6
s_nop 3
v_add_f32_dpp v72, v74, v72 row_ror:8 row_mask:0xf bank_mask:0x3
s_nop 1
v_add_f32_dpp v72, v73, v75 row_ror:8 row_mask:0xf bank_mask:0xc
v_cvt_pk_bf16_f32 v72, 0, v72
v_mul_f32 v72, s52, v72
v_cvt_pk_bf16_f32 v72, 0, v72
v_max3_f32 v56, v56, v79, v72
v_smfmac_f32_16x16x64_bf16 v[64:67], v[40:43], v[136:143], v6
v_max_f32_dpp v56, v56, v56 row_ror:8 row_mask:0xf bank_mask:0xf
v_mov_b32 v74, v56
v_smfmac_f32_16x16x64_bf16 v[68:71], v[40:43], v[144:151], v6
v_permlane16_swap_b32 v74, v56
v_max_f32 v56, v56, v74
v_mov_b32 v74, v56
v_smfmac_f32_16x16x64_bf16 v[64:67], v[44:47], v[152:159], v6
v_permlane32_swap_b32 v74, v56
v_max_f32 v56, v56, v74
v_mul_f32 v56, s53, v56
v_smfmac_f32_16x16x64_bf16 v[68:71], v[44:47], v[160:167], v6
v_fma_f32 v76, v76, s53, -v56
v_fma_f32 v77, v77, s53, -v56
v_fma_f32 v78, v78, s53, -v56
v_fma_f32 v79, v79, s53, -v56
v_fma_f32 v72, v72, s53, -v56
v_exp_f32 v76, v76
v_exp_f32 v77, v77
v_exp_f32 v78, v78
v_exp_f32 v79, v79
v_exp_f32 v72, v72
v_cvt_pk_bf16_f32 v52, v76, v77
v_cvt_pk_bf16_f32 v53, v78, v79
v_mov_b32_dpp v74, v72 row_ror:8 row_mask:0xf bank_mask:0xf
v_mov_b32_dpp v54, v52 row_ror:8 row_mask:0xf bank_mask:0xf
v_mov_b32_dpp v55, v53 row_ror:8 row_mask:0xf bank_mask:0xf
v_add_f32 v64, v64, v66
v_add_f32 v65, v65, v67
s_waitcnt vmcnt(2)
v_mfma_f32_16x16x32_bf16 v[56:59], v[80:83], v[52:55], 0
v_add_f32 v68, v68, v70
v_add_f32 v69, v69, v71
v_cvt_pk_bf16_f32 v94, v64, v65
v_mfma_f32_16x16x32_bf16 v[60:63], v[84:87], v[52:55], 0
v_cvt_pk_bf16_f32 v95, v68, v69
v_cvt_pk_bf16_f32 v88, v72, v74
v_cvt_pk_bf16_f32 v91, v72, v74
s_cmp_eq_u32 s20, 63
s_cbranch_scc1 L_t_tail
v_add_f32 v75, v76, v77
v_mfma_f32_16x16x16_bf16 v[56:59], v[94:95], v[88:89], v[56:59]
v_add_f32 v78, v78, v79
v_add_f32 v75, v75, v72
v_mfma_f32_16x16x16_bf16 v[60:63], v[94:95], v[90:91], v[60:63]
v_add_f32 v75, v75, v78
v_mov_b64 v[16:17], 0
v_mov_b64 v[18:19], 0
v_add_f32_dpp v75, v75, v75 row_ror:8 row_mask:0xf bank_mask:0xf
v_mov_b32 v74, v75
v_mov_b64 v[20:21], 0
v_mov_b64 v[22:23], 0
v_permlane16_swap_b32 v74, v75
v_add_f32 v75, v75, v74
v_mov_b32 v74, v75
v_mov_b64 v[24:25], 0
v_mov_b64 v[26:27], 0
v_permlane32_swap_b32 v74, v75
v_add_f32 v75, v75, v74
v_rcp_f32 v74, v75
v_mov_b64 v[28:29], 0
v_pk_mul_f32 v[56:57], v[56:57], v[74:75] op_sel_hi:[1,0]
v_pk_mul_f32 v[58:59], v[58:59], v[74:75] op_sel_hi:[1,0]
v_pk_mul_f32 v[60:61], v[60:61], v[74:75] op_sel_hi:[1,0]
v_pk_mul_f32 v[62:63], v[62:63], v[74:75] op_sel_hi:[1,0]
v_cvt_pk_bf16_f32 v48, v56, v60
v_cvt_pk_bf16_f32 v49, v57, v61
v_cvt_pk_bf16_f32 v50, v58, v62
v_cvt_pk_bf16_f32 v51, v59, v63
ds_write_b128 v10, v[48:51] offset:13312
v_mov_b64 v[72:73], -1
v_mov_b64 v[74:75], -1
v_mov_b64 v[30:31], 0
v_mov_b64 v[32:33], 0
v_mov_b64 v[34:35], 0
v_mov_b64 v[36:37], 0
s_waitcnt lgkmcnt(0)
s_barrier
ds_read_b128 v[56:59], v0 offset:13312
ds_read_b128 v[60:63], v0 offset:14336
ds_read_b128 v[80:83], v1 offset:30720
ds_read_b128 v[84:87], v1 offset:31744
ds_read_b128 v[64:67], v0 offset:17408
v_mov_b64 v[38:39], 0
v_mov_b64 v[40:41], 0
v_mov_b64 v[42:43], 0
v_mov_b64 v[44:45], 0
v_mov_b64 v[46:47], 0
s_xor_b32 s46, s26, 262144
buffer_store_dwordx4 v[72:75], v0, s[8:11], s46 offen offset:0
buffer_store_dwordx4 v[72:75], v0, s[8:11], s46 offen offset:1024
s_add_u32 s20, s20, 1
s_waitcnt lgkmcnt(4)
v_smfmac_f32_16x16x64_bf16 v[16:19], v[56:59], v[96:103], v6
v_smfmac_f32_16x16x64_bf16 v[20:23], v[56:59], v[104:111], v6
s_waitcnt lgkmcnt(3)
v_smfmac_f32_16x16x64_bf16 v[16:19], v[60:63], v[112:119], v6
v_smfmac_f32_16x16x64_bf16 v[20:23], v[60:63], v[120:127], v6
v_smfmac_f32_16x16x64_bf16 v[24:27], v[56:59], v[168:175], v6
v_smfmac_f32_16x16x64_bf16 v[28:31], v[56:59], v[176:183], v6
v_add_f32 v16, v16, v18
v_smfmac_f32_16x16x64_bf16 v[24:27], v[60:63], v[184:191], v6
v_add_f32 v17, v17, v19
v_cvt_pk_bf16_f32 v48, v16, v17
v_smfmac_f32_16x16x64_bf16 v[28:31], v[60:63], v[192:199], v6
v_add_f32 v20, v20, v22
v_smfmac_f32_16x16x64_bf16 v[32:35], v[56:59], v[200:207], v6
v_add_f32 v21, v21, v23
v_cvt_pk_bf16_f32 v49, v20, v21
v_smfmac_f32_16x16x64_bf16 v[36:39], v[56:59], v[208:215], v6
v_add_f32 v24, v24, v26
v_smfmac_f32_16x16x64_bf16 v[32:35], v[60:63], v[216:223], v6
v_add_f32 v25, v25, v27
v_cvt_pk_bf16_f32 v50, v24, v25
v_smfmac_f32_16x16x64_bf16 v[36:39], v[60:63], v[224:231], v6
v_add_f32 v28, v28, v30
v_smfmac_f32_16x16x64_bf16 v[40:43], v[56:59], v[232:239], v6
v_add_f32 v29, v29, v31
v_cvt_pk_bf16_f32 v51, v28, v29
buffer_store_dwordx4 v[48:51], v11, s[8:11], s24 offen
v_smfmac_f32_16x16x64_bf16 v[44:47], v[56:59], v[240:247], v6
v_add_f32 v32, v32, v34
v_add_f32 v33, v33, v35
v_smfmac_f32_16x16x64_bf16 v[40:43], v[60:63], v[248:255], v6
v_cvt_pk_bf16_f32 v52, v32, v33
v_add_f32 v36, v36, v38
s_waitcnt lgkmcnt(1)
v_smfmac_f32_16x16x64_bf16 v[44:47], v[60:63], v[80:87], v6
v_add_f32 v37, v37, v39
v_cvt_pk_bf16_f32 v53, v36, v37
v_add_f32 v40, v40, v42
v_add_f32 v41, v41, v43
v_cvt_pk_bf16_f32 v54, v40, v41
s_nop 2
v_add_f32 v44, v44, v46
v_add_f32 v45, v45, v47
v_cvt_pk_bf16_f32 v55, v44, v45
buffer_store_dwordx4 v[52:55], v11, s[8:11], s25 offen
s_xor_b32 s24, s24, 262144
s_xor_b32 s25, s25, 262144
ds_read_b128 v[96:99], v1 offset:6144
v_mov_b64 v[62:63], 0
ds_read_b128 v[100:103], v1 offset:7168
v_mov_b64 v[60:61], 0
ds_read_b128 v[104:107], v1 offset:8192
v_mov_b64 v[58:59], 0
ds_read_b128 v[108:111], v1 offset:9216
v_mov_b64 v[56:57], 0
ds_read_b128 v[112:115], v1 offset:10240
v_mov_b64 v[54:55], 0
ds_read_b128 v[116:119], v1 offset:11264
v_mov_b64 v[52:53], 0
ds_read_b128 v[120:123], v1 offset:12288
v_mov_b64 v[50:51], 0
ds_read_b128 v[124:127], v1 offset:13312
v_mov_b64 v[48:49], 0
ds_read_b128 v[24:27], v1 offset:0
v_mov_b64 v[80:81], -1
ds_read_b128 v[28:31], v1 offset:1024
ds_read_b128 v[32:35], v1 offset:2048
ds_read_b128 v[36:39], v1 offset:3072
ds_read_b128 v[40:43], v1 offset:4096
ds_read_b128 v[44:47], v1 offset:5120
s_nop 7
s_nop 7
s_nop 7
s_nop 6
s_waitcnt lgkmcnt(14)
buffer_load_dwordx4 v[72:75], v0, s[8:11], s26 offen offset:0 sc1
buffer_load_dwordx4 v[76:79], v0, s[8:11], s26 offen offset:1024 sc1
s_nop 7
s_nop 7
s_nop 7
buffer_load_dwordx4 v[72:75], v0, s[8:11], s26 offen offset:0 sc1
buffer_load_dwordx4 v[76:79], v0, s[8:11], s26 offen offset:1024 sc1
L_t_in:
s_waitcnt vmcnt(3)
v_max3_u32 v68, v72, v73, v74
v_max_u32 v68, v68, v75
v_mfma_f32_16x16x32_bf16 v[88:91], v[64:67], v[72:75], 0
s_waitcnt vmcnt(2)
v_max3_u32 v68, v68, v76, v77
v_max3_u32 v68, v68, v78, v79
v_mfma_f32_16x16x32_bf16 v[88:91], v[64:67], v[76:79], v[88:91]
v_cmp_eq_u32 vcc, -1, v68
s_cbranch_vccnz L_t_in_re
L_t_in_ok:
s_nop 5
v_add_f32_dpp v88, v88, v88 row_ror:8 row_mask:0xf bank_mask:0xf
v_add_f32_dpp v89, v89, v89 row_ror:8 row_mask:0xf bank_mask:0xf
s_nop 0
v_add_f32_dpp v88, v88, v88 row_ror:4 row_mask:0xf bank_mask:0xf
v_add_f32_dpp v89, v89, v89 row_ror:4 row_mask:0xf bank_mask:0xf
v_cvt_pk_bf16_f32 v90, v88, v89
buffer_store_dword v90, v12, s[8:11], s22 offen
s_xor_b32 s22, s22, 8192
s_xor_b32 s23, s23, 8192
s_xor_b32 s26, s26, 262144
v_mov_b64 v[64:65], 0
v_mov_b64 v[66:67], 0
v_mov_b64 v[68:69], 0
v_mov_b64 v[70:71], 0
s_nop 7
s_nop 7
s_nop 7
s_nop 7
s_nop 7
s_nop 7
s_nop 7
s_nop 5
s_branch L_t_pre
L_t_tail:
buffer_store_dwordx4 v[92:95], v0, s[8:11], s35 offen sc1
s_waitcnt vmcnt(0) lgkmcnt(0)
s_endpgm
L_t_arm_re:
s_nop 15
s_nop 15
s_nop 15
s_nop 15
s_sub_u32 s36, s36, 1
s_cbranch_scc0 L_t_arm
s_mov_b32 s36, 0
s_branch L_t_arm_ok
L_t_f0_re:
s_sub_u32 s36, s36, 1
s_cbranch_scc0 L_t_f0
s_mov_b32 s36, 0
s_branch L_t_f0_ok
L_t_ring_re:
buffer_load_dwordx4 v[16:19], v0, s[8:11], s21 offen offset:0 sc1
buffer_load_dwordx4 v[20:23], v0, s[8:11], s21 offen offset:1024 sc1
s_nop 7
s_nop 7
v_mov_b64 v[48:49], 0
v_mov_b64 v[50:51], 0
v_mov_b64 v[52:53], 0
v_mov_b64 v[54:55], 0
L_t_ring_re2:
s_sub_u32 s36, s36, 1
s_cbranch_scc0 L_t_ring
s_mov_b32 s36, 0
s_branch L_t_ring_ok
L_t_fl_re:
s_cmp_eq_u32 s66, 0
s_cbranch_scc1 L_t_fl_np
L_t_fl_c:
v_cmp_eq_u32 s[62:63], s37, v15
s_nop 4
s_lshr_b64 s[62:63], s[62:63], 32
s_lshl_b64 s[62:63], s[62:63], s20
s_bitset1_b64 s[62:63], 63
s_andn2_b64 s[64:65], s[62:63], s[60:61]
s_mov_b32 s66, 0
L_t_fl_np:
s_bitcmp1_b64 s[62:63], s20
s_cbranch_scc0 L_t_fl_sync
s_bitcmp1_b64 s[60:61], s20
s_cbranch_scc0 L_t_fl_ok
s_lshl_b32 s46, s20, 2
s_add_u32 s46, s46, s33
s_sub_u32 s46, s46, s32
s_add_u32 s46, s46, 8
v_mov_b32 v88, v14
s_mov_b32 exec_lo, 0
v_lshrrev_b32 v88, 2, v0
v_add_u32 v88, s46, v88
s_mov_b32 exec_lo, -1
buffer_load_dword v15, v88, s[8:11], s32 offen sc1
s_mov_b32 exec_lo, -1
s_mov_b32 s66, 1
s_add_u32 s46, s20, 1
s_bitset0_b64 s[64:65], s46
s_branch L_t_fl_ok2
L_t_fl_sync:
s_lshl_b32 s46, s20, 2
s_add_u32 s46, s46, s33
s_sub_u32 s46, s46, s32
s_add_u32 s46, s46, 4
v_mov_b32 v88, v14
s_mov_b32 exec_lo, 0
v_lshrrev_b32 v88, 2, v0
v_add_u32 v88, s46, v88
buffer_load_dword v15, v88, s[8:11], s32 offen sc1
s_mov_b32 exec_lo, -1
s_waitcnt vmcnt(0)
L_t_fl_re2:
s_sub_u32 s36, s36, 1
s_cbranch_scc0 L_t_fl_c
s_mov_b32 s36, 0
s_branch L_t_fl_ok
L_t_in_re:
buffer_load_dwordx4 v[72:75], v0, s[8:11], s26 offen offset:0 sc1
buffer_load_dwordx4 v[76:79], v0, s[8:11], s26 offen offset:1024 sc1
L_t_in_re2:
s_sub_u32 s36, s36, 1
s_cbranch_scc0 L_t_in
s_mov_b32 s36, 0
s_branch L_t_in_ok
L_head:
v_and_b32 v4, 63, v0
v_lshrrev_b32 v2, 4, v4
v_and_b32 v3, 15, v4
v_lshlrev_b32 v1, 4, v4
s_sub_u32 s20, s16, 1
s_lshl_b32 s20, s20, 3
s_and_b32 s46, s17, 7
s_add_u32 s20, s20, s46
s_lshr_b32 s21, s17, 3
s_lshl_b32 s29, s20, 8
s_lshl_b32 s46, s18, 6
s_add_u32 s29, s29, s46
v_lshlrev_b32 v5, 16, v2
v_lshl_add_u32 v5, v3, 2, v5
s_lshl_b32 s22, s21, 15
s_add_u32 s22, s22, 13631488
s_lshl_b32 s46, s21, 5
s_add_u32 s46, s46, s20
s_lshl_b32 s46, s46, 2
s_add_u32 s46, s46, s18
s_lshl_b32 s27, s46, 6
s_add_u32 s27, s27, 131072
s_mul_i32 s46, s20, 2101248
s_mul_i32 s47, s21, 28672
s_add_u32 s46, s46, s47
s_add_u32 s46, s46, 16805888
s_lshl_b32 s23, s18, 11
s_add_u32 s23, s23, s46
s_add_u32 s23, s23, 20480
s_lshl_b32 s24, s18, 12
s_add_u32 s24, s24, s46
s_lshl_b32 s25, s18, 10
s_add_u32 s25, s25, s46
s_add_u32 s25, s25, 16384
s_lshl_b32 s26, s20, 6
s_add_u32 s26, s26, s21
s_lshl_b32 s26, s26, 2
s_add_u32 s26, s26, s18
s_add_u32 s26, s26, 99614720
v_lshrrev_b32 v126, 2, v4
v_lshlrev_b32 v126, 13, v126
v_and_b32 v127, 3, v4
v_lshl_add_u32 v126, v127, 6, v126
s_lshl_b32 s47, s21, 2
s_add_u32 s47, s47, s18
s_lshl_b32 s47, s47, 18
s_lshl_b32 s48, s20, 8
s_add_u32 s47, s47, s48
s_add_u32 s48, s47, 131072
s_load_dwordx2 s[12:13], s[0:1], 16
s_mov_b32 s14, 4194304
s_mov_b32 s15, 0x00020000
s_waitcnt lgkmcnt(0)
buffer_load_dword v127, v126, s[12:15], s47 offen
buffer_load_dword v127, v126, s[12:15], s48 offen
s_load_dwordx2 s[12:13], s[0:1], 24
s_mov_b32 s14, 4194304
s_mov_b32 s15, 0x00020000
s_waitcnt lgkmcnt(0)
buffer_load_dword v127, v126, s[12:15], s47 offen
buffer_load_dword v127, v126, s[12:15], s48 offen
s_load_dwordx2 s[12:13], s[0:1], 32
s_mov_b32 s14, 4194304
s_mov_b32 s15, 0x00020000
s_waitcnt lgkmcnt(0)
buffer_load_dword v127, v126, s[12:15], s47 offen
buffer_load_dword v127, v126, s[12:15], s48 offen
v_bfe_u32 v124, v4, 2, 2
v_lshlrev_b32 v124, 16, v124
v_lshl_add_u32 v124, v2, 13, v124
v_and_b32 v125, 3, v4
v_lshl_add_u32 v124, v125, 4, v124
s_mul_i32 s28, s18, 32768
v_lshlrev_b32 v125, 2, v4
v_add_u32 v125, s28, v125
s_load_dwordx2 s[12:13], s[0:1], 16
s_mov_b32 s14, 4194304
s_mov_b32 s15, 0x00020000
s_waitcnt lgkmcnt(0)
s_add_u32 m0, s28, 0
s_add_u32 s46, s29, 0
buffer_load_dwordx4 v124, s[12:15], s46 offen lds
s_add_u32 m0, s28, 1024
s_add_u32 s46, s29, 32768
buffer_load_dwordx4 v124, s[12:15], s46 offen lds
s_add_u32 m0, s28, 2048
s_add_u32 s46, s29, 262144
buffer_load_dwordx4 v124, s[12:15], s46 offen lds
s_add_u32 m0, s28, 3072
s_add_u32 s46, s29, 294912
buffer_load_dwordx4 v124, s[12:15], s46 offen lds
s_add_u32 m0, s28, 4096
s_add_u32 s46, s29, 524288
buffer_load_dwordx4 v124, s[12:15], s46 offen lds
s_add_u32 m0, s28, 5120
s_add_u32 s46, s29, 557056
buffer_load_dwordx4 v124, s[12:15], s46 offen lds
s_add_u32 m0, s28, 6144
s_add_u32 s46, s29, 786432
buffer_load_dwordx4 v124, s[12:15], s46 offen lds
s_add_u32 m0, s28, 7168
s_add_u32 s46, s29, 819200
buffer_load_dwordx4 v124, s[12:15], s46 offen lds
s_add_u32 m0, s28, 8192
s_add_u32 s46, s29, 1048576
buffer_load_dwordx4 v124, s[12:15], s46 offen lds
s_add_u32 m0, s28, 9216
s_add_u32 s46, s29, 1081344
buffer_load_dwordx4 v124, s[12:15], s46 offen lds
s_add_u32 m0, s28, 10240
s_add_u32 s46, s29, 1310720
buffer_load_dwordx4 v124, s[12:15], s46 offen lds
s_add_u32 m0, s28, 11264
s_add_u32 s46, s29, 1343488
buffer_load_dwordx4 v124, s[12:15], s46 offen lds
s_add_u32 m0, s28, 12288
s_add_u32 s46, s29, 1572864
buffer_load_dwordx4 v124, s[12:15], s46 offen lds
s_add_u32 m0, s28, 13312
s_add_u32 s46, s29, 1605632
buffer_load_dwordx4 v124, s[12:15], s46 offen lds
s_add_u32 m0, s28, 14336
s_add_u32 s46, s29, 1835008
buffer_load_dwordx4 v124, s[12:15], s46 offen lds
s_add_u32 m0, s28, 15360
s_add_u32 s46, s29, 1867776
buffer_load_dwordx4 v124, s[12:15], s46 offen lds
s_add_u32 m0, s28, 16384
s_add_u32 s46, s29, 2097152
buffer_load_dwordx4 v124, s[12:15], s46 offen lds
s_add_u32 m0, s28, 17408
s_add_u32 s46, s29, 2129920
buffer_load_dwordx4 v124, s[12:15], s46 offen lds
s_add_u32 m0, s28, 18432
s_add_u32 s46, s29, 2359296
buffer_load_dwordx4 v124, s[12:15], s46 offen lds
s_add_u32 m0, s28, 19456
s_add_u32 s46, s29, 2392064
buffer_load_dwordx4 v124, s[12:15], s46 offen lds
s_add_u32 m0, s28, 20480
s_add_u32 s46, s29, 2621440
buffer_load_dwordx4 v124, s[12:15], s46 offen lds
s_add_u32 m0, s28, 21504
s_add_u32 s46, s29, 2654208
buffer_load_dwordx4 v124, s[12:15], s46 offen lds
s_add_u32 m0, s28, 22528
s_add_u32 s46, s29, 2883584
buffer_load_dwordx4 v124, s[12:15], s46 offen lds
s_add_u32 m0, s28, 23552
s_add_u32 s46, s29, 2916352
buffer_load_dwordx4 v124, s[12:15], s46 offen lds
s_add_u32 m0, s28, 24576
s_add_u32 s46, s29, 3145728
buffer_load_dwordx4 v124, s[12:15], s46 offen lds
s_add_u32 m0, s28, 25600
s_add_u32 s46, s29, 3178496
buffer_load_dwordx4 v124, s[12:15], s46 offen lds
s_add_u32 m0, s28, 26624
s_add_u32 s46, s29, 3407872
buffer_load_dwordx4 v124, s[12:15], s46 offen lds
s_add_u32 m0, s28, 27648
s_add_u32 s46, s29, 3440640
buffer_load_dwordx4 v124, s[12:15], s46 offen lds
s_add_u32 m0, s28, 28672
s_add_u32 s46, s29, 3670016
buffer_load_dwordx4 v124, s[12:15], s46 offen lds
s_add_u32 m0, s28, 29696
s_add_u32 s46, s29, 3702784
buffer_load_dwordx4 v124, s[12:15], s46 offen lds
s_add_u32 m0, s28, 30720
s_add_u32 s46, s29, 3932160
buffer_load_dwordx4 v124, s[12:15], s46 offen lds
s_add_u32 m0, s28, 31744
s_add_u32 s46, s29, 3964928
buffer_load_dwordx4 v124, s[12:15], s46 offen lds
s_waitcnt vmcnt(30)
ds_read2st64_b32 v[16:17], v125 offset0:0 offset1:1
ds_read2st64_b32 v[18:19], v125 offset0:2 offset1:3
ds_read2st64_b32 v[20:21], v125 offset0:4 offset1:5
ds_read2st64_b32 v[22:23], v125 offset0:6 offset1:7
s_waitcnt vmcnt(28)
ds_read2st64_b32 v[24:25], v125 offset0:8 offset1:9
ds_read2st64_b32 v[26:27], v125 offset0:10 offset1:11
ds_read2st64_b32 v[28:29], v125 offset0:12 offset1:13
ds_read2st64_b32 v[30:31], v125 offset0:14 offset1:15
s_waitcnt lgkmcnt(4)
s_load_dwordx2 s[12:13], s[0:1], 24
s_mov_b32 s14, 4194304
s_mov_b32 s15, 0x00020000
s_waitcnt lgkmcnt(0)
s_add_u32 m0, s28, 0
s_add_u32 s46, s29, 0
buffer_load_dwordx4 v124, s[12:15], s46 offen lds
s_add_u32 m0, s28, 1024
s_add_u32 s46, s29, 32768
buffer_load_dwordx4 v124, s[12:15], s46 offen lds
v_perm_b32 v80, v17, v16, s50
v_perm_b32 v81, v19, v18, s50
v_perm_b32 v82, v21, v20, s50
v_perm_b32 v83, v23, v22, s50
v_accvgpr_write_b32 a0, v80
v_accvgpr_write_b32 a1, v81
v_accvgpr_write_b32 a2, v82
v_accvgpr_write_b32 a3, v83
v_perm_b32 v84, v17, v16, s51
v_perm_b32 v85, v19, v18, s51
v_perm_b32 v86, v21, v20, s51
v_perm_b32 v87, v23, v22, s51
v_accvgpr_write_b32 a4, v84
v_accvgpr_write_b32 a5, v85
v_accvgpr_write_b32 a6, v86
v_accvgpr_write_b32 a7, v87
s_waitcnt vmcnt(28)
ds_read2st64_b32 v[16:17], v125 offset0:16 offset1:17
ds_read2st64_b32 v[18:19], v125 offset0:18 offset1:19
ds_read2st64_b32 v[20:21], v125 offset0:20 offset1:21
ds_read2st64_b32 v[22:23], v125 offset0:22 offset1:23
s_waitcnt lgkmcnt(4)
s_add_u32 m0, s28, 2048
s_add_u32 s46, s29, 262144
buffer_load_dwordx4 v124, s[12:15], s46 offen lds
s_add_u32 m0, s28, 3072
s_add_u32 s46, s29, 294912
buffer_load_dwordx4 v124, s[12:15], s46 offen lds
v_perm_b32 v80, v25, v24, s50
v_perm_b32 v81, v27, v26, s50
v_perm_b32 v82, v29, v28, s50
v_perm_b32 v83, v31, v30, s50
v_accvgpr_write_b32 a8, v80
v_accvgpr_write_b32 a9, v81
v_accvgpr_write_b32 a10, v82
v_accvgpr_write_b32 a11, v83
v_perm_b32 v84, v25, v24, s51
v_perm_b32 v85, v27, v26, s51
v_perm_b32 v86, v29, v28, s51
v_perm_b32 v87, v31, v30, s51
v_accvgpr_write_b32 a12, v84
v_accvgpr_write_b32 a13, v85
v_accvgpr_write_b32 a14, v86
v_accvgpr_write_b32 a15, v87
s_waitcnt vmcnt(28)
ds_read2st64_b32 v[24:25], v125 offset0:24 offset1:25
ds_read2st64_b32 v[26:27], v125 offset0:26 offset1:27
ds_read2st64_b32 v[28:29], v125 offset0:28 offset1:29
ds_read2st64_b32 v[30:31], v125 offset0:30 offset1:31
s_waitcnt lgkmcnt(4)
s_add_u32 m0, s28, 4096
s_add_u32 s46, s29, 524288
buffer_load_dwordx4 v124, s[12:15], s46 offen lds
s_add_u32 m0, s28, 5120
s_add_u32 s46, s29, 557056
buffer_load_dwordx4 v124, s[12:15], s46 offen lds
v_perm_b32 v80, v17, v16, s50
v_perm_b32 v81, v19, v18, s50
v_perm_b32 v82, v21, v20, s50
v_perm_b32 v83, v23, v22, s50
v_accvgpr_write_b32 a16, v80
v_accvgpr_write_b32 a17, v81
v_accvgpr_write_b32 a18, v82
v_accvgpr_write_b32 a19, v83
v_perm_b32 v84, v17, v16, s51
v_perm_b32 v85, v19, v18, s51
v_perm_b32 v86, v21, v20, s51
v_perm_b32 v87, v23, v22, s51
v_accvgpr_write_b32 a20, v84
v_accvgpr_write_b32 a21, v85
v_accvgpr_write_b32 a22, v86
v_accvgpr_write_b32 a23, v87
s_waitcnt vmcnt(28)
ds_read2st64_b32 v[16:17], v125 offset0:32 offset1:33
ds_read2st64_b32 v[18:19], v125 offset0:34 offset1:35
ds_read2st64_b32 v[20:21], v125 offset0:36 offset1:37
ds_read2st64_b32 v[22:23], v125 offset0:38 offset1:39
s_waitcnt lgkmcnt(4)
s_add_u32 m0, s28, 6144
s_add_u32 s46, s29, 786432
buffer_load_dwordx4 v124, s[12:15], s46 offen lds
s_add_u32 m0, s28, 7168
s_add_u32 s46, s29, 819200
buffer_load_dwordx4 v124, s[12:15], s46 offen lds
v_perm_b32 v80, v25, v24, s50
v_perm_b32 v81, v27, v26, s50
v_perm_b32 v82, v29, v28, s50
v_perm_b32 v83, v31, v30, s50
v_accvgpr_write_b32 a24, v80
v_accvgpr_write_b32 a25, v81
v_accvgpr_write_b32 a26, v82
v_accvgpr_write_b32 a27, v83
v_perm_b32 v84, v25, v24, s51
v_perm_b32 v85, v27, v26, s51
v_perm_b32 v86, v29, v28, s51
v_perm_b32 v87, v31, v30, s51
v_accvgpr_write_b32 a28, v84
v_accvgpr_write_b32 a29, v85
v_accvgpr_write_b32 a30, v86
v_accvgpr_write_b32 a31, v87
s_waitcnt vmcnt(28)
ds_read2st64_b32 v[24:25], v125 offset0:40 offset1:41
ds_read2st64_b32 v[26:27], v125 offset0:42 offset1:43
ds_read2st64_b32 v[28:29], v125 offset0:44 offset1:45
ds_read2st64_b32 v[30:31], v125 offset0:46 offset1:47
s_waitcnt lgkmcnt(4)
s_add_u32 m0, s28, 8192
s_add_u32 s46, s29, 1048576
buffer_load_dwordx4 v124, s[12:15], s46 offen lds
s_add_u32 m0, s28, 9216
s_add_u32 s46, s29, 1081344
buffer_load_dwordx4 v124, s[12:15], s46 offen lds
v_perm_b32 v80, v17, v16, s50
v_perm_b32 v81, v19, v18, s50
v_perm_b32 v82, v21, v20, s50
v_perm_b32 v83, v23, v22, s50
v_accvgpr_write_b32 a32, v80
v_accvgpr_write_b32 a33, v81
v_accvgpr_write_b32 a34, v82
v_accvgpr_write_b32 a35, v83
v_perm_b32 v84, v17, v16, s51
v_perm_b32 v85, v19, v18, s51
v_perm_b32 v86, v21, v20, s51
v_perm_b32 v87, v23, v22, s51
v_accvgpr_write_b32 a36, v84
v_accvgpr_write_b32 a37, v85
v_accvgpr_write_b32 a38, v86
v_accvgpr_write_b32 a39, v87
s_waitcnt vmcnt(28)
ds_read2st64_b32 v[16:17], v125 offset0:48 offset1:49
ds_read2st64_b32 v[18:19], v125 offset0:50 offset1:51
ds_read2st64_b32 v[20:21], v125 offset0:52 offset1:53
ds_read2st64_b32 v[22:23], v125 offset0:54 offset1:55
s_waitcnt lgkmcnt(4)
s_add_u32 m0, s28, 10240
s_add_u32 s46, s29, 1310720
buffer_load_dwordx4 v124, s[12:15], s46 offen lds
s_add_u32 m0, s28, 11264
s_add_u32 s46, s29, 1343488
buffer_load_dwordx4 v124, s[12:15], s46 offen lds
v_perm_b32 v80, v25, v24, s50
v_perm_b32 v81, v27, v26, s50
v_perm_b32 v82, v29, v28, s50
v_perm_b32 v83, v31, v30, s50
v_accvgpr_write_b32 a40, v80
v_accvgpr_write_b32 a41, v81
v_accvgpr_write_b32 a42, v82
v_accvgpr_write_b32 a43, v83
v_perm_b32 v84, v25, v24, s51
v_perm_b32 v85, v27, v26, s51
v_perm_b32 v86, v29, v28, s51
v_perm_b32 v87, v31, v30, s51
v_accvgpr_write_b32 a44, v84
v_accvgpr_write_b32 a45, v85
v_accvgpr_write_b32 a46, v86
v_accvgpr_write_b32 a47, v87
s_waitcnt vmcnt(28)
ds_read2st64_b32 v[24:25], v125 offset0:56 offset1:57
ds_read2st64_b32 v[26:27], v125 offset0:58 offset1:59
ds_read2st64_b32 v[28:29], v125 offset0:60 offset1:61
ds_read2st64_b32 v[30:31], v125 offset0:62 offset1:63
s_waitcnt lgkmcnt(4)
s_add_u32 m0, s28, 12288
s_add_u32 s46, s29, 1572864
buffer_load_dwordx4 v124, s[12:15], s46 offen lds
s_add_u32 m0, s28, 13312
s_add_u32 s46, s29, 1605632
buffer_load_dwordx4 v124, s[12:15], s46 offen lds
v_perm_b32 v80, v17, v16, s50
v_perm_b32 v81, v19, v18, s50
v_perm_b32 v82, v21, v20, s50
v_perm_b32 v83, v23, v22, s50
v_accvgpr_write_b32 a48, v80
v_accvgpr_write_b32 a49, v81
v_accvgpr_write_b32 a50, v82
v_accvgpr_write_b32 a51, v83
v_perm_b32 v84, v17, v16, s51
v_perm_b32 v85, v19, v18, s51
v_perm_b32 v86, v21, v20, s51
v_perm_b32 v87, v23, v22, s51
v_accvgpr_write_b32 a52, v84
v_accvgpr_write_b32 a53, v85
v_accvgpr_write_b32 a54, v86
v_accvgpr_write_b32 a55, v87
s_waitcnt vmcnt(28)
ds_read2st64_b32 v[16:17], v125 offset0:64 offset1:65
ds_read2st64_b32 v[18:19], v125 offset0:66 offset1:67
ds_read2st64_b32 v[20:21], v125 offset0:68 offset1:69
ds_read2st64_b32 v[22:23], v125 offset0:70 offset1:71
s_waitcnt lgkmcnt(4)
s_add_u32 m0, s28, 14336
s_add_u32 s46, s29, 1835008
buffer_load_dwordx4 v124, s[12:15], s46 offen lds
s_add_u32 m0, s28, 15360
s_add_u32 s46, s29, 1867776
buffer_load_dwordx4 v124, s[12:15], s46 offen lds
v_perm_b32 v80, v25, v24, s50
v_perm_b32 v81, v27, v26, s50
v_perm_b32 v82, v29, v28, s50
v_perm_b32 v83, v31, v30, s50
v_accvgpr_write_b32 a56, v80
v_accvgpr_write_b32 a57, v81
v_accvgpr_write_b32 a58, v82
v_accvgpr_write_b32 a59, v83
v_perm_b32 v84, v25, v24, s51
v_perm_b32 v85, v27, v26, s51
v_perm_b32 v86, v29, v28, s51
v_perm_b32 v87, v31, v30, s51
v_accvgpr_write_b32 a60, v84
v_accvgpr_write_b32 a61, v85
v_accvgpr_write_b32 a62, v86
v_accvgpr_write_b32 a63, v87
s_waitcnt vmcnt(28)
ds_read2st64_b32 v[24:25], v125 offset0:72 offset1:73
ds_read2st64_b32 v[26:27], v125 offset0:74 offset1:75
ds_read2st64_b32 v[28:29], v125 offset0:76 offset1:77
ds_read2st64_b32 v[30:31], v125 offset0:78 offset1:79
s_waitcnt lgkmcnt(4)
s_add_u32 m0, s28, 16384
s_add_u32 s46, s29, 2097152
buffer_load_dwordx4 v124, s[12:15], s46 offen lds
s_add_u32 m0, s28, 17408
s_add_u32 s46, s29, 2129920
buffer_load_dwordx4 v124, s[12:15], s46 offen lds
v_perm_b32 v80, v17, v16, s50
v_perm_b32 v81, v19, v18, s50
v_perm_b32 v82, v21, v20, s50
v_perm_b32 v83, v23, v22, s50
v_accvgpr_write_b32 a64, v80
v_accvgpr_write_b32 a65, v81
v_accvgpr_write_b32 a66, v82
v_accvgpr_write_b32 a67, v83
v_perm_b32 v84, v17, v16, s51
v_perm_b32 v85, v19, v18, s51
v_perm_b32 v86, v21, v20, s51
v_perm_b32 v87, v23, v22, s51
v_accvgpr_write_b32 a68, v84
v_accvgpr_write_b32 a69, v85
v_accvgpr_write_b32 a70, v86
v_accvgpr_write_b32 a71, v87
s_waitcnt vmcnt(28)
ds_read2st64_b32 v[16:17], v125 offset0:80 offset1:81
ds_read2st64_b32 v[18:19], v125 offset0:82 offset1:83
ds_read2st64_b32 v[20:21], v125 offset0:84 offset1:85
ds_read2st64_b32 v[22:23], v125 offset0:86 offset1:87
s_waitcnt lgkmcnt(4)
s_add_u32 m0, s28, 18432
s_add_u32 s46, s29, 2359296
buffer_load_dwordx4 v124, s[12:15], s46 offen lds
s_add_u32 m0, s28, 19456
s_add_u32 s46, s29, 2392064
buffer_load_dwordx4 v124, s[12:15], s46 offen lds
v_perm_b32 v80, v25, v24, s50
v_perm_b32 v81, v27, v26, s50
v_perm_b32 v82, v29, v28, s50
v_perm_b32 v83, v31, v30, s50
v_accvgpr_write_b32 a72, v80
v_accvgpr_write_b32 a73, v81
v_accvgpr_write_b32 a74, v82
v_accvgpr_write_b32 a75, v83
v_perm_b32 v84, v25, v24, s51
v_perm_b32 v85, v27, v26, s51
v_perm_b32 v86, v29, v28, s51
v_perm_b32 v87, v31, v30, s51
v_accvgpr_write_b32 a76, v84
v_accvgpr_write_b32 a77, v85
v_accvgpr_write_b32 a78, v86
v_accvgpr_write_b32 a79, v87
s_waitcnt vmcnt(28)
ds_read2st64_b32 v[24:25], v125 offset0:88 offset1:89
ds_read2st64_b32 v[26:27], v125 offset0:90 offset1:91
ds_read2st64_b32 v[28:29], v125 offset0:92 offset1:93
ds_read2st64_b32 v[30:31], v125 offset0:94 offset1:95
s_waitcnt lgkmcnt(4)
s_add_u32 m0, s28, 20480
s_add_u32 s46, s29, 2621440
buffer_load_dwordx4 v124, s[12:15], s46 offen lds
s_add_u32 m0, s28, 21504
s_add_u32 s46, s29, 2654208
buffer_load_dwordx4 v124, s[12:15], s46 offen lds
v_perm_b32 v80, v17, v16, s50
v_perm_b32 v81, v19, v18, s50
v_perm_b32 v82, v21, v20, s50
v_perm_b32 v83, v23, v22, s50
v_accvgpr_write_b32 a80, v80
v_accvgpr_write_b32 a81, v81
v_accvgpr_write_b32 a82, v82
v_accvgpr_write_b32 a83, v83
v_perm_b32 v84, v17, v16, s51
v_perm_b32 v85, v19, v18, s51
v_perm_b32 v86, v21, v20, s51
v_perm_b32 v87, v23, v22, s51
v_accvgpr_write_b32 a84, v84
v_accvgpr_write_b32 a85, v85
v_accvgpr_write_b32 a86, v86
v_accvgpr_write_b32 a87, v87
s_waitcnt vmcnt(28)
ds_read2st64_b32 v[16:17], v125 offset0:96 offset1:97
ds_read2st64_b32 v[18:19], v125 offset0:98 offset1:99
ds_read2st64_b32 v[20:21], v125 offset0:100 offset1:101
ds_read2st64_b32 v[22:23], v125 offset0:102 offset1:103
s_waitcnt lgkmcnt(4)
s_add_u32 m0, s28, 22528
s_add_u32 s46, s29, 2883584
buffer_load_dwordx4 v124, s[12:15], s46 offen lds
s_add_u32 m0, s28, 23552
s_add_u32 s46, s29, 2916352
buffer_load_dwordx4 v124, s[12:15], s46 offen lds
v_perm_b32 v80, v25, v24, s50
v_perm_b32 v81, v27, v26, s50
v_perm_b32 v82, v29, v28, s50
v_perm_b32 v83, v31, v30, s50
v_accvgpr_write_b32 a88, v80
v_accvgpr_write_b32 a89, v81
v_accvgpr_write_b32 a90, v82
v_accvgpr_write_b32 a91, v83
v_perm_b32 v84, v25, v24, s51
v_perm_b32 v85, v27, v26, s51
v_perm_b32 v86, v29, v28, s51
v_perm_b32 v87, v31, v30, s51
v_accvgpr_write_b32 a92, v84
v_accvgpr_write_b32 a93, v85
v_accvgpr_write_b32 a94, v86
v_accvgpr_write_b32 a95, v87
s_waitcnt vmcnt(28)
ds_read2st64_b32 v[24:25], v125 offset0:104 offset1:105
ds_read2st64_b32 v[26:27], v125 offset0:106 offset1:107
ds_read2st64_b32 v[28:29], v125 offset0:108 offset1:109
ds_read2st64_b32 v[30:31], v125 offset0:110 offset1:111
s_waitcnt lgkmcnt(4)
s_add_u32 m0, s28, 24576
s_add_u32 s46, s29, 3145728
buffer_load_dwordx4 v124, s[12:15], s46 offen lds
s_add_u32 m0, s28, 25600
s_add_u32 s46, s29, 3178496
buffer_load_dwordx4 v124, s[12:15], s46 offen lds
v_perm_b32 v80, v17, v16, s50
v_perm_b32 v81, v19, v18, s50
v_perm_b32 v82, v21, v20, s50
v_perm_b32 v83, v23, v22, s50
v_accvgpr_write_b32 a96, v80
v_accvgpr_write_b32 a97, v81
v_accvgpr_write_b32 a98, v82
v_accvgpr_write_b32 a99, v83
v_perm_b32 v84, v17, v16, s51
v_perm_b32 v85, v19, v18, s51
v_perm_b32 v86, v21, v20, s51
v_perm_b32 v87, v23, v22, s51
v_accvgpr_write_b32 a100, v84
v_accvgpr_write_b32 a101, v85
v_accvgpr_write_b32 a102, v86
v_accvgpr_write_b32 a103, v87
s_waitcnt vmcnt(28)
ds_read2st64_b32 v[16:17], v125 offset0:112 offset1:113
ds_read2st64_b32 v[18:19], v125 offset0:114 offset1:115
ds_read2st64_b32 v[20:21], v125 offset0:116 offset1:117
ds_read2st64_b32 v[22:23], v125 offset0:118 offset1:119
s_waitcnt lgkmcnt(4)
s_add_u32 m0, s28, 26624
s_add_u32 s46, s29, 3407872
buffer_load_dwordx4 v124, s[12:15], s46 offen lds
s_add_u32 m0, s28, 27648
s_add_u32 s46, s29, 3440640
buffer_load_dwordx4 v124, s[12:15], s46 offen lds
v_perm_b32 v80, v25, v24, s50
v_perm_b32 v81, v27, v26, s50
v_perm_b32 v82, v29, v28, s50
v_perm_b32 v83, v31, v30, s50
v_accvgpr_write_b32 a104, v80
v_accvgpr_write_b32 a105, v81
v_accvgpr_write_b32 a106, v82
v_accvgpr_write_b32 a107, v83
v_perm_b32 v84, v25, v24, s51
v_perm_b32 v85, v27, v26, s51
v_perm_b32 v86, v29, v28, s51
v_perm_b32 v87, v31, v30, s51
v_accvgpr_write_b32 a108, v84
v_accvgpr_write_b32 a109, v85
v_accvgpr_write_b32 a110, v86
v_accvgpr_write_b32 a111, v87
s_waitcnt vmcnt(28)
ds_read2st64_b32 v[24:25], v125 offset0:120 offset1:121
ds_read2st64_b32 v[26:27], v125 offset0:122 offset1:123
ds_read2st64_b32 v[28:29], v125 offset0:124 offset1:125
ds_read2st64_b32 v[30:31], v125 offset0:126 offset1:127
s_waitcnt lgkmcnt(4)
s_add_u32 m0, s28, 28672
s_add_u32 s46, s29, 3670016
buffer_load_dwordx4 v124, s[12:15], s46 offen lds
s_add_u32 m0, s28, 29696
s_add_u32 s46, s29, 3702784
buffer_load_dwordx4 v124, s[12:15], s46 offen lds
v_perm_b32 v80, v17, v16, s50
v_perm_b32 v81, v19, v18, s50
v_perm_b32 v82, v21, v20, s50
v_perm_b32 v83, v23, v22, s50
v_accvgpr_write_b32 a112, v80
v_accvgpr_write_b32 a113, v81
v_accvgpr_write_b32 a114, v82
v_accvgpr_write_b32 a115, v83
v_perm_b32 v84, v17, v16, s51
v_perm_b32 v85, v19, v18, s51
v_perm_b32 v86, v21, v20, s51
v_perm_b32 v87, v23, v22, s51
v_accvgpr_write_b32 a116, v84
v_accvgpr_write_b32 a117, v85
v_accvgpr_write_b32 a118, v86
v_accvgpr_write_b32 a119, v87
s_waitcnt vmcnt(28)
ds_read2st64_b32 v[16:17], v125 offset0:0 offset1:1
ds_read2st64_b32 v[18:19], v125 offset0:2 offset1:3
ds_read2st64_b32 v[20:21], v125 offset0:4 offset1:5
ds_read2st64_b32 v[22:23], v125 offset0:6 offset1:7
s_waitcnt lgkmcnt(4)
s_add_u32 m0, s28, 30720
s_add_u32 s46, s29, 3932160
buffer_load_dwordx4 v124, s[12:15], s46 offen lds
s_add_u32 m0, s28, 31744
s_add_u32 s46, s29, 3964928
buffer_load_dwordx4 v124, s[12:15], s46 offen lds
v_perm_b32 v80, v25, v24, s50
v_perm_b32 v81, v27, v26, s50
v_perm_b32 v82, v29, v28, s50
v_perm_b32 v83, v31, v30, s50
v_accvgpr_write_b32 a120, v80
v_accvgpr_write_b32 a121, v81
v_accvgpr_write_b32 a122, v82
v_accvgpr_write_b32 a123, v83
v_perm_b32 v84, v25, v24, s51
v_perm_b32 v85, v27, v26, s51
v_perm_b32 v86, v29, v28, s51
v_perm_b32 v87, v31, v30, s51
v_accvgpr_write_b32 a124, v84
v_accvgpr_write_b32 a125, v85
v_accvgpr_write_b32 a126, v86
v_accvgpr_write_b32 a127, v87
s_waitcnt vmcnt(28)
ds_read2st64_b32 v[24:25], v125 offset0:8 offset1:9
ds_read2st64_b32 v[26:27], v125 offset0:10 offset1:11
ds_read2st64_b32 v[28:29], v125 offset0:12 offset1:13
ds_read2st64_b32 v[30:31], v125 offset0:14 offset1:15
s_waitcnt lgkmcnt(4)
s_load_dwordx2 s[12:13], s[0:1], 32
s_mov_b32 s14, 4194304
s_mov_b32 s15, 0x00020000
s_waitcnt lgkmcnt(0)
s_add_u32 m0, s28, 0
s_add_u32 s46, s29, 0
buffer_load_dwordx4 v124, s[12:15], s46 offen lds
s_add_u32 m0, s28, 1024
s_add_u32 s46, s29, 32768
buffer_load_dwordx4 v124, s[12:15], s46 offen lds
v_perm_b32 v80, v17, v16, s50
v_perm_b32 v81, v19, v18, s50
v_perm_b32 v82, v21, v20, s50
v_perm_b32 v83, v23, v22, s50
v_accvgpr_write_b32 a128, v80
v_accvgpr_write_b32 a129, v81
v_accvgpr_write_b32 a130, v82
v_accvgpr_write_b32 a131, v83
v_perm_b32 v84, v17, v16, s51
v_perm_b32 v85, v19, v18, s51
v_perm_b32 v86, v21, v20, s51
v_perm_b32 v87, v23, v22, s51
v_accvgpr_write_b32 a132, v84
v_accvgpr_write_b32 a133, v85
v_accvgpr_write_b32 a134, v86
v_accvgpr_write_b32 a135, v87
s_waitcnt vmcnt(28)
ds_read2st64_b32 v[16:17], v125 offset0:16 offset1:17
ds_read2st64_b32 v[18:19], v125 offset0:18 offset1:19
ds_read2st64_b32 v[20:21], v125 offset0:20 offset1:21
ds_read2st64_b32 v[22:23], v125 offset0:22 offset1:23
s_waitcnt lgkmcnt(4)
s_add_u32 m0, s28, 2048
s_add_u32 s46, s29, 262144
buffer_load_dwordx4 v124, s[12:15], s46 offen lds
s_add_u32 m0, s28, 3072
s_add_u32 s46, s29, 294912
buffer_load_dwordx4 v124, s[12:15], s46 offen lds
v_perm_b32 v80, v25, v24, s50
v_perm_b32 v81, v27, v26, s50
v_perm_b32 v82, v29, v28, s50
v_perm_b32 v83, v31, v30, s50
v_accvgpr_write_b32 a136, v80
v_accvgpr_write_b32 a137, v81
v_accvgpr_write_b32 a138, v82
v_accvgpr_write_b32 a139, v83
v_perm_b32 v84, v25, v24, s51
v_perm_b32 v85, v27, v26, s51
v_perm_b32 v86, v29, v28, s51
v_perm_b32 v87, v31, v30, s51
v_accvgpr_write_b32 a140, v84
v_accvgpr_write_b32 a141, v85
v_accvgpr_write_b32 a142, v86
v_accvgpr_write_b32 a143, v87
s_waitcnt vmcnt(28)
ds_read2st64_b32 v[24:25], v125 offset0:24 offset1:25
ds_read2st64_b32 v[26:27], v125 offset0:26 offset1:27
ds_read2st64_b32 v[28:29], v125 offset0:28 offset1:29
ds_read2st64_b32 v[30:31], v125 offset0:30 offset1:31
s_waitcnt lgkmcnt(4)
s_add_u32 m0, s28, 4096
s_add_u32 s46, s29, 524288
buffer_load_dwordx4 v124, s[12:15], s46 offen lds
s_add_u32 m0, s28, 5120
s_add_u32 s46, s29, 557056
buffer_load_dwordx4 v124, s[12:15], s46 offen lds
v_perm_b32 v80, v17, v16, s50
v_perm_b32 v81, v19, v18, s50
v_perm_b32 v82, v21, v20, s50
v_perm_b32 v83, v23, v22, s50
v_accvgpr_write_b32 a144, v80
v_accvgpr_write_b32 a145, v81
v_accvgpr_write_b32 a146, v82
v_accvgpr_write_b32 a147, v83
v_perm_b32 v84, v17, v16, s51
v_perm_b32 v85, v19, v18, s51
v_perm_b32 v86, v21, v20, s51
v_perm_b32 v87, v23, v22, s51
v_accvgpr_write_b32 a148, v84
v_accvgpr_write_b32 a149, v85
v_accvgpr_write_b32 a150, v86
v_accvgpr_write_b32 a151, v87
s_waitcnt vmcnt(28)
ds_read2st64_b32 v[16:17], v125 offset0:32 offset1:33
ds_read2st64_b32 v[18:19], v125 offset0:34 offset1:35
ds_read2st64_b32 v[20:21], v125 offset0:36 offset1:37
ds_read2st64_b32 v[22:23], v125 offset0:38 offset1:39
s_waitcnt lgkmcnt(4)
s_add_u32 m0, s28, 6144
s_add_u32 s46, s29, 786432
buffer_load_dwordx4 v124, s[12:15], s46 offen lds
s_add_u32 m0, s28, 7168
s_add_u32 s46, s29, 819200
buffer_load_dwordx4 v124, s[12:15], s46 offen lds
v_perm_b32 v80, v25, v24, s50
v_perm_b32 v81, v27, v26, s50
v_perm_b32 v82, v29, v28, s50
v_perm_b32 v83, v31, v30, s50
v_accvgpr_write_b32 a152, v80
v_accvgpr_write_b32 a153, v81
v_accvgpr_write_b32 a154, v82
v_accvgpr_write_b32 a155, v83
v_perm_b32 v84, v25, v24, s51
v_perm_b32 v85, v27, v26, s51
v_perm_b32 v86, v29, v28, s51
v_perm_b32 v87, v31, v30, s51
v_accvgpr_write_b32 a156, v84
v_accvgpr_write_b32 a157, v85
v_accvgpr_write_b32 a158, v86
v_accvgpr_write_b32 a159, v87
s_waitcnt vmcnt(28)
ds_read2st64_b32 v[24:25], v125 offset0:40 offset1:41
ds_read2st64_b32 v[26:27], v125 offset0:42 offset1:43
ds_read2st64_b32 v[28:29], v125 offset0:44 offset1:45
ds_read2st64_b32 v[30:31], v125 offset0:46 offset1:47
s_waitcnt lgkmcnt(4)
s_add_u32 m0, s28, 8192
s_add_u32 s46, s29, 1048576
buffer_load_dwordx4 v124, s[12:15], s46 offen lds
s_add_u32 m0, s28, 9216
s_add_u32 s46, s29, 1081344
buffer_load_dwordx4 v124, s[12:15], s46 offen lds
v_perm_b32 v80, v17, v16, s50
v_perm_b32 v81, v19, v18, s50
v_perm_b32 v82, v21, v20, s50
v_perm_b32 v83, v23, v22, s50
v_accvgpr_write_b32 a160, v80
v_accvgpr_write_b32 a161, v81
v_accvgpr_write_b32 a162, v82
v_accvgpr_write_b32 a163, v83
v_perm_b32 v84, v17, v16, s51
v_perm_b32 v85, v19, v18, s51
v_perm_b32 v86, v21, v20, s51
v_perm_b32 v87, v23, v22, s51
v_accvgpr_write_b32 a164, v84
v_accvgpr_write_b32 a165, v85
v_accvgpr_write_b32 a166, v86
v_accvgpr_write_b32 a167, v87
s_waitcnt vmcnt(28)
ds_read2st64_b32 v[16:17], v125 offset0:48 offset1:49
ds_read2st64_b32 v[18:19], v125 offset0:50 offset1:51
ds_read2st64_b32 v[20:21], v125 offset0:52 offset1:53
ds_read2st64_b32 v[22:23], v125 offset0:54 offset1:55
s_waitcnt lgkmcnt(4)
s_add_u32 m0, s28, 10240
s_add_u32 s46, s29, 1310720
buffer_load_dwordx4 v124, s[12:15], s46 offen lds
s_add_u32 m0, s28, 11264
s_add_u32 s46, s29, 1343488
buffer_load_dwordx4 v124, s[12:15], s46 offen lds
v_perm_b32 v80, v25, v24, s50
v_perm_b32 v81, v27, v26, s50
v_perm_b32 v82, v29, v28, s50
v_perm_b32 v83, v31, v30, s50
v_accvgpr_write_b32 a168, v80
v_accvgpr_write_b32 a169, v81
v_accvgpr_write_b32 a170, v82
v_accvgpr_write_b32 a171, v83
v_perm_b32 v84, v25, v24, s51
v_perm_b32 v85, v27, v26, s51
v_perm_b32 v86, v29, v28, s51
v_perm_b32 v87, v31, v30, s51
v_accvgpr_write_b32 a172, v84
v_accvgpr_write_b32 a173, v85
v_accvgpr_write_b32 a174, v86
v_accvgpr_write_b32 a175, v87
s_waitcnt vmcnt(28)
ds_read2st64_b32 v[24:25], v125 offset0:56 offset1:57
ds_read2st64_b32 v[26:27], v125 offset0:58 offset1:59
ds_read2st64_b32 v[28:29], v125 offset0:60 offset1:61
ds_read2st64_b32 v[30:31], v125 offset0:62 offset1:63
s_waitcnt lgkmcnt(4)
s_add_u32 m0, s28, 12288
s_add_u32 s46, s29, 1572864
buffer_load_dwordx4 v124, s[12:15], s46 offen lds
s_add_u32 m0, s28, 13312
s_add_u32 s46, s29, 1605632
buffer_load_dwordx4 v124, s[12:15], s46 offen lds
v_perm_b32 v80, v17, v16, s50
v_perm_b32 v81, v19, v18, s50
v_perm_b32 v82, v21, v20, s50
v_perm_b32 v83, v23, v22, s50
v_accvgpr_write_b32 a176, v80
v_accvgpr_write_b32 a177, v81
v_accvgpr_write_b32 a178, v82
v_accvgpr_write_b32 a179, v83
v_perm_b32 v84, v17, v16, s51
v_perm_b32 v85, v19, v18, s51
v_perm_b32 v86, v21, v20, s51
v_perm_b32 v87, v23, v22, s51
v_accvgpr_write_b32 a180, v84
v_accvgpr_write_b32 a181, v85
v_accvgpr_write_b32 a182, v86
v_accvgpr_write_b32 a183, v87
s_waitcnt vmcnt(28)
ds_read2st64_b32 v[16:17], v125 offset0:64 offset1:65
ds_read2st64_b32 v[18:19], v125 offset0:66 offset1:67
ds_read2st64_b32 v[20:21], v125 offset0:68 offset1:69
ds_read2st64_b32 v[22:23], v125 offset0:70 offset1:71
s_waitcnt lgkmcnt(4)
s_add_u32 m0, s28, 14336
s_add_u32 s46, s29, 1835008
buffer_load_dwordx4 v124, s[12:15], s46 offen lds
s_add_u32 m0, s28, 15360
s_add_u32 s46, s29, 1867776
buffer_load_dwordx4 v124, s[12:15], s46 offen lds
v_perm_b32 v80, v25, v24, s50
v_perm_b32 v81, v27, v26, s50
v_perm_b32 v82, v29, v28, s50
v_perm_b32 v83, v31, v30, s50
v_accvgpr_write_b32 a184, v80
v_accvgpr_write_b32 a185, v81
v_accvgpr_write_b32 a186, v82
v_accvgpr_write_b32 a187, v83
v_perm_b32 v84, v25, v24, s51
v_perm_b32 v85, v27, v26, s51
v_perm_b32 v86, v29, v28, s51
v_perm_b32 v87, v31, v30, s51
v_accvgpr_write_b32 a188, v84
v_accvgpr_write_b32 a189, v85
v_accvgpr_write_b32 a190, v86
v_accvgpr_write_b32 a191, v87
s_waitcnt vmcnt(28)
ds_read2st64_b32 v[24:25], v125 offset0:72 offset1:73
ds_read2st64_b32 v[26:27], v125 offset0:74 offset1:75
ds_read2st64_b32 v[28:29], v125 offset0:76 offset1:77
ds_read2st64_b32 v[30:31], v125 offset0:78 offset1:79
s_waitcnt lgkmcnt(4)
s_add_u32 m0, s28, 16384
s_add_u32 s46, s29, 2097152
buffer_load_dwordx4 v124, s[12:15], s46 offen lds
s_add_u32 m0, s28, 17408
s_add_u32 s46, s29, 2129920
buffer_load_dwordx4 v124, s[12:15], s46 offen lds
v_perm_b32 v80, v17, v16, s50
v_perm_b32 v81, v19, v18, s50
v_perm_b32 v82, v21, v20, s50
v_perm_b32 v83, v23, v22, s50
v_accvgpr_write_b32 a192, v80
v_accvgpr_write_b32 a193, v81
v_accvgpr_write_b32 a194, v82
v_accvgpr_write_b32 a195, v83
v_perm_b32 v84, v17, v16, s51
v_perm_b32 v85, v19, v18, s51
v_perm_b32 v86, v21, v20, s51
v_perm_b32 v87, v23, v22, s51
v_accvgpr_write_b32 a196, v84
v_accvgpr_write_b32 a197, v85
v_accvgpr_write_b32 a198, v86
v_accvgpr_write_b32 a199, v87
s_waitcnt vmcnt(28)
ds_read2st64_b32 v[16:17], v125 offset0:80 offset1:81
ds_read2st64_b32 v[18:19], v125 offset0:82 offset1:83
ds_read2st64_b32 v[20:21], v125 offset0:84 offset1:85
ds_read2st64_b32 v[22:23], v125 offset0:86 offset1:87
s_waitcnt lgkmcnt(4)
s_add_u32 m0, s28, 18432
s_add_u32 s46, s29, 2359296
buffer_load_dwordx4 v124, s[12:15], s46 offen lds
s_add_u32 m0, s28, 19456
s_add_u32 s46, s29, 2392064
buffer_load_dwordx4 v124, s[12:15], s46 offen lds
v_perm_b32 v80, v25, v24, s50
v_perm_b32 v81, v27, v26, s50
v_perm_b32 v82, v29, v28, s50
v_perm_b32 v83, v31, v30, s50
v_accvgpr_write_b32 a200, v80
v_accvgpr_write_b32 a201, v81
v_accvgpr_write_b32 a202, v82
v_accvgpr_write_b32 a203, v83
v_perm_b32 v84, v25, v24, s51
v_perm_b32 v85, v27, v26, s51
v_perm_b32 v86, v29, v28, s51
v_perm_b32 v87, v31, v30, s51
v_accvgpr_write_b32 a204, v84
v_accvgpr_write_b32 a205, v85
v_accvgpr_write_b32 a206, v86
v_accvgpr_write_b32 a207, v87
s_waitcnt vmcnt(28)
ds_read2st64_b32 v[24:25], v125 offset0:88 offset1:89
ds_read2st64_b32 v[26:27], v125 offset0:90 offset1:91
ds_read2st64_b32 v[28:29], v125 offset0:92 offset1:93
ds_read2st64_b32 v[30:31], v125 offset0:94 offset1:95
s_waitcnt lgkmcnt(4)
s_add_u32 m0, s28, 20480
s_add_u32 s46, s29, 2621440
buffer_load_dwordx4 v124, s[12:15], s46 offen lds
s_add_u32 m0, s28, 21504
s_add_u32 s46, s29, 2654208
buffer_load_dwordx4 v124, s[12:15], s46 offen lds
v_perm_b32 v80, v17, v16, s50
v_perm_b32 v81, v19, v18, s50
v_perm_b32 v82, v21, v20, s50
v_perm_b32 v83, v23, v22, s50
v_accvgpr_write_b32 a208, v80
v_accvgpr_write_b32 a209, v81
v_accvgpr_write_b32 a210, v82
v_accvgpr_write_b32 a211, v83
v_perm_b32 v84, v17, v16, s51
v_perm_b32 v85, v19, v18, s51
v_perm_b32 v86, v21, v20, s51
v_perm_b32 v87, v23, v22, s51
v_accvgpr_write_b32 a212, v84
v_accvgpr_write_b32 a213, v85
v_accvgpr_write_b32 a214, v86
v_accvgpr_write_b32 a215, v87
s_waitcnt vmcnt(28)
ds_read2st64_b32 v[16:17], v125 offset0:96 offset1:97
ds_read2st64_b32 v[18:19], v125 offset0:98 offset1:99
ds_read2st64_b32 v[20:21], v125 offset0:100 offset1:101
ds_read2st64_b32 v[22:23], v125 offset0:102 offset1:103
s_waitcnt lgkmcnt(4)
s_add_u32 m0, s28, 22528
s_add_u32 s46, s29, 2883584
buffer_load_dwordx4 v124, s[12:15], s46 offen lds
s_add_u32 m0, s28, 23552
s_add_u32 s46, s29, 2916352
buffer_load_dwordx4 v124, s[12:15], s46 offen lds
v_perm_b32 v80, v25, v24, s50
v_perm_b32 v81, v27, v26, s50
v_perm_b32 v82, v29, v28, s50
v_perm_b32 v83, v31, v30, s50
v_accvgpr_write_b32 a216, v80
v_accvgpr_write_b32 a217, v81
v_accvgpr_write_b32 a218, v82
v_accvgpr_write_b32 a219, v83
v_perm_b32 v84, v25, v24, s51
v_perm_b32 v85, v27, v26, s51
v_perm_b32 v86, v29, v28, s51
v_perm_b32 v87, v31, v30, s51
v_accvgpr_write_b32 a220, v84
v_accvgpr_write_b32 a221, v85
v_accvgpr_write_b32 a222, v86
v_accvgpr_write_b32 a223, v87
s_waitcnt vmcnt(28)
ds_read2st64_b32 v[24:25], v125 offset0:104 offset1:105
ds_read2st64_b32 v[26:27], v125 offset0:106 offset1:107
ds_read2st64_b32 v[28:29], v125 offset0:108 offset1:109
ds_read2st64_b32 v[30:31], v125 offset0:110 offset1:111
s_waitcnt lgkmcnt(4)
s_add_u32 m0, s28, 24576
s_add_u32 s46, s29, 3145728
buffer_load_dwordx4 v124, s[12:15], s46 offen lds
s_add_u32 m0, s28, 25600
s_add_u32 s46, s29, 3178496
buffer_load_dwordx4 v124, s[12:15], s46 offen lds
v_perm_b32 v80, v17, v16, s50
v_perm_b32 v81, v19, v18, s50
v_perm_b32 v82, v21, v20, s50
v_perm_b32 v83, v23, v22, s50
v_accvgpr_write_b32 a224, v80
v_accvgpr_write_b32 a225, v81
v_accvgpr_write_b32 a226, v82
v_accvgpr_write_b32 a227, v83
v_perm_b32 v84, v17, v16, s51
v_perm_b32 v85, v19, v18, s51
v_perm_b32 v86, v21, v20, s51
v_perm_b32 v87, v23, v22, s51
v_accvgpr_write_b32 a228, v84
v_accvgpr_write_b32 a229, v85
v_accvgpr_write_b32 a230, v86
v_accvgpr_write_b32 a231, v87
s_waitcnt vmcnt(28)
ds_read2st64_b32 v[16:17], v125 offset0:112 offset1:113
ds_read2st64_b32 v[18:19], v125 offset0:114 offset1:115
ds_read2st64_b32 v[20:21], v125 offset0:116 offset1:117
ds_read2st64_b32 v[22:23], v125 offset0:118 offset1:119
s_waitcnt lgkmcnt(4)
s_add_u32 m0, s28, 26624
s_add_u32 s46, s29, 3407872
buffer_load_dwordx4 v124, s[12:15], s46 offen lds
s_add_u32 m0, s28, 27648
s_add_u32 s46, s29, 3440640
buffer_load_dwordx4 v124, s[12:15], s46 offen lds
v_perm_b32 v80, v25, v24, s50
v_perm_b32 v81, v27, v26, s50
v_perm_b32 v82, v29, v28, s50
v_perm_b32 v83, v31, v30, s50
v_accvgpr_write_b32 a232, v80
v_accvgpr_write_b32 a233, v81
v_accvgpr_write_b32 a234, v82
v_accvgpr_write_b32 a235, v83
v_perm_b32 v84, v25, v24, s51
v_perm_b32 v85, v27, v26, s51
v_perm_b32 v86, v29, v28, s51
v_perm_b32 v87, v31, v30, s51
v_accvgpr_write_b32 a236, v84
v_accvgpr_write_b32 a237, v85
v_accvgpr_write_b32 a238, v86
v_accvgpr_write_b32 a239, v87
s_waitcnt vmcnt(28)
ds_read2st64_b32 v[24:25], v125 offset0:120 offset1:121
ds_read2st64_b32 v[26:27], v125 offset0:122 offset1:123
ds_read2st64_b32 v[28:29], v125 offset0:124 offset1:125
ds_read2st64_b32 v[30:31], v125 offset0:126 offset1:127
s_waitcnt lgkmcnt(4)
s_add_u32 m0, s28, 28672
s_add_u32 s46, s29, 3670016
buffer_load_dwordx4 v124, s[12:15], s46 offen lds
s_add_u32 m0, s28, 29696
s_add_u32 s46, s29, 3702784
buffer_load_dwordx4 v124, s[12:15], s46 offen lds
v_perm_b32 v80, v17, v16, s50
v_perm_b32 v81, v19, v18, s50
v_perm_b32 v82, v21, v20, s50
v_perm_b32 v83, v23, v22, s50
v_accvgpr_write_b32 a240, v80
v_accvgpr_write_b32 a241, v81
v_accvgpr_write_b32 a242, v82
v_accvgpr_write_b32 a243, v83
v_perm_b32 v84, v17, v16, s51
v_perm_b32 v85, v19, v18, s51
v_perm_b32 v86, v21, v20, s51
v_perm_b32 v87, v23, v22, s51
v_accvgpr_write_b32 a244, v84
v_accvgpr_write_b32 a245, v85
v_accvgpr_write_b32 a246, v86
v_accvgpr_write_b32 a247, v87
s_waitcnt vmcnt(28)
ds_read2st64_b32 v[16:17], v125 offset0:0 offset1:1
ds_read2st64_b32 v[18:19], v125 offset0:2 offset1:3
ds_read2st64_b32 v[20:21], v125 offset0:4 offset1:5
ds_read2st64_b32 v[22:23], v125 offset0:6 offset1:7
s_waitcnt lgkmcnt(4)
s_add_u32 m0, s28, 30720
s_add_u32 s46, s29, 3932160
buffer_load_dwordx4 v124, s[12:15], s46 offen lds
s_add_u32 m0, s28, 31744
s_add_u32 s46, s29, 3964928
buffer_load_dwordx4 v124, s[12:15], s46 offen lds
v_perm_b32 v80, v25, v24, s50
v_perm_b32 v81, v27, v26, s50
v_perm_b32 v82, v29, v28, s50
v_perm_b32 v83, v31, v30, s50
v_accvgpr_write_b32 a248, v80
v_accvgpr_write_b32 a249, v81
v_accvgpr_write_b32 a250, v82
v_accvgpr_write_b32 a251, v83
v_perm_b32 v84, v25, v24, s51
v_perm_b32 v85, v27, v26, s51
v_perm_b32 v86, v29, v28, s51
v_perm_b32 v87, v31, v30, s51
v_accvgpr_write_b32 a252, v84
v_accvgpr_write_b32 a253, v85
v_accvgpr_write_b32 a254, v86
v_accvgpr_write_b32 a255, v87
s_waitcnt vmcnt(28)
ds_read2st64_b32 v[24:25], v125 offset0:8 offset1:9
ds_read2st64_b32 v[26:27], v125 offset0:10 offset1:11
ds_read2st64_b32 v[28:29], v125 offset0:12 offset1:13
ds_read2st64_b32 v[30:31], v125 offset0:14 offset1:15
s_waitcnt lgkmcnt(4)
v_perm_b32 v128, v17, v16, s50
v_perm_b32 v129, v19, v18, s50
v_perm_b32 v130, v21, v20, s50
v_perm_b32 v131, v23, v22, s50
v_perm_b32 v132, v17, v16, s51
v_perm_b32 v133, v19, v18, s51
v_perm_b32 v134, v21, v20, s51
v_perm_b32 v135, v23, v22, s51
s_waitcnt vmcnt(26)
ds_read2st64_b32 v[16:17], v125 offset0:16 offset1:17
ds_read2st64_b32 v[18:19], v125 offset0:18 offset1:19
ds_read2st64_b32 v[20:21], v125 offset0:20 offset1:21
ds_read2st64_b32 v[22:23], v125 offset0:22 offset1:23
s_waitcnt lgkmcnt(4)
v_perm_b32 v136, v25, v24, s50
v_perm_b32 v137, v27, v26, s50
v_perm_b32 v138, v29, v28, s50
v_perm_b32 v139, v31, v30, s50
v_perm_b32 v140, v25, v24, s51
v_perm_b32 v141, v27, v26, s51
v_perm_b32 v142, v29, v28, s51
v_perm_b32 v143, v31, v30, s51
s_waitcnt vmcnt(24)
ds_read2st64_b32 v[24:25], v125 offset0:24 offset1:25
ds_read2st64_b32 v[26:27], v125 offset0:26 offset1:27
ds_read2st64_b32 v[28:29], v125 offset0:28 offset1:29
ds_read2st64_b32 v[30:31], v125 offset0:30 offset1:31
s_waitcnt lgkmcnt(4)
v_perm_b32 v144, v17, v16, s50
v_perm_b32 v145, v19, v18, s50
v_perm_b32 v146, v21, v20, s50
v_perm_b32 v147, v23, v22, s50
v_perm_b32 v148, v17, v16, s51
v_perm_b32 v149, v19, v18, s51
v_perm_b32 v150, v21, v20, s51
v_perm_b32 v151, v23, v22, s51
s_waitcnt vmcnt(22)
ds_read2st64_b32 v[16:17], v125 offset0:32 offset1:33
ds_read2st64_b32 v[18:19], v125 offset0:34 offset1:35
ds_read2st64_b32 v[20:21], v125 offset0:36 offset1:37
ds_read2st64_b32 v[22:23], v125 offset0:38 offset1:39
s_waitcnt lgkmcnt(4)
v_perm_b32 v152, v25, v24, s50
v_perm_b32 v153, v27, v26, s50
v_perm_b32 v154, v29, v28, s50
v_perm_b32 v155, v31, v30, s50
v_perm_b32 v156, v25, v24, s51
v_perm_b32 v157, v27, v26, s51
v_perm_b32 v158, v29, v28, s51
v_perm_b32 v159, v31, v30, s51
s_waitcnt vmcnt(20)
ds_read2st64_b32 v[24:25], v125 offset0:40 offset1:41
ds_read2st64_b32 v[26:27], v125 offset0:42 offset1:43
ds_read2st64_b32 v[28:29], v125 offset0:44 offset1:45
ds_read2st64_b32 v[30:31], v125 offset0:46 offset1:47
s_waitcnt lgkmcnt(4)
v_perm_b32 v160, v17, v16, s50
v_perm_b32 v161, v19, v18, s50
v_perm_b32 v162, v21, v20, s50
v_perm_b32 v163, v23, v22, s50
v_perm_b32 v164, v17, v16, s51
v_perm_b32 v165, v19, v18, s51
v_perm_b32 v166, v21, v20, s51
v_perm_b32 v167, v23, v22, s51
s_waitcnt vmcnt(18)
ds_read2st64_b32 v[16:17], v125 offset0:48 offset1:49
ds_read2st64_b32 v[18:19], v125 offset0:50 offset1:51
ds_read2st64_b32 v[20:21], v125 offset0:52 offset1:53
ds_read2st64_b32 v[22:23], v125 offset0:54 offset1:55
s_waitcnt lgkmcnt(4)
v_perm_b32 v168, v25, v24, s50
v_perm_b32 v169, v27, v26, s50
v_perm_b32 v170, v29, v28, s50
v_perm_b32 v171, v31, v30, s50
v_perm_b32 v172, v25, v24, s51
v_perm_b32 v173, v27, v26, s51
v_perm_b32 v174, v29, v28, s51
v_perm_b32 v175, v31, v30, s51
s_waitcnt vmcnt(16)
ds_read2st64_b32 v[24:25], v125 offset0:56 offset1:57
ds_read2st64_b32 v[26:27], v125 offset0:58 offset1:59
ds_read2st64_b32 v[28:29], v125 offset0:60 offset1:61
ds_read2st64_b32 v[30:31], v125 offset0:62 offset1:63
s_waitcnt lgkmcnt(4)
v_perm_b32 v176, v17, v16, s50
v_perm_b32 v177, v19, v18, s50
v_perm_b32 v178, v21, v20, s50
v_perm_b32 v179, v23, v22, s50
v_perm_b32 v180, v17, v16, s51
v_perm_b32 v181, v19, v18, s51
v_perm_b32 v182, v21, v20, s51
v_perm_b32 v183, v23, v22, s51
s_waitcnt vmcnt(14)
ds_read2st64_b32 v[16:17], v125 offset0:64 offset1:65
ds_read2st64_b32 v[18:19], v125 offset0:66 offset1:67
ds_read2st64_b32 v[20:21], v125 offset0:68 offset1:69
ds_read2st64_b32 v[22:23], v125 offset0:70 offset1:71
s_waitcnt lgkmcnt(4)
v_perm_b32 v184, v25, v24, s50
v_perm_b32 v185, v27, v26, s50
v_perm_b32 v186, v29, v28, s50
v_perm_b32 v187, v31, v30, s50
v_perm_b32 v188, v25, v24, s51
v_perm_b32 v189, v27, v26, s51
v_perm_b32 v190, v29, v28, s51
v_perm_b32 v191, v31, v30, s51
s_waitcnt vmcnt(12)
ds_read2st64_b32 v[24:25], v125 offset0:72 offset1:73
ds_read2st64_b32 v[26:27], v125 offset0:74 offset1:75
ds_read2st64_b32 v[28:29], v125 offset0:76 offset1:77
ds_read2st64_b32 v[30:31], v125 offset0:78 offset1:79
s_waitcnt lgkmcnt(4)
v_perm_b32 v192, v17, v16, s50
v_perm_b32 v193, v19, v18, s50
v_perm_b32 v194, v21, v20, s50
v_perm_b32 v195, v23, v22, s50
v_perm_b32 v196, v17, v16, s51
v_perm_b32 v197, v19, v18, s51
v_perm_b32 v198, v21, v20, s51
v_perm_b32 v199, v23, v22, s51
s_waitcnt vmcnt(10)
ds_read2st64_b32 v[16:17], v125 offset0:80 offset1:81
ds_read2st64_b32 v[18:19], v125 offset0:82 offset1:83
ds_read2st64_b32 v[20:21], v125 offset0:84 offset1:85
ds_read2st64_b32 v[22:23], v125 offset0:86 offset1:87
s_waitcnt lgkmcnt(4)
v_perm_b32 v200, v25, v24, s50
v_perm_b32 v201, v27, v26, s50
v_perm_b32 v202, v29, v28, s50
v_perm_b32 v203, v31, v30, s50
v_perm_b32 v204, v25, v24, s51
v_perm_b32 v205, v27, v26, s51
v_perm_b32 v206, v29, v28, s51
v_perm_b32 v207, v31, v30, s51
s_waitcnt vmcnt(8)
ds_read2st64_b32 v[24:25], v125 offset0:88 offset1:89
ds_read2st64_b32 v[26:27], v125 offset0:90 offset1:91
ds_read2st64_b32 v[28:29], v125 offset0:92 offset1:93
ds_read2st64_b32 v[30:31], v125 offset0:94 offset1:95
s_waitcnt lgkmcnt(4)
v_perm_b32 v208, v17, v16, s50
v_perm_b32 v209, v19, v18, s50
v_perm_b32 v210, v21, v20, s50
v_perm_b32 v211, v23, v22, s50
v_perm_b32 v212, v17, v16, s51
v_perm_b32 v213, v19, v18, s51
v_perm_b32 v214, v21, v20, s51
v_perm_b32 v215, v23, v22, s51
s_waitcnt vmcnt(6)
ds_read2st64_b32 v[16:17], v125 offset0:96 offset1:97
ds_read2st64_b32 v[18:19], v125 offset0:98 offset1:99
ds_read2st64_b32 v[20:21], v125 offset0:100 offset1:101
ds_read2st64_b32 v[22:23], v125 offset0:102 offset1:103
s_waitcnt lgkmcnt(4)
v_perm_b32 v216, v25, v24, s50
v_perm_b32 v217, v27, v26, s50
v_perm_b32 v218, v29, v28, s50
v_perm_b32 v219, v31, v30, s50
v_perm_b32 v220, v25, v24, s51
v_perm_b32 v221, v27, v26, s51
v_perm_b32 v222, v29, v28, s51
v_perm_b32 v223, v31, v30, s51
s_waitcnt vmcnt(4)
ds_read2st64_b32 v[24:25], v125 offset0:104 offset1:105
ds_read2st64_b32 v[26:27], v125 offset0:106 offset1:107
ds_read2st64_b32 v[28:29], v125 offset0:108 offset1:109
ds_read2st64_b32 v[30:31], v125 offset0:110 offset1:111
s_waitcnt lgkmcnt(4)
v_perm_b32 v224, v17, v16, s50
v_perm_b32 v225, v19, v18, s50
v_perm_b32 v226, v21, v20, s50
v_perm_b32 v227, v23, v22, s50
v_perm_b32 v228, v17, v16, s51
v_perm_b32 v229, v19, v18, s51
v_perm_b32 v230, v21, v20, s51
v_perm_b32 v231, v23, v22, s51
s_waitcnt vmcnt(2)
ds_read2st64_b32 v[16:17], v125 offset0:112 offset1:113
ds_read2st64_b32 v[18:19], v125 offset0:114 offset1:115
ds_read2st64_b32 v[20:21], v125 offset0:116 offset1:117
ds_read2st64_b32 v[22:23], v125 offset0:118 offset1:119
s_waitcnt lgkmcnt(4)
v_perm_b32 v232, v25, v24, s50
v_perm_b32 v233, v27, v26, s50
v_perm_b32 v234, v29, v28, s50
v_perm_b32 v235, v31, v30, s50
v_perm_b32 v236, v25, v24, s51
v_perm_b32 v237, v27, v26, s51
v_perm_b32 v238, v29, v28, s51
v_perm_b32 v239, v31, v30, s51
s_waitcnt vmcnt(0)
ds_read2st64_b32 v[24:25], v125 offset0:120 offset1:121
ds_read2st64_b32 v[26:27], v125 offset0:122 offset1:123
ds_read2st64_b32 v[28:29], v125 offset0:124 offset1:125
ds_read2st64_b32 v[30:31], v125 offset0:126 offset1:127
s_waitcnt lgkmcnt(4)
v_perm_b32 v240, v17, v16, s50
v_perm_b32 v241, v19, v18, s50
v_perm_b32 v242, v21, v20, s50
v_perm_b32 v243, v23, v22, s50
v_perm_b32 v244, v17, v16, s51
v_perm_b32 v245, v19, v18, s51
v_perm_b32 v246, v21, v20, s51
v_perm_b32 v247, v23, v22, s51
s_waitcnt lgkmcnt(0)
v_perm_b32 v248, v25, v24, s50
v_perm_b32 v249, v27, v26, s50
v_perm_b32 v250, v29, v28, s50
v_perm_b32 v251, v31, v30, s50
v_perm_b32 v252, v25, v24, s51
v_perm_b32 v253, v27, v26, s51
v_perm_b32 v254, v29, v28, s51
v_perm_b32 v255, v31, v30, s51
v_mov_b32 v120, -1
v_mov_b32 v121, -1
v_mov_b32 v122, -1
v_mov_b32 v123, -1
v_mov_b32 v124, 1
s_cmp_lg_u32 s18, 0
s_cbranch_scc1 L_h_cx_ok
v_mov_b32 v18, 4
L_h_cx:
global_load_dword v16, v18, s[4:5] sc1
s_waitcnt vmcnt(0)
v_cmp_gt_u32 vcc, 144, v16
s_cbranch_vccnz L_h_cx_re
L_h_cx_ok:
s_barrier
buffer_load_dwordx4 v[16:19], v1, s[8:11], s22 offen offset:0
buffer_load_dwordx4 v[20:23], v1, s[8:11], s22 offen offset:1024
buffer_load_dwordx4 v[24:27], v1, s[8:11], s22 offen offset:2048
buffer_load_dwordx4 v[28:31], v1, s[8:11], s22 offen offset:3072
s_add_u32 s22, s22, 4096
buffer_load_dwordx4 v[32:35], v1, s[8:11], s22 offen offset:0
buffer_load_dwordx4 v[36:39], v1, s[8:11], s22 offen offset:1024
buffer_load_dwordx4 v[40:43], v1, s[8:11], s22 offen offset:2048
buffer_load_dwordx4 v[44:47], v1, s[8:11], s22 offen offset:3072
s_add_u32 s22, s22, 4096
buffer_load_dwordx4 v[48:51], v1, s[8:11], s22 offen offset:0
buffer_load_dwordx4 v[52:55], v1, s[8:11], s22 offen offset:1024
buffer_load_dwordx4 v[56:59], v1, s[8:11], s22 offen offset:2048
buffer_load_dwordx4 v[60:63], v1, s[8:11], s22 offen offset:3072
s_add_u32 s22, s22, 4096
buffer_load_dwordx4 v[64:67], v1, s[8:11], s22 offen offset:0
buffer_load_dwordx4 v[68:71], v1, s[8:11], s22 offen offset:1024
buffer_load_dwordx4 v[72:75], v1, s[8:11], s22 offen offset:2048
buffer_load_dwordx4 v[76:79], v1, s[8:11], s22 offen offset:3072
s_add_u32 s22, s22, 4096
s_mov_b32 s28, 16
s_waitcnt vmcnt(0)
L_h_p1:
s_waitcnt vmcnt(20)
v_mfma_f32_16x16x32_bf16 v[80:83], a[0:3], v[16:19], 0
v_mfma_f32_16x16x32_bf16 v[84:87], a[4:7], v[16:19], 0
v_mfma_f32_16x16x32_bf16 v[88:91], a[128:131], v[16:19], 0
v_mfma_f32_16x16x32_bf16 v[92:95], a[132:135], v[16:19], 0
v_mfma_f32_16x16x32_bf16 v[96:99], v[16:19], v[128:131], 0
v_mfma_f32_16x16x32_bf16 v[100:103], v[16:19], v[132:135], 0
buffer_load_dwordx4 v[16:19], v1, s[8:11], s22 offen offset:0
s_waitcnt vmcnt(20)
v_mfma_f32_16x16x32_bf16 v[80:83], a[8:11], v[20:23], v[80:83]
v_mfma_f32_16x16x32_bf16 v[84:87], a[12:15], v[20:23], v[84:87]
v_mfma_f32_16x16x32_bf16 v[88:91], a[136:139], v[20:23], v[88:91]
v_mfma_f32_16x16x32_bf16 v[92:95], a[140:143], v[20:23], v[92:95]
v_mfma_f32_16x16x32_bf16 v[96:99], v[20:23], v[136:139], v[96:99]
v_mfma_f32_16x16x32_bf16 v[100:103], v[20:23], v[140:143], v[100:103]
buffer_load_dwordx4 v[20:23], v1, s[8:11], s22 offen offset:1024
buffer_store_dwordx4 v[120:123], v1, s[8:11], s25 offen sc1
s_add_u32 s25, s25, 114688
s_waitcnt vmcnt(20)
v_mfma_f32_16x16x32_bf16 v[80:83], a[16:19], v[24:27], v[80:83]
v_mfma_f32_16x16x32_bf16 v[84:87], a[20:23], v[24:27], v[84:87]
v_mfma_f32_16x16x32_bf16 v[88:91], a[144:147], v[24:27], v[88:91]
v_mfma_f32_16x16x32_bf16 v[92:95], a[148:151], v[24:27], v[92:95]
v_mfma_f32_16x16x32_bf16 v[96:99], v[24:27], v[144:147], v[96:99]
v_mfma_f32_16x16x32_bf16 v[100:103], v[24:27], v[148:151], v[100:103]
buffer_load_dwordx4 v[24:27], v1, s[8:11], s22 offen offset:2048
s_waitcnt vmcnt(20)
v_mfma_f32_16x16x32_bf16 v[80:83], a[24:27], v[28:31], v[80:83]
v_mfma_f32_16x16x32_bf16 v[84:87], a[28:31], v[28:31], v[84:87]
v_mfma_f32_16x16x32_bf16 v[88:91], a[152:155], v[28:31], v[88:91]
v_mfma_f32_16x16x32_bf16 v[92:95], a[156:159], v[28:31], v[92:95]
v_mfma_f32_16x16x32_bf16 v[96:99], v[28:31], v[152:155], v[96:99]
v_mfma_f32_16x16x32_bf16 v[100:103], v[28:31], v[156:159], v[100:103]
buffer_load_dwordx4 v[28:31], v1, s[8:11], s22 offen offset:3072
s_add_u32 s22, s22, 4096
s_waitcnt vmcnt(20)
v_mfma_f32_16x16x32_bf16 v[80:83], a[32:35], v[32:35], v[80:83]
v_mfma_f32_16x16x32_bf16 v[84:87], a[36:39], v[32:35], v[84:87]
v_mfma_f32_16x16x32_bf16 v[88:91], a[160:163], v[32:35], v[88:91]
v_mfma_f32_16x16x32_bf16 v[92:95], a[164:167], v[32:35], v[92:95]
v_mfma_f32_16x16x32_bf16 v[96:99], v[32:35], v[160:163], v[96:99]
v_mfma_f32_16x16x32_bf16 v[100:103], v[32:35], v[164:167], v[100:103]
buffer_load_dwordx4 v[32:35], v1, s[8:11], s22 offen offset:0
s_waitcnt vmcnt(20)
v_mfma_f32_16x16x32_bf16 v[80:83], a[40:43], v[36:39], v[80:83]
v_mfma_f32_16x16x32_bf16 v[84:87], a[44:47], v[36:39], v[84:87]
v_mfma_f32_16x16x32_bf16 v[88:91], a[168:171], v[36:39], v[88:91]
v_mfma_f32_16x16x32_bf16 v[92:95], a[172:175], v[36:39], v[92:95]
v_mfma_f32_16x16x32_bf16 v[96:99], v[36:39], v[168:171], v[96:99]
v_mfma_f32_16x16x32_bf16 v[100:103], v[36:39], v[172:175], v[100:103]
buffer_load_dwordx4 v[36:39], v1, s[8:11], s22 offen offset:1024
s_waitcnt vmcnt(20)
v_mfma_f32_16x16x32_bf16 v[80:83], a[48:51], v[40:43], v[80:83]
v_mfma_f32_16x16x32_bf16 v[84:87], a[52:55], v[40:43], v[84:87]
v_mfma_f32_16x16x32_bf16 v[88:91], a[176:179], v[40:43], v[88:91]
v_mfma_f32_16x16x32_bf16 v[92:95], a[180:183], v[40:43], v[92:95]
v_mfma_f32_16x16x32_bf16 v[96:99], v[40:43], v[176:179], v[96:99]
v_mfma_f32_16x16x32_bf16 v[100:103], v[40:43], v[180:183], v[100:103]
buffer_load_dwordx4 v[40:43], v1, s[8:11], s22 offen offset:2048
s_waitcnt vmcnt(20)
v_mfma_f32_16x16x32_bf16 v[80:83], a[56:59], v[44:47], v[80:83]
v_mfma_f32_16x16x32_bf16 v[84:87], a[60:63], v[44:47], v[84:87]
v_mfma_f32_16x16x32_bf16 v[88:91], a[184:187], v[44:47], v[88:91]
v_mfma_f32_16x16x32_bf16 v[92:95], a[188:191], v[44:47], v[92:95]
v_mfma_f32_16x16x32_bf16 v[96:99], v[44:47], v[184:187], v[96:99]
v_mfma_f32_16x16x32_bf16 v[100:103], v[44:47], v[188:191], v[100:103]
buffer_load_dwordx4 v[44:47], v1, s[8:11], s22 offen offset:3072
s_add_u32 s22, s22, 4096
s_waitcnt vmcnt(20)
v_mfma_f32_16x16x32_bf16 v[80:83], a[64:67], v[48:51], v[80:83]
v_mfma_f32_16x16x32_bf16 v[84:87], a[68:71], v[48:51], v[84:87]
v_mfma_f32_16x16x32_bf16 v[88:91], a[192:195], v[48:51], v[88:91]
v_mfma_f32_16x16x32_bf16 v[92:95], a[196:199], v[48:51], v[92:95]
v_mfma_f32_16x16x32_bf16 v[96:99], v[48:51], v[192:195], v[96:99]
v_mfma_f32_16x16x32_bf16 v[100:103], v[48:51], v[196:199], v[100:103]
buffer_load_dwordx4 v[48:51], v1, s[8:11], s22 offen offset:0
s_waitcnt vmcnt(20)
v_mfma_f32_16x16x32_bf16 v[80:83], a[72:75], v[52:55], v[80:83]
v_mfma_f32_16x16x32_bf16 v[84:87], a[76:79], v[52:55], v[84:87]
v_mfma_f32_16x16x32_bf16 v[88:91], a[200:203], v[52:55], v[88:91]
v_mfma_f32_16x16x32_bf16 v[92:95], a[204:207], v[52:55], v[92:95]
v_mfma_f32_16x16x32_bf16 v[96:99], v[52:55], v[200:203], v[96:99]
v_mfma_f32_16x16x32_bf16 v[100:103], v[52:55], v[204:207], v[100:103]
buffer_load_dwordx4 v[52:55], v1, s[8:11], s22 offen offset:1024
s_waitcnt vmcnt(20)
v_mfma_f32_16x16x32_bf16 v[80:83], a[80:83], v[56:59], v[80:83]
v_mfma_f32_16x16x32_bf16 v[84:87], a[84:87], v[56:59], v[84:87]
v_mfma_f32_16x16x32_bf16 v[88:91], a[208:211], v[56:59], v[88:91]
v_mfma_f32_16x16x32_bf16 v[92:95], a[212:215], v[56:59], v[92:95]
v_mfma_f32_16x16x32_bf16 v[96:99], v[56:59], v[208:211], v[96:99]
v_mfma_f32_16x16x32_bf16 v[100:103], v[56:59], v[212:215], v[100:103]
buffer_load_dwordx4 v[56:59], v1, s[8:11], s22 offen offset:2048
s_waitcnt vmcnt(20)
v_mfma_f32_16x16x32_bf16 v[80:83], a[88:91], v[60:63], v[80:83]
v_mfma_f32_16x16x32_bf16 v[84:87], a[92:95], v[60:63], v[84:87]
v_mfma_f32_16x16x32_bf16 v[88:91], a[216:219], v[60:63], v[88:91]
v_mfma_f32_16x16x32_bf16 v[92:95], a[220:223], v[60:63], v[92:95]
v_mfma_f32_16x16x32_bf16 v[96:99], v[60:63], v[216:219], v[96:99]
v_mfma_f32_16x16x32_bf16 v[100:103], v[60:63], v[220:223], v[100:103]
buffer_load_dwordx4 v[60:63], v1, s[8:11], s22 offen offset:3072
s_add_u32 s22, s22, 4096
s_waitcnt vmcnt(20)
v_mfma_f32_16x16x32_bf16 v[80:83], a[96:99], v[64:67], v[80:83]
v_mfma_f32_16x16x32_bf16 v[84:87], a[100:103], v[64:67], v[84:87]
v_mfma_f32_16x16x32_bf16 v[88:91], a[224:227], v[64:67], v[88:91]
v_mfma_f32_16x16x32_bf16 v[92:95], a[228:231], v[64:67], v[92:95]
v_mfma_f32_16x16x32_bf16 v[96:99], v[64:67], v[224:227], v[96:99]
v_mfma_f32_16x16x32_bf16 v[100:103], v[64:67], v[228:231], v[100:103]
buffer_load_dwordx4 v[64:67], v1, s[8:11], s22 offen offset:0
s_waitcnt vmcnt(20)
v_mfma_f32_16x16x32_bf16 v[80:83], a[104:107], v[68:71], v[80:83]
v_mfma_f32_16x16x32_bf16 v[84:87], a[108:111], v[68:71], v[84:87]
v_mfma_f32_16x16x32_bf16 v[88:91], a[232:235], v[68:71], v[88:91]
v_mfma_f32_16x16x32_bf16 v[92:95], a[236:239], v[68:71], v[92:95]
v_mfma_f32_16x16x32_bf16 v[96:99], v[68:71], v[232:235], v[96:99]
v_mfma_f32_16x16x32_bf16 v[100:103], v[68:71], v[236:239], v[100:103]
buffer_load_dwordx4 v[68:71], v1, s[8:11], s22 offen offset:1024
s_waitcnt vmcnt(20)
v_mfma_f32_16x16x32_bf16 v[80:83], a[112:115], v[72:75], v[80:83]
v_mfma_f32_16x16x32_bf16 v[84:87], a[116:119], v[72:75], v[84:87]
v_mfma_f32_16x16x32_bf16 v[88:91], a[240:243], v[72:75], v[88:91]
v_mfma_f32_16x16x32_bf16 v[92:95], a[244:247], v[72:75], v[92:95]
v_mfma_f32_16x16x32_bf16 v[96:99], v[72:75], v[240:243], v[96:99]
v_mfma_f32_16x16x32_bf16 v[100:103], v[72:75], v[244:247], v[100:103]
buffer_load_dwordx4 v[72:75], v1, s[8:11], s22 offen offset:2048
s_waitcnt vmcnt(20)
v_mfma_f32_16x16x32_bf16 v[80:83], a[120:123], v[76:79], v[80:83]
v_mfma_f32_16x16x32_bf16 v[84:87], a[124:127], v[76:79], v[84:87]
v_mfma_f32_16x16x32_bf16 v[88:91], a[248:251], v[76:79], v[88:91]
v_mfma_f32_16x16x32_bf16 v[92:95], a[252:255], v[76:79], v[92:95]
v_mfma_f32_16x16x32_bf16 v[96:99], v[76:79], v[248:251], v[96:99]
v_mfma_f32_16x16x32_bf16 v[100:103], v[76:79], v[252:255], v[100:103]
buffer_load_dwordx4 v[76:79], v1, s[8:11], s22 offen offset:3072
s_add_u32 s22, s22, 102400
v_cvt_pk_bf16_f32 v104, v80, v84
v_cvt_pk_bf16_f32 v105, v81, v85
v_cvt_pk_bf16_f32 v106, v82, v86
v_cvt_pk_bf16_f32 v107, v83, v87
buffer_store_dwordx4 v[104:107], v1, s[8:11], s23 offen offset:0
v_cvt_pk_bf16_f32 v108, v88, v92
v_cvt_pk_bf16_f32 v109, v89, v93
v_cvt_pk_bf16_f32 v110, v90, v94
v_cvt_pk_bf16_f32 v111, v91, v95
buffer_store_dwordx4 v[108:111], v1, s[8:11], s24 offen offset:0 sc1
v_cvt_pk_bf16_f32 v112, v96, v97
v_cvt_pk_bf16_f32 v113, v98, v99
v_cvt_pk_bf16_f32 v116, v100, v101
v_cvt_pk_bf16_f32 v117, v102, v103
s_waitcnt vmcnt(18)
v_mfma_f32_16x16x32_bf16 v[80:83], a[0:3], v[16:19], 0
v_mfma_f32_16x16x32_bf16 v[84:87], a[4:7], v[16:19], 0
v_mfma_f32_16x16x32_bf16 v[88:91], a[128:131], v[16:19], 0
v_mfma_f32_16x16x32_bf16 v[92:95], a[132:135], v[16:19], 0
v_mfma_f32_16x16x32_bf16 v[96:99], v[16:19], v[128:131], 0
v_mfma_f32_16x16x32_bf16 v[100:103], v[16:19], v[132:135], 0
buffer_load_dwordx4 v[16:19], v1, s[8:11], s22 offen offset:0
s_waitcnt vmcnt(18)
v_mfma_f32_16x16x32_bf16 v[80:83], a[8:11], v[20:23], v[80:83]
v_mfma_f32_16x16x32_bf16 v[84:87], a[12:15], v[20:23], v[84:87]
v_mfma_f32_16x16x32_bf16 v[88:91], a[136:139], v[20:23], v[88:91]
v_mfma_f32_16x16x32_bf16 v[92:95], a[140:143], v[20:23], v[92:95]
v_mfma_f32_16x16x32_bf16 v[96:99], v[20:23], v[136:139], v[96:99]
v_mfma_f32_16x16x32_bf16 v[100:103], v[20:23], v[140:143], v[100:103]
buffer_load_dwordx4 v[20:23], v1, s[8:11], s22 offen offset:1024
s_mov_b64 exec, 1
buffer_store_byte v124, off, s[8:11], s27 sc1
s_mov_b64 exec, -1
s_mov_b32 s27, s26
s_add_u32 s26, s26, 16
s_waitcnt vmcnt(18)
v_mfma_f32_16x16x32_bf16 v[80:83], a[16:19], v[24:27], v[80:83]
v_mfma_f32_16x16x32_bf16 v[84:87], a[20:23], v[24:27], v[84:87]
v_mfma_f32_16x16x32_bf16 v[88:91], a[144:147], v[24:27], v[88:91]
v_mfma_f32_16x16x32_bf16 v[92:95], a[148:151], v[24:27], v[92:95]
v_mfma_f32_16x16x32_bf16 v[96:99], v[24:27], v[144:147], v[96:99]
v_mfma_f32_16x16x32_bf16 v[100:103], v[24:27], v[148:151], v[100:103]
buffer_load_dwordx4 v[24:27], v1, s[8:11], s22 offen offset:2048
s_waitcnt vmcnt(18)
v_mfma_f32_16x16x32_bf16 v[80:83], a[24:27], v[28:31], v[80:83]
v_mfma_f32_16x16x32_bf16 v[84:87], a[28:31], v[28:31], v[84:87]
v_mfma_f32_16x16x32_bf16 v[88:91], a[152:155], v[28:31], v[88:91]
v_mfma_f32_16x16x32_bf16 v[92:95], a[156:159], v[28:31], v[92:95]
v_mfma_f32_16x16x32_bf16 v[96:99], v[28:31], v[152:155], v[96:99]
v_mfma_f32_16x16x32_bf16 v[100:103], v[28:31], v[156:159], v[100:103]
buffer_load_dwordx4 v[28:31], v1, s[8:11], s22 offen offset:3072
s_add_u32 s22, s22, 4096
s_waitcnt vmcnt(18)
v_mfma_f32_16x16x32_bf16 v[80:83], a[32:35], v[32:35], v[80:83]
v_mfma_f32_16x16x32_bf16 v[84:87], a[36:39], v[32:35], v[84:87]
v_mfma_f32_16x16x32_bf16 v[88:91], a[160:163], v[32:35], v[88:91]
v_mfma_f32_16x16x32_bf16 v[92:95], a[164:167], v[32:35], v[92:95]
v_mfma_f32_16x16x32_bf16 v[96:99], v[32:35], v[160:163], v[96:99]
v_mfma_f32_16x16x32_bf16 v[100:103], v[32:35], v[164:167], v[100:103]
buffer_load_dwordx4 v[32:35], v1, s[8:11], s22 offen offset:0
s_waitcnt vmcnt(18)
v_mfma_f32_16x16x32_bf16 v[80:83], a[40:43], v[36:39], v[80:83]
v_mfma_f32_16x16x32_bf16 v[84:87], a[44:47], v[36:39], v[84:87]
v_mfma_f32_16x16x32_bf16 v[88:91], a[168:171], v[36:39], v[88:91]
v_mfma_f32_16x16x32_bf16 v[92:95], a[172:175], v[36:39], v[92:95]
v_mfma_f32_16x16x32_bf16 v[96:99], v[36:39], v[168:171], v[96:99]
v_mfma_f32_16x16x32_bf16 v[100:103], v[36:39], v[172:175], v[100:103]
buffer_load_dwordx4 v[36:39], v1, s[8:11], s22 offen offset:1024
s_waitcnt vmcnt(18)
v_mfma_f32_16x16x32_bf16 v[80:83], a[48:51], v[40:43], v[80:83]
v_mfma_f32_16x16x32_bf16 v[84:87], a[52:55], v[40:43], v[84:87]
v_mfma_f32_16x16x32_bf16 v[88:91], a[176:179], v[40:43], v[88:91]
v_mfma_f32_16x16x32_bf16 v[92:95], a[180:183], v[40:43], v[92:95]
v_mfma_f32_16x16x32_bf16 v[96:99], v[40:43], v[176:179], v[96:99]
v_mfma_f32_16x16x32_bf16 v[100:103], v[40:43], v[180:183], v[100:103]
buffer_load_dwordx4 v[40:43], v1, s[8:11], s22 offen offset:2048
s_waitcnt vmcnt(18)
v_mfma_f32_16x16x32_bf16 v[80:83], a[56:59], v[44:47], v[80:83]
v_mfma_f32_16x16x32_bf16 v[84:87], a[60:63], v[44:47], v[84:87]
v_mfma_f32_16x16x32_bf16 v[88:91], a[184:187], v[44:47], v[88:91]
v_mfma_f32_16x16x32_bf16 v[92:95], a[188:191], v[44:47], v[92:95]
v_mfma_f32_16x16x32_bf16 v[96:99], v[44:47], v[184:187], v[96:99]
v_mfma_f32_16x16x32_bf16 v[100:103], v[44:47], v[188:191], v[100:103]
buffer_load_dwordx4 v[44:47], v1, s[8:11], s22 offen offset:3072
s_add_u32 s22, s22, 4096
s_waitcnt vmcnt(18)
v_mfma_f32_16x16x32_bf16 v[80:83], a[64:67], v[48:51], v[80:83]
v_mfma_f32_16x16x32_bf16 v[84:87], a[68:71], v[48:51], v[84:87]
v_mfma_f32_16x16x32_bf16 v[88:91], a[192:195], v[48:51], v[88:91]
v_mfma_f32_16x16x32_bf16 v[92:95], a[196:199], v[48:51], v[92:95]
v_mfma_f32_16x16x32_bf16 v[96:99], v[48:51], v[192:195], v[96:99]
v_mfma_f32_16x16x32_bf16 v[100:103], v[48:51], v[196:199], v[100:103]
buffer_load_dwordx4 v[48:51], v1, s[8:11], s22 offen offset:0
s_waitcnt vmcnt(18)
v_mfma_f32_16x16x32_bf16 v[80:83], a[72:75], v[52:55], v[80:83]
v_mfma_f32_16x16x32_bf16 v[84:87], a[76:79], v[52:55], v[84:87]
v_mfma_f32_16x16x32_bf16 v[88:91], a[200:203], v[52:55], v[88:91]
v_mfma_f32_16x16x32_bf16 v[92:95], a[204:207], v[52:55], v[92:95]
v_mfma_f32_16x16x32_bf16 v[96:99], v[52:55], v[200:203], v[96:99]
v_mfma_f32_16x16x32_bf16 v[100:103], v[52:55], v[204:207], v[100:103]
buffer_load_dwordx4 v[52:55], v1, s[8:11], s22 offen offset:1024
s_waitcnt vmcnt(18)
v_mfma_f32_16x16x32_bf16 v[80:83], a[80:83], v[56:59], v[80:83]
v_mfma_f32_16x16x32_bf16 v[84:87], a[84:87], v[56:59], v[84:87]
v_mfma_f32_16x16x32_bf16 v[88:91], a[208:211], v[56:59], v[88:91]
v_mfma_f32_16x16x32_bf16 v[92:95], a[212:215], v[56:59], v[92:95]
v_mfma_f32_16x16x32_bf16 v[96:99], v[56:59], v[208:211], v[96:99]
v_mfma_f32_16x16x32_bf16 v[100:103], v[56:59], v[212:215], v[100:103]
buffer_load_dwordx4 v[56:59], v1, s[8:11], s22 offen offset:2048
s_waitcnt vmcnt(18)
v_mfma_f32_16x16x32_bf16 v[80:83], a[88:91], v[60:63], v[80:83]
v_mfma_f32_16x16x32_bf16 v[84:87], a[92:95], v[60:63], v[84:87]
v_mfma_f32_16x16x32_bf16 v[88:91], a[216:219], v[60:63], v[88:91]
v_mfma_f32_16x16x32_bf16 v[92:95], a[220:223], v[60:63], v[92:95]
v_mfma_f32_16x16x32_bf16 v[96:99], v[60:63], v[216:219], v[96:99]
v_mfma_f32_16x16x32_bf16 v[100:103], v[60:63], v[220:223], v[100:103]
buffer_load_dwordx4 v[60:63], v1, s[8:11], s22 offen offset:3072
s_add_u32 s22, s22, 4096
s_waitcnt vmcnt(18)
v_mfma_f32_16x16x32_bf16 v[80:83], a[96:99], v[64:67], v[80:83]
v_mfma_f32_16x16x32_bf16 v[84:87], a[100:103], v[64:67], v[84:87]
v_mfma_f32_16x16x32_bf16 v[88:91], a[224:227], v[64:67], v[88:91]
v_mfma_f32_16x16x32_bf16 v[92:95], a[228:231], v[64:67], v[92:95]
v_mfma_f32_16x16x32_bf16 v[96:99], v[64:67], v[224:227], v[96:99]
v_mfma_f32_16x16x32_bf16 v[100:103], v[64:67], v[228:231], v[100:103]
buffer_load_dwordx4 v[64:67], v1, s[8:11], s22 offen offset:0
s_waitcnt vmcnt(18)
v_mfma_f32_16x16x32_bf16 v[80:83], a[104:107], v[68:71], v[80:83]
v_mfma_f32_16x16x32_bf16 v[84:87], a[108:111], v[68:71], v[84:87]
v_mfma_f32_16x16x32_bf16 v[88:91], a[232:235], v[68:71], v[88:91]
v_mfma_f32_16x16x32_bf16 v[92:95], a[236:239], v[68:71], v[92:95]
v_mfma_f32_16x16x32_bf16 v[96:99], v[68:71], v[232:235], v[96:99]
v_mfma_f32_16x16x32_bf16 v[100:103], v[68:71], v[236:239], v[100:103]
buffer_load_dwordx4 v[68:71], v1, s[8:11], s22 offen offset:1024
s_waitcnt vmcnt(18)
v_mfma_f32_16x16x32_bf16 v[80:83], a[112:115], v[72:75], v[80:83]
v_mfma_f32_16x16x32_bf16 v[84:87], a[116:119], v[72:75], v[84:87]
v_mfma_f32_16x16x32_bf16 v[88:91], a[240:243], v[72:75], v[88:91]
v_mfma_f32_16x16x32_bf16 v[92:95], a[244:247], v[72:75], v[92:95]
v_mfma_f32_16x16x32_bf16 v[96:99], v[72:75], v[240:243], v[96:99]
v_mfma_f32_16x16x32_bf16 v[100:103], v[72:75], v[244:247], v[100:103]
buffer_load_dwordx4 v[72:75], v1, s[8:11], s22 offen offset:2048
s_waitcnt vmcnt(18)
v_mfma_f32_16x16x32_bf16 v[80:83], a[120:123], v[76:79], v[80:83]
v_mfma_f32_16x16x32_bf16 v[84:87], a[124:127], v[76:79], v[84:87]
v_mfma_f32_16x16x32_bf16 v[88:91], a[248:251], v[76:79], v[88:91]
v_mfma_f32_16x16x32_bf16 v[92:95], a[252:255], v[76:79], v[92:95]
v_mfma_f32_16x16x32_bf16 v[96:99], v[76:79], v[248:251], v[96:99]
v_mfma_f32_16x16x32_bf16 v[100:103], v[76:79], v[252:255], v[100:103]
buffer_load_dwordx4 v[76:79], v1, s[8:11], s22 offen offset:3072
s_add_u32 s22, s22, 4096
v_cvt_pk_bf16_f32 v104, v80, v84
v_cvt_pk_bf16_f32 v105, v81, v85
v_cvt_pk_bf16_f32 v106, v82, v86
v_cvt_pk_bf16_f32 v107, v83, v87
buffer_store_dwordx4 v[104:107], v1, s[8:11], s23 offen offset:1024
v_cvt_pk_bf16_f32 v108, v88, v92
v_cvt_pk_bf16_f32 v109, v89, v93
v_cvt_pk_bf16_f32 v110, v90, v94
v_cvt_pk_bf16_f32 v111, v91, v95
buffer_store_dwordx4 v[108:111], v1, s[8:11], s24 offen offset:1024 sc1
v_cvt_pk_bf16_f32 v114, v96, v97
v_cvt_pk_bf16_f32 v115, v98, v99
v_cvt_pk_bf16_f32 v118, v100, v101
v_cvt_pk_bf16_f32 v119, v102, v103
buffer_store_dwordx4 v[112:115], v1, s[8:11], s24 offen offset:2048 sc1
buffer_store_dwordx4 v[116:119], v1, s[8:11], s24 offen offset:3072 sc1
s_add_u32 s23, s23, 114688
s_add_u32 s24, s24, 114688
s_sub_u32 s28, s28, 1
s_cmp_lg_u32 s28, 0
s_cbranch_scc1 L_h_p1
s_waitcnt vmcnt(0)
s_mov_b64 exec, 1
buffer_store_byte v124, off, s[8:11], s27 sc1
s_mov_b64 exec, -1
s_barrier
s_and_b32 s32, s18, 1
s_lshr_b32 s33, s18, 1
s_mul_i32 s46, s20, 2101248
s_mul_i32 s47, s21, 28672
s_add_u32 s46, s46, s47
s_add_u32 s46, s46, 16805888
s_lshl_b32 s23, s32, 10
s_add_u32 s23, s23, s46
s_add_u32 s23, s23, 20480
s_mov_b32 s24, s46
s_lshl_b32 s25, s18, 10
s_add_u32 s25, s25, s46
s_add_u32 s25, s25, 16384
s_lshl_b32 s46, s21, 1
s_add_u32 s46, s46, s32
s_lshl_b32 s47, s20, 1
s_add_u32 s47, s47, s33
s_mul_i32 s30, s46, 180224
s_lshl_b32 s48, s47, 11
s_add_u32 s30, s30, s48
s_add_u32 s30, s30, 100663296
s_lshl_b32 s31, s46, 8
s_lshl_b32 s48, s47, 2
s_add_u32 s31, s31, s48
s_add_u32 s31, s31, 98304
s_mov_b32 s52, 1035273459
s_mov_b32 s53, 1069066811
v_lshrrev_b32 v153, 2, v3
v_and_b32 v154, 3, v3
v_lshlrev_b32 v5, 7, v153
v_lshl_add_u32 v5, v2, 5, v5
v_lshl_add_u32 v5, v154, 2, v5
s_lshl_b32 s46, s18, 9
v_add_u32 v5, s46, v5
v_lshl_add_u32 v7, v4, 3, s46
s_lshl_b32 s46, s33, 10
v_lshl_add_u32 v8, v4, 3, s46
v_and_b32 v152, 1, v3
v_lshlrev_b32 v152, 4, v152
v_lshl_add_u32 v152, v153, 5, v152
v_lshl_add_u32 v6, v2, 7, v152
v_lshl_add_u32 v154, v153, 3, v154
s_lshl_b32 s46, s32, 2
v_add_u32 v154, s46, v154
v_lshlrev_b32 v153, 3, v2
v_sub_u32 v154, v154, v153
v_cmp_le_i32 s[84:85], 0, v154
v_cmp_le_i32 s[86:87], 1, v154
v_cmp_le_i32 s[88:89], 2, v154
v_cmp_le_i32 s[90:91], 3, v154
v_cmp_le_i32 s[92:93], 4, v154
v_cmp_le_i32 s[94:95], 5, v154
v_cmp_le_i32 s[96:97], 6, v154
v_cmp_le_i32 s[98:99], 7, v154
v_mov_b32 v155, 3463342888
v_mov_b32 v121, 0
v_mov_b32 v122, 0
s_mov_b32 s28, 16
L_h_p2:
s_add_u32 s46, s23, 0
buffer_load_dwordx4 v[16:19], v1, s[8:11], s46 offen offset:0
s_add_u32 s47, s24, 0
buffer_load_dwordx4 v[32:35], v1, s[8:11], s47 offen offset:0
buffer_load_dwordx4 v[36:39], v1, s[8:11], s47 offen offset:1024
buffer_load_dwordx4 v[20:23], v1, s[8:11], s46 offen offset:2048
s_add_u32 s47, s24, 4096
buffer_load_dwordx4 v[40:43], v1, s[8:11], s47 offen offset:0
buffer_load_dwordx4 v[44:47], v1, s[8:11], s47 offen offset:1024
s_add_u32 s46, s23, 4096
buffer_load_dwordx4 v[24:27], v1, s[8:11], s46 offen offset:0
s_add_u32 s47, s24, 8192
buffer_load_dwordx4 v[48:51], v1, s[8:11], s47 offen offset:0
buffer_load_dwordx4 v[52:55], v1, s[8:11], s47 offen offset:1024
buffer_load_dwordx4 v[28:31], v1, s[8:11], s46 offen offset:2048
s_add_u32 s47, s24, 12288
buffer_load_dwordx4 v[56:59], v1, s[8:11], s47 offen offset:0
buffer_load_dwordx4 v[60:63], v1, s[8:11], s47 offen offset:1024
s_lshl_b32 s46, s33, 13
s_add_u32 s46, s46, s24
s_add_u32 s47, s46, 4096
buffer_load_dwordx4 v[64:67], v1, s[8:11], s46 offen offset:2048
buffer_load_dwordx4 v[68:71], v1, s[8:11], s46 offen offset:3072
buffer_load_dwordx4 v[72:75], v1, s[8:11], s47 offen offset:2048
buffer_load_dwordx4 v[76:79], v1, s[8:11], s47 offen offset:3072
s_waitcnt vmcnt(13)
v_mfma_f32_16x16x32_bf16 v[80:83], v[32:35], v[16:19], 0
v_mfma_f32_16x16x32_bf16 v[84:87], v[36:39], v[16:19], 0
s_waitcnt vmcnt(10)
v_mfma_f32_16x16x32_bf16 v[80:83], v[40:43], v[20:23], v[80:83]
v_mfma_f32_16x16x32_bf16 v[84:87], v[44:47], v[20:23], v[84:87]
s_waitcnt vmcnt(7)
v_mfma_f32_16x16x32_bf16 v[80:83], v[48:51], v[24:27], v[80:83]
v_mfma_f32_16x16x32_bf16 v[84:87], v[52:55], v[24:27], v[84:87]
s_waitcnt vmcnt(4)
v_mfma_f32_16x16x32_bf16 v[80:83], v[56:59], v[28:31], v[80:83]
v_mfma_f32_16x16x32_bf16 v[84:87], v[60:63], v[28:31], v[84:87]
s_nop 6
v_cvt_pk_bf16_f32 v80, 0, v80
v_cvt_pk_bf16_f32 v81, 0, v81
v_cvt_pk_bf16_f32 v82, 0, v82
v_cvt_pk_bf16_f32 v83, 0, v83
v_cvt_pk_bf16_f32 v84, 0, v84
v_cvt_pk_bf16_f32 v85, 0, v85
v_cvt_pk_bf16_f32 v86, 0, v86
v_cvt_pk_bf16_f32 v87, 0, v87
v_mul_f32 v80, s52, v80
v_mul_f32 v81, s52, v81
v_mul_f32 v82, s52, v82
v_mul_f32 v83, s52, v83
v_mul_f32 v84, s52, v84
v_mul_f32 v85, s52, v85
v_mul_f32 v86, s52, v86
v_mul_f32 v87, s52, v87
v_cvt_pk_bf16_f32 v80, 0, v80
v_cvt_pk_bf16_f32 v81, 0, v81
v_cvt_pk_bf16_f32 v82, 0, v82
v_cvt_pk_bf16_f32 v83, 0, v83
v_cvt_pk_bf16_f32 v84, 0, v84
v_cvt_pk_bf16_f32 v85, 0, v85
v_cvt_pk_bf16_f32 v86, 0, v86
v_cvt_pk_bf16_f32 v87, 0, v87
v_cndmask_b32 v80, v155, v80, s[84:85]
v_cndmask_b32 v81, v155, v81, s[86:87]
v_cndmask_b32 v82, v155, v82, s[88:89]
v_cndmask_b32 v83, v155, v83, s[90:91]
v_cndmask_b32 v84, v155, v84, s[92:93]
v_cndmask_b32 v85, v155, v85, s[94:95]
v_cndmask_b32 v86, v155, v86, s[96:97]
v_cndmask_b32 v87, v155, v87, s[98:99]
v_max3_f32 v152, v80, v81, v82
v_max3_f32 v152, v152, v83, v84
v_max3_f32 v152, v152, v85, v86
v_max_f32 v152, v152, v87
L_h_km:
buffer_load_dwordx4 v[112:115], v1, s[8:11], s25 offen sc1
s_waitcnt vmcnt(0)
v_max3_u32 v153, v112, v113, v114
v_max_u32 v153, v153, v115
v_cmp_eq_u32 vcc, -1, v153
s_cbranch_vccnz L_h_km_re
L_h_km_ok:
ds_write2_b32 v5, v112, v113 offset0:0 offset1:4
ds_write_b64 v7, v[114:115] offset:2048
s_waitcnt lgkmcnt(0)
s_barrier
ds_read_b128 v[92:95], v6 offset:0
ds_read_b128 v[96:99], v6 offset:512
ds_read_b128 v[100:103], v6 offset:1024
ds_read_b128 v[104:107], v6 offset:1536
ds_read_b64 v[108:109], v8 offset:2048
ds_read_b64 v[110:111], v8 offset:2560
v_xor_b32 v5, 4096, v5
v_xor_b32 v6, 4096, v6
v_xor_b32 v7, 4096, v7
v_xor_b32 v8, 4096, v8
s_waitcnt lgkmcnt(5)
v_mfma_f32_16x16x32_bf16 v[88:91], v[92:95], v[16:19], 0
s_waitcnt lgkmcnt(4)
v_mfma_f32_16x16x32_bf16 v[88:91], v[96:99], v[20:23], v[88:91]
s_waitcnt lgkmcnt(3)
v_mfma_f32_16x16x32_bf16 v[88:91], v[100:103], v[24:27], v[88:91]
s_waitcnt lgkmcnt(2)
v_mfma_f32_16x16x32_bf16 v[88:91], v[104:107], v[28:31], v[88:91]
s_nop 7
v_cvt_pk_bf16_f32 v88, 0, v88
v_cvt_pk_bf16_f32 v89, 0, v89
v_mul_f32 v88, s52, v88
v_mul_f32 v89, s52, v89
v_cvt_pk_bf16_f32 v88, 0, v88
v_cvt_pk_bf16_f32 v89, 0, v89
v_max3_f32 v152, v152, v88, v89
v_mov_b32 v153, v152
s_nop 1
v_permlane16_swap_b32 v153, v152
v_max_f32 v152, v152, v153
v_mov_b32 v153, v152
s_nop 1
v_permlane32_swap_b32 v153, v152
v_max_f32 v152, v152, v153
v_mul_f32 v152, s53, v152
v_fma_f32 v80, v80, s53, -v152
v_fma_f32 v81, v81, s53, -v152
v_fma_f32 v82, v82, s53, -v152
v_fma_f32 v83, v83, s53, -v152
v_fma_f32 v84, v84, s53, -v152
v_fma_f32 v85, v85, s53, -v152
v_fma_f32 v86, v86, s53, -v152
v_fma_f32 v87, v87, s53, -v152
v_fma_f32 v88, v88, s53, -v152
v_fma_f32 v89, v89, s53, -v152
v_exp_f32 v80, v80
v_exp_f32 v81, v81
v_exp_f32 v82, v82
v_exp_f32 v83, v83
v_exp_f32 v84, v84
v_exp_f32 v85, v85
v_exp_f32 v86, v86
v_exp_f32 v87, v87
v_exp_f32 v88, v88
v_exp_f32 v89, v89
v_add_f32 v154, v80, v81
v_add_f32 v154, v154, v82
v_add_f32 v154, v154, v83
v_add_f32 v154, v154, v84
v_add_f32 v154, v154, v85
v_add_f32 v154, v154, v86
v_add_f32 v154, v154, v87
v_add_f32 v154, v154, v88
v_add_f32 v154, v154, v89
v_mov_b32 v153, v154
s_nop 1
v_permlane16_swap_b32 v153, v154
v_add_f32 v154, v154, v153
v_mov_b32 v153, v154
s_nop 1
v_permlane32_swap_b32 v153, v154
v_add_f32 v154, v154, v153
v_rcp_f32 v153, v154
s_nop 0
v_mul_f32 v80, v80, v153
v_mul_f32 v81, v81, v153
v_mul_f32 v82, v82, v153
v_mul_f32 v83, v83, v153
v_mul_f32 v84, v84, v153
v_mul_f32 v85, v85, v153
v_mul_f32 v86, v86, v153
v_mul_f32 v87, v87, v153
v_mul_f32 v88, v88, v153
v_mul_f32 v89, v89, v153
v_cvt_pk_bf16_f32 v116, v80, v81
v_cvt_pk_bf16_f32 v117, v82, v83
v_cvt_pk_bf16_f32 v118, v84, v85
v_cvt_pk_bf16_f32 v119, v86, v87
v_cvt_pk_bf16_f32 v120, v88, v89
v_cvt_pk_bf16_f32 v123, v88, v89
v_mfma_f32_16x16x32_bf16 v[128:131], v[64:67], v[116:119], 0
v_mfma_f32_16x16x32_bf16 v[132:135], v[68:71], v[116:119], 0
v_mfma_f32_16x16x32_bf16 v[136:139], v[72:75], v[116:119], 0
v_mfma_f32_16x16x32_bf16 v[140:143], v[76:79], v[116:119], 0
s_waitcnt lgkmcnt(0)
v_mfma_f32_16x16x16_bf16 v[128:131], v[108:109], v[120:121], v[128:131]
v_mfma_f32_16x16x16_bf16 v[132:135], v[108:109], v[122:123], v[132:135]
v_mfma_f32_16x16x16_bf16 v[136:139], v[110:111], v[120:121], v[136:139]
v_mfma_f32_16x16x16_bf16 v[140:143], v[110:111], v[122:123], v[140:143]
s_nop 4
v_cvt_pk_bf16_f32 v144, v128, v132
v_cvt_pk_bf16_f32 v145, v129, v133
v_cvt_pk_bf16_f32 v146, v130, v134
v_cvt_pk_bf16_f32 v147, v131, v135
buffer_store_dwordx4 v[144:147], v1, s[8:11], s30 offen offset:0 sc1
v_cvt_pk_bf16_f32 v148, v136, v140
v_cvt_pk_bf16_f32 v149, v137, v141
v_cvt_pk_bf16_f32 v150, v138, v142
v_cvt_pk_bf16_f32 v151, v139, v143
buffer_store_dwordx4 v[148:151], v1, s[8:11], s30 offen offset:1024 sc1
s_waitcnt vmcnt(0)
s_mov_b64 exec, 1
buffer_store_dword v124, off, s[8:11], s31 sc1
s_mov_b64 exec, -1
s_add_u32 s23, s23, 114688
s_add_u32 s24, s24, 114688
s_add_u32 s25, s25, 114688
s_add_u32 s30, s30, 1441792
s_add_u32 s31, s31, 2048
s_sub_u32 s28, s28, 1
s_cmp_lg_u32 s28, 0
s_cbranch_scc1 L_h_p2
s_endpgm
L_h_cx_re:
s_nop 15
s_nop 15
s_nop 15
s_nop 15
s_nop 15
s_nop 15
s_nop 15
s_nop 15
s_nop 15
s_nop 15
s_nop 15
s_nop 15
s_nop 15
s_nop 15
s_nop 15
s_nop 15
s_sub_u32 s36, s36, 1
s_cbranch_scc0 L_h_cx
s_mov_b32 s36, 0
s_branch L_h_cx_ok
L_h_km_re:
s_sub_u32 s36, s36, 1
s_cbranch_scc0 L_h_km
s_mov_b32 s36, 0
s_branch L_h_km_ok
L_og:
v_and_b32 v4, 63, v0
v_lshrrev_b32 v2, 4, v4
v_and_b32 v3, 15, v4
v_lshlrev_b32 v1, 4, v4
s_load_dwordx2 s[84:85], s[0:1], 0
s_mov_b32 s86, 2097152
s_mov_b32 s87, 0x00020000
s_waitcnt lgkmcnt(0)
s_load_dwordx2 s[88:89], s[0:1], 80
s_mov_b32 s90, 2097152
s_mov_b32 s91, 0x00020000
s_waitcnt lgkmcnt(0)
s_load_dwordx2 s[12:13], s[0:1], 64
s_mov_b32 s14, 1409024
s_mov_b32 s15, 0x00020000
s_waitcnt lgkmcnt(0)
s_sub_u32 s20, s16, 5
s_lshl_b32 s20, s20, 5
s_add_u32 s20, s20, s17
v_lshrrev_b32 v5, 2, v3
v_and_b32 v7, 3, v3
v_lshl_add_u32 v5, v5, 3, v7
v_lshlrev_b32 v5, 10, v5
v_lshl_add_u32 v6, v2, 4, v5
s_cmp_ge_u32 s20, 64
s_cbranch_scc1 L_o_arm
s_cmp_ge_u32 s18, 2
s_cbranch_scc1 L_o_tw
s_lshl_b32 s46, s20, 15
s_lshl_b32 s47, s18, 12
s_add_u32 s47, s46, s47
buffer_load_dwordx4 v[32:35], v6, s[84:87], s47 offen offset:0
buffer_load_dwordx4 v[36:39], v6, s[84:87], s47 offen offset:64
buffer_load_dwordx4 v[40:43], v6, s[84:87], s47 offen offset:128
buffer_load_dwordx4 v[44:47], v6, s[84:87], s47 offen offset:192
buffer_load_dwordx4 v[48:51], v6, s[84:87], s47 offen offset:256
buffer_load_dwordx4 v[52:55], v6, s[84:87], s47 offen offset:320
buffer_load_dwordx4 v[56:59], v6, s[84:87], s47 offen offset:384
buffer_load_dwordx4 v[60:63], v6, s[84:87], s47 offen offset:448
buffer_load_dwordx4 v[64:67], v6, s[84:87], s47 offen offset:512
buffer_load_dwordx4 v[68:71], v6, s[84:87], s47 offen offset:576
buffer_load_dwordx4 v[72:75], v6, s[84:87], s47 offen offset:640
buffer_load_dwordx4 v[76:79], v6, s[84:87], s47 offen offset:704
buffer_load_dwordx4 v[80:83], v6, s[84:87], s47 offen offset:768
buffer_load_dwordx4 v[84:87], v6, s[84:87], s47 offen offset:832
buffer_load_dwordx4 v[88:91], v6, s[84:87], s47 offen offset:896
buffer_load_dwordx4 v[92:95], v6, s[84:87], s47 offen offset:960
s_lshl_b32 s47, s18, 14
s_add_u32 s22, s46, s47
s_add_u32 s22, s22, 13631488
s_mov_b32 s48, 0xffff0000
v_mov_b32 v16, 0
v_mov_b32 v17, 0
v_mov_b32 v18, 0
v_mov_b32 v19, 0
s_waitcnt vmcnt(15)
v_lshlrev_b32 v96, 16, v32
v_and_b32 v97, s48, v32
v_add_f32 v16, v16, v96
v_add_f32 v17, v17, v97
v_lshlrev_b32 v98, 16, v33
v_and_b32 v99, s48, v33
v_add_f32 v18, v18, v98
v_add_f32 v19, v19, v99
v_lshlrev_b32 v100, 16, v34
v_and_b32 v101, s48, v34
v_add_f32 v16, v16, v100
v_add_f32 v17, v17, v101
v_lshlrev_b32 v102, 16, v35
v_and_b32 v103, s48, v35
v_add_f32 v18, v18, v102
v_add_f32 v19, v19, v103
s_waitcnt vmcnt(14)
v_lshlrev_b32 v104, 16, v36
v_and_b32 v105, s48, v36
v_add_f32 v16, v16, v104
v_add_f32 v17, v17, v105
v_lshlrev_b32 v106, 16, v37
v_and_b32 v107, s48, v37
v_add_f32 v18, v18, v106
v_add_f32 v19, v19, v107
v_lshlrev_b32 v108, 16, v38
v_and_b32 v109, s48, v38
v_add_f32 v16, v16, v108
v_add_f32 v17, v17, v109
v_lshlrev_b32 v110, 16, v39
v_and_b32 v111, s48, v39
v_add_f32 v18, v18, v110
v_add_f32 v19, v19, v111
s_waitcnt vmcnt(13)
v_lshlrev_b32 v112, 16, v40
v_and_b32 v113, s48, v40
v_add_f32 v16, v16, v112
v_add_f32 v17, v17, v113
v_lshlrev_b32 v114, 16, v41
v_and_b32 v115, s48, v41
v_add_f32 v18, v18, v114
v_add_f32 v19, v19, v115
v_lshlrev_b32 v116, 16, v42
v_and_b32 v117, s48, v42
v_add_f32 v16, v16, v116
v_add_f32 v17, v17, v117
v_lshlrev_b32 v118, 16, v43
v_and_b32 v119, s48, v43
v_add_f32 v18, v18, v118
v_add_f32 v19, v19, v119
s_waitcnt vmcnt(12)
v_lshlrev_b32 v120, 16, v44
v_and_b32 v121, s48, v44
v_add_f32 v16, v16, v120
v_add_f32 v17, v17, v121
v_lshlrev_b32 v122, 16, v45
v_and_b32 v123, s48, v45
v_add_f32 v18, v18, v122
v_add_f32 v19, v19, v123
v_lshlrev_b32 v124, 16, v46
v_and_b32 v125, s48, v46
v_add_f32 v16, v16, v124
v_add_f32 v17, v17, v125
v_lshlrev_b32 v126, 16, v47
v_and_b32 v127, s48, v47
v_add_f32 v18, v18, v126
v_add_f32 v19, v19, v127
s_waitcnt vmcnt(11)
v_lshlrev_b32 v128, 16, v48
v_and_b32 v129, s48, v48
v_add_f32 v16, v16, v128
v_add_f32 v17, v17, v129
v_lshlrev_b32 v130, 16, v49
v_and_b32 v131, s48, v49
v_add_f32 v18, v18, v130
v_add_f32 v19, v19, v131
v_lshlrev_b32 v132, 16, v50
v_and_b32 v133, s48, v50
v_add_f32 v16, v16, v132
v_add_f32 v17, v17, v133
v_lshlrev_b32 v134, 16, v51
v_and_b32 v135, s48, v51
v_add_f32 v18, v18, v134
v_add_f32 v19, v19, v135
s_waitcnt vmcnt(10)
v_lshlrev_b32 v136, 16, v52
v_and_b32 v137, s48, v52
v_add_f32 v16, v16, v136
v_add_f32 v17, v17, v137
v_lshlrev_b32 v138, 16, v53
v_and_b32 v139, s48, v53
v_add_f32 v18, v18, v138
v_add_f32 v19, v19, v139
v_lshlrev_b32 v140, 16, v54
v_and_b32 v141, s48, v54
v_add_f32 v16, v16, v140
v_add_f32 v17, v17, v141
v_lshlrev_b32 v142, 16, v55
v_and_b32 v143, s48, v55
v_add_f32 v18, v18, v142
v_add_f32 v19, v19, v143
s_waitcnt vmcnt(9)
v_lshlrev_b32 v144, 16, v56
v_and_b32 v145, s48, v56
v_add_f32 v16, v16, v144
v_add_f32 v17, v17, v145
v_lshlrev_b32 v146, 16, v57
v_and_b32 v147, s48, v57
v_add_f32 v18, v18, v146
v_add_f32 v19, v19, v147
v_lshlrev_b32 v148, 16, v58
v_and_b32 v149, s48, v58
v_add_f32 v16, v16, v148
v_add_f32 v17, v17, v149
v_lshlrev_b32 v150, 16, v59
v_and_b32 v151, s48, v59
v_add_f32 v18, v18, v150
v_add_f32 v19, v19, v151
s_waitcnt vmcnt(8)
v_lshlrev_b32 v152, 16, v60
v_and_b32 v153, s48, v60
v_add_f32 v16, v16, v152
v_add_f32 v17, v17, v153
v_lshlrev_b32 v154, 16, v61
v_and_b32 v155, s48, v61
v_add_f32 v18, v18, v154
v_add_f32 v19, v19, v155
v_lshlrev_b32 v156, 16, v62
v_and_b32 v157, s48, v62
v_add_f32 v16, v16, v156
v_add_f32 v17, v17, v157
v_lshlrev_b32 v158, 16, v63
v_and_b32 v159, s48, v63
v_add_f32 v18, v18, v158
v_add_f32 v19, v19, v159
s_waitcnt vmcnt(7)
v_lshlrev_b32 v160, 16, v64
v_and_b32 v161, s48, v64
v_add_f32 v16, v16, v160
v_add_f32 v17, v17, v161
v_lshlrev_b32 v162, 16, v65
v_and_b32 v163, s48, v65
v_add_f32 v18, v18, v162
v_add_f32 v19, v19, v163
v_lshlrev_b32 v164, 16, v66
v_and_b32 v165, s48, v66
v_add_f32 v16, v16, v164
v_add_f32 v17, v17, v165
v_lshlrev_b32 v166, 16, v67
v_and_b32 v167, s48, v67
v_add_f32 v18, v18, v166
v_add_f32 v19, v19, v167
s_waitcnt vmcnt(6)
v_lshlrev_b32 v168, 16, v68
v_and_b32 v169, s48, v68
v_add_f32 v16, v16, v168
v_add_f32 v17, v17, v169
v_lshlrev_b32 v170, 16, v69
v_and_b32 v171, s48, v69
v_add_f32 v18, v18, v170
v_add_f32 v19, v19, v171
v_lshlrev_b32 v172, 16, v70
v_and_b32 v173, s48, v70
v_add_f32 v16, v16, v172
v_add_f32 v17, v17, v173
v_lshlrev_b32 v174, 16, v71
v_and_b32 v175, s48, v71
v_add_f32 v18, v18, v174
v_add_f32 v19, v19, v175
s_waitcnt vmcnt(5)
v_lshlrev_b32 v176, 16, v72
v_and_b32 v177, s48, v72
v_add_f32 v16, v16, v176
v_add_f32 v17, v17, v177
v_lshlrev_b32 v178, 16, v73
v_and_b32 v179, s48, v73
v_add_f32 v18, v18, v178
v_add_f32 v19, v19, v179
v_lshlrev_b32 v180, 16, v74
v_and_b32 v181, s48, v74
v_add_f32 v16, v16, v180
v_add_f32 v17, v17, v181
v_lshlrev_b32 v182, 16, v75
v_and_b32 v183, s48, v75
v_add_f32 v18, v18, v182
v_add_f32 v19, v19, v183
s_waitcnt vmcnt(4)
v_lshlrev_b32 v184, 16, v76
v_and_b32 v185, s48, v76
v_add_f32 v16, v16, v184
v_add_f32 v17, v17, v185
v_lshlrev_b32 v186, 16, v77
v_and_b32 v187, s48, v77
v_add_f32 v18, v18, v186
v_add_f32 v19, v19, v187
v_lshlrev_b32 v188, 16, v78
v_and_b32 v189, s48, v78
v_add_f32 v16, v16, v188
v_add_f32 v17, v17, v189
v_lshlrev_b32 v190, 16, v79
v_and_b32 v191, s48, v79
v_add_f32 v18, v18, v190
v_add_f32 v19, v19, v191
s_waitcnt vmcnt(3)
v_lshlrev_b32 v192, 16, v80
v_and_b32 v193, s48, v80
v_add_f32 v16, v16, v192
v_add_f32 v17, v17, v193
v_lshlrev_b32 v194, 16, v81
v_and_b32 v195, s48, v81
v_add_f32 v18, v18, v194
v_add_f32 v19, v19, v195
v_lshlrev_b32 v196, 16, v82
v_and_b32 v197, s48, v82
v_add_f32 v16, v16, v196
v_add_f32 v17, v17, v197
v_lshlrev_b32 v198, 16, v83
v_and_b32 v199, s48, v83
v_add_f32 v18, v18, v198
v_add_f32 v19, v19, v199
s_waitcnt vmcnt(2)
v_lshlrev_b32 v200, 16, v84
v_and_b32 v201, s48, v84
v_add_f32 v16, v16, v200
v_add_f32 v17, v17, v201
v_lshlrev_b32 v202, 16, v85
v_and_b32 v203, s48, v85
v_add_f32 v18, v18, v202
v_add_f32 v19, v19, v203
v_lshlrev_b32 v204, 16, v86
v_and_b32 v205, s48, v86
v_add_f32 v16, v16, v204
v_add_f32 v17, v17, v205
v_lshlrev_b32 v206, 16, v87
v_and_b32 v207, s48, v87
v_add_f32 v18, v18, v206
v_add_f32 v19, v19, v207
s_waitcnt vmcnt(1)
v_lshlrev_b32 v208, 16, v88
v_and_b32 v209, s48, v88
v_add_f32 v16, v16, v208
v_add_f32 v17, v17, v209
v_lshlrev_b32 v210, 16, v89
v_and_b32 v211, s48, v89
v_add_f32 v18, v18, v210
v_add_f32 v19, v19, v211
v_lshlrev_b32 v212, 16, v90
v_and_b32 v213, s48, v90
v_add_f32 v16, v16, v212
v_add_f32 v17, v17, v213
v_lshlrev_b32 v214, 16, v91
v_and_b32 v215, s48, v91
v_add_f32 v18, v18, v214
v_add_f32 v19, v19, v215
s_waitcnt vmcnt(0)
v_lshlrev_b32 v216, 16, v92
v_and_b32 v217, s48, v92
v_add_f32 v16, v16, v216
v_add_f32 v17, v17, v217
v_lshlrev_b32 v218, 16, v93
v_and_b32 v219, s48, v93
v_add_f32 v18, v18, v218
v_add_f32 v19, v19, v219
v_lshlrev_b32 v220, 16, v94
v_and_b32 v221, s48, v94
v_add_f32 v16, v16, v220
v_add_f32 v17, v17, v221
v_lshlrev_b32 v222, 16, v95
v_and_b32 v223, s48, v95
v_add_f32 v18, v18, v222
v_add_f32 v19, v19, v223
v_add_f32 v16, v16, v17
v_add_f32 v18, v18, v19
v_add_f32 v20, v16, v18
v_mov_b32 v21, v20
s_nop 1
v_permlane16_swap_b32 v21, v20
v_add_f32 v20, v20, v21
v_mov_b32 v21, v20
s_nop 1
v_permlane32_swap_b32 v21, v20
v_add_f32 v20, v20, v21
v_mul_f32 v20, 989855744, v20
v_mov_b32 v16, 0
v_mov_b32 v17, 0
v_mov_b32 v18, 0
v_mov_b32 v19, 0
v_sub_f32 v24, v96, v20
v_fmac_f32 v16, v24, v24
v_sub_f32 v25, v97, v20
v_fmac_f32 v17, v25, v25
v_sub_f32 v26, v98, v20
v_fmac_f32 v18, v26, v26
v_sub_f32 v27, v99, v20
v_fmac_f32 v19, v27, v27
v_sub_f32 v24, v100, v20
v_fmac_f32 v16, v24, v24
v_sub_f32 v25, v101, v20
v_fmac_f32 v17, v25, v25
v_sub_f32 v26, v102, v20
v_fmac_f32 v18, v26, v26
v_sub_f32 v27, v103, v20
v_fmac_f32 v19, v27, v27
v_sub_f32 v24, v104, v20
v_fmac_f32 v16, v24, v24
v_sub_f32 v25, v105, v20
v_fmac_f32 v17, v25, v25
v_sub_f32 v26, v106, v20
v_fmac_f32 v18, v26, v26
v_sub_f32 v27, v107, v20
v_fmac_f32 v19, v27, v27
v_sub_f32 v24, v108, v20
v_fmac_f32 v16, v24, v24
v_sub_f32 v25, v109, v20
v_fmac_f32 v17, v25, v25
v_sub_f32 v26, v110, v20
v_fmac_f32 v18, v26, v26
v_sub_f32 v27, v111, v20
v_fmac_f32 v19, v27, v27
v_sub_f32 v24, v112, v20
v_fmac_f32 v16, v24, v24
v_sub_f32 v25, v113, v20
v_fmac_f32 v17, v25, v25
v_sub_f32 v26, v114, v20
v_fmac_f32 v18, v26, v26
v_sub_f32 v27, v115, v20
v_fmac_f32 v19, v27, v27
v_sub_f32 v24, v116, v20
v_fmac_f32 v16, v24, v24
v_sub_f32 v25, v117, v20
v_fmac_f32 v17, v25, v25
v_sub_f32 v26, v118, v20
v_fmac_f32 v18, v26, v26
v_sub_f32 v27, v119, v20
v_fmac_f32 v19, v27, v27
v_sub_f32 v24, v120, v20
v_fmac_f32 v16, v24, v24
v_sub_f32 v25, v121, v20
v_fmac_f32 v17, v25, v25
v_sub_f32 v26, v122, v20
v_fmac_f32 v18, v26, v26
v_sub_f32 v27, v123, v20
v_fmac_f32 v19, v27, v27
v_sub_f32 v24, v124, v20
v_fmac_f32 v16, v24, v24
v_sub_f32 v25, v125, v20
v_fmac_f32 v17, v25, v25
v_sub_f32 v26, v126, v20
v_fmac_f32 v18, v26, v26
v_sub_f32 v27, v127, v20
v_fmac_f32 v19, v27, v27
v_sub_f32 v24, v128, v20
v_fmac_f32 v16, v24, v24
v_sub_f32 v25, v129, v20
v_fmac_f32 v17, v25, v25
v_sub_f32 v26, v130, v20
v_fmac_f32 v18, v26, v26
v_sub_f32 v27, v131, v20
v_fmac_f32 v19, v27, v27
v_sub_f32 v24, v132, v20
v_fmac_f32 v16, v24, v24
v_sub_f32 v25, v133, v20
v_fmac_f32 v17, v25, v25
v_sub_f32 v26, v134, v20
v_fmac_f32 v18, v26, v26
v_sub_f32 v27, v135, v20
v_fmac_f32 v19, v27, v27
v_sub_f32 v24, v136, v20
v_fmac_f32 v16, v24, v24
v_sub_f32 v25, v137, v20
v_fmac_f32 v17, v25, v25
v_sub_f32 v26, v138, v20
v_fmac_f32 v18, v26, v26
v_sub_f32 v27, v139, v20
v_fmac_f32 v19, v27, v27
v_sub_f32 v24, v140, v20
v_fmac_f32 v16, v24, v24
v_sub_f32 v25, v141, v20
v_fmac_f32 v17, v25, v25
v_sub_f32 v26, v142, v20
v_fmac_f32 v18, v26, v26
v_sub_f32 v27, v143, v20
v_fmac_f32 v19, v27, v27
v_sub_f32 v24, v144, v20
v_fmac_f32 v16, v24, v24
v_sub_f32 v25, v145, v20
v_fmac_f32 v17, v25, v25
v_sub_f32 v26, v146, v20
v_fmac_f32 v18, v26, v26
v_sub_f32 v27, v147, v20
v_fmac_f32 v19, v27, v27
v_sub_f32 v24, v148, v20
v_fmac_f32 v16, v24, v24
v_sub_f32 v25, v149, v20
v_fmac_f32 v17, v25, v25
v_sub_f32 v26, v150, v20
v_fmac_f32 v18, v26, v26
v_sub_f32 v27, v151, v20
v_fmac_f32 v19, v27, v27
v_sub_f32 v24, v152, v20
v_fmac_f32 v16, v24, v24
v_sub_f32 v25, v153, v20
v_fmac_f32 v17, v25, v25
v_sub_f32 v26, v154, v20
v_fmac_f32 v18, v26, v26
v_sub_f32 v27, v155, v20
v_fmac_f32 v19, v27, v27
v_sub_f32 v24, v156, v20
v_fmac_f32 v16, v24, v24
v_sub_f32 v25, v157, v20
v_fmac_f32 v17, v25, v25
v_sub_f32 v26, v158, v20
v_fmac_f32 v18, v26, v26
v_sub_f32 v27, v159, v20
v_fmac_f32 v19, v27, v27
v_sub_f32 v24, v160, v20
v_fmac_f32 v16, v24, v24
v_sub_f32 v25, v161, v20
v_fmac_f32 v17, v25, v25
v_sub_f32 v26, v162, v20
v_fmac_f32 v18, v26, v26
v_sub_f32 v27, v163, v20
v_fmac_f32 v19, v27, v27
v_sub_f32 v24, v164, v20
v_fmac_f32 v16, v24, v24
v_sub_f32 v25, v165, v20
v_fmac_f32 v17, v25, v25
v_sub_f32 v26, v166, v20
v_fmac_f32 v18, v26, v26
v_sub_f32 v27, v167, v20
v_fmac_f32 v19, v27, v27
v_sub_f32 v24, v168, v20
v_fmac_f32 v16, v24, v24
v_sub_f32 v25, v169, v20
v_fmac_f32 v17, v25, v25
v_sub_f32 v26, v170, v20
v_fmac_f32 v18, v26, v26
v_sub_f32 v27, v171, v20
v_fmac_f32 v19, v27, v27
v_sub_f32 v24, v172, v20
v_fmac_f32 v16, v24, v24
v_sub_f32 v25, v173, v20
v_fmac_f32 v17, v25, v25
v_sub_f32 v26, v174, v20
v_fmac_f32 v18, v26, v26
v_sub_f32 v27, v175, v20
v_fmac_f32 v19, v27, v27
v_sub_f32 v24, v176, v20
v_fmac_f32 v16, v24, v24
v_sub_f32 v25, v177, v20
v_fmac_f32 v17, v25, v25
v_sub_f32 v26, v178, v20
v_fmac_f32 v18, v26, v26
v_sub_f32 v27, v179, v20
v_fmac_f32 v19, v27, v27
v_sub_f32 v24, v180, v20
v_fmac_f32 v16, v24, v24
v_sub_f32 v25, v181, v20
v_fmac_f32 v17, v25, v25
v_sub_f32 v26, v182, v20
v_fmac_f32 v18, v26, v26
v_sub_f32 v27, v183, v20
v_fmac_f32 v19, v27, v27
v_sub_f32 v24, v184, v20
v_fmac_f32 v16, v24, v24
v_sub_f32 v25, v185, v20
v_fmac_f32 v17, v25, v25
v_sub_f32 v26, v186, v20
v_fmac_f32 v18, v26, v26
v_sub_f32 v27, v187, v20
v_fmac_f32 v19, v27, v27
v_sub_f32 v24, v188, v20
v_fmac_f32 v16, v24, v24
v_sub_f32 v25, v189, v20
v_fmac_f32 v17, v25, v25
v_sub_f32 v26, v190, v20
v_fmac_f32 v18, v26, v26
v_sub_f32 v27, v191, v20
v_fmac_f32 v19, v27, v27
v_sub_f32 v24, v192, v20
v_fmac_f32 v16, v24, v24
v_sub_f32 v25, v193, v20
v_fmac_f32 v17, v25, v25
v_sub_f32 v26, v194, v20
v_fmac_f32 v18, v26, v26
v_sub_f32 v27, v195, v20
v_fmac_f32 v19, v27, v27
v_sub_f32 v24, v196, v20
v_fmac_f32 v16, v24, v24
v_sub_f32 v25, v197, v20
v_fmac_f32 v17, v25, v25
v_sub_f32 v26, v198, v20
v_fmac_f32 v18, v26, v26
v_sub_f32 v27, v199, v20
v_fmac_f32 v19, v27, v27
v_sub_f32 v24, v200, v20
v_fmac_f32 v16, v24, v24
v_sub_f32 v25, v201, v20
v_fmac_f32 v17, v25, v25
v_sub_f32 v26, v202, v20
v_fmac_f32 v18, v26, v26
v_sub_f32 v27, v203, v20
v_fmac_f32 v19, v27, v27
v_sub_f32 v24, v204, v20
v_fmac_f32 v16, v24, v24
v_sub_f32 v25, v205, v20
v_fmac_f32 v17, v25, v25
v_sub_f32 v26, v206, v20
v_fmac_f32 v18, v26, v26
v_sub_f32 v27, v207, v20
v_fmac_f32 v19, v27, v27
v_sub_f32 v24, v208, v20
v_fmac_f32 v16, v24, v24
v_sub_f32 v25, v209, v20
v_fmac_f32 v17, v25, v25
v_sub_f32 v26, v210, v20
v_fmac_f32 v18, v26, v26
v_sub_f32 v27, v211, v20
v_fmac_f32 v19, v27, v27
v_sub_f32 v24, v212, v20
v_fmac_f32 v16, v24, v24
v_sub_f32 v25, v213, v20
v_fmac_f32 v17, v25, v25
v_sub_f32 v26, v214, v20
v_fmac_f32 v18, v26, v26
v_sub_f32 v27, v215, v20
v_fmac_f32 v19, v27, v27
v_sub_f32 v24, v216, v20
v_fmac_f32 v16, v24, v24
v_sub_f32 v25, v217, v20
v_fmac_f32 v17, v25, v25
v_sub_f32 v26, v218, v20
v_fmac_f32 v18, v26, v26
v_sub_f32 v27, v219, v20
v_fmac_f32 v19, v27, v27
v_sub_f32 v24, v220, v20
v_fmac_f32 v16, v24, v24
v_sub_f32 v25, v221, v20
v_fmac_f32 v17, v25, v25
v_sub_f32 v26, v222, v20
v_fmac_f32 v18, v26, v26
v_sub_f32 v27, v223, v20
v_fmac_f32 v19, v27, v27
v_add_f32 v16, v16, v17
v_add_f32 v18, v18, v19
v_add_f32 v22, v16, v18
v_mov_b32 v21, v22
s_nop 1
v_permlane16_swap_b32 v21, v22
v_add_f32 v22, v22, v21
v_mov_b32 v21, v22
s_nop 1
v_permlane32_swap_b32 v21, v22
v_add_f32 v22, v22, v21
v_mul_f32 v22, 989855744, v22
v_cvt_pk_bf16_f32 v20, 0, v20
v_cvt_pk_bf16_f32 v22, 0, v22
v_add_f32 v22, 925353388, v22
v_cvt_pk_bf16_f32 v22, 0, v22
v_sqrt_f32 v22, v22
s_nop 0
v_cvt_pk_bf16_f32 v22, 0, v22
v_rcp_f32 v22, v22
v_sub_f32 v96, v96, v20
v_cvt_pk_bf16_f32 v96, 0, v96
v_mul_f32 v96, v96, v22
v_sub_f32 v97, v97, v20
v_cvt_pk_bf16_f32 v97, 0, v97
v_mul_f32 v97, v97, v22
v_cvt_pk_bf16_f32 v32, v96, v97
v_sub_f32 v98, v98, v20
v_cvt_pk_bf16_f32 v98, 0, v98
v_mul_f32 v98, v98, v22
v_sub_f32 v99, v99, v20
v_cvt_pk_bf16_f32 v99, 0, v99
v_mul_f32 v99, v99, v22
v_cvt_pk_bf16_f32 v33, v98, v99
v_sub_f32 v100, v100, v20
v_cvt_pk_bf16_f32 v100, 0, v100
v_mul_f32 v100, v100, v22
v_sub_f32 v101, v101, v20
v_cvt_pk_bf16_f32 v101, 0, v101
v_mul_f32 v101, v101, v22
v_cvt_pk_bf16_f32 v34, v100, v101
v_sub_f32 v102, v102, v20
v_cvt_pk_bf16_f32 v102, 0, v102
v_mul_f32 v102, v102, v22
v_sub_f32 v103, v103, v20
v_cvt_pk_bf16_f32 v103, 0, v103
v_mul_f32 v103, v103, v22
v_cvt_pk_bf16_f32 v35, v102, v103
buffer_store_dwordx4 v[32:35], v1, s[8:11], s22 offen offset:0 sc1
v_sub_f32 v104, v104, v20
v_cvt_pk_bf16_f32 v104, 0, v104
v_mul_f32 v104, v104, v22
v_sub_f32 v105, v105, v20
v_cvt_pk_bf16_f32 v105, 0, v105
v_mul_f32 v105, v105, v22
v_cvt_pk_bf16_f32 v36, v104, v105
v_sub_f32 v106, v106, v20
v_cvt_pk_bf16_f32 v106, 0, v106
v_mul_f32 v106, v106, v22
v_sub_f32 v107, v107, v20
v_cvt_pk_bf16_f32 v107, 0, v107
v_mul_f32 v107, v107, v22
v_cvt_pk_bf16_f32 v37, v106, v107
v_sub_f32 v108, v108, v20
v_cvt_pk_bf16_f32 v108, 0, v108
v_mul_f32 v108, v108, v22
v_sub_f32 v109, v109, v20
v_cvt_pk_bf16_f32 v109, 0, v109
v_mul_f32 v109, v109, v22
v_cvt_pk_bf16_f32 v38, v108, v109
v_sub_f32 v110, v110, v20
v_cvt_pk_bf16_f32 v110, 0, v110
v_mul_f32 v110, v110, v22
v_sub_f32 v111, v111, v20
v_cvt_pk_bf16_f32 v111, 0, v111
v_mul_f32 v111, v111, v22
v_cvt_pk_bf16_f32 v39, v110, v111
buffer_store_dwordx4 v[36:39], v1, s[8:11], s22 offen offset:1024 sc1
v_sub_f32 v112, v112, v20
v_cvt_pk_bf16_f32 v112, 0, v112
v_mul_f32 v112, v112, v22
v_sub_f32 v113, v113, v20
v_cvt_pk_bf16_f32 v113, 0, v113
v_mul_f32 v113, v113, v22
v_cvt_pk_bf16_f32 v40, v112, v113
v_sub_f32 v114, v114, v20
v_cvt_pk_bf16_f32 v114, 0, v114
v_mul_f32 v114, v114, v22
v_sub_f32 v115, v115, v20
v_cvt_pk_bf16_f32 v115, 0, v115
v_mul_f32 v115, v115, v22
v_cvt_pk_bf16_f32 v41, v114, v115
v_sub_f32 v116, v116, v20
v_cvt_pk_bf16_f32 v116, 0, v116
v_mul_f32 v116, v116, v22
v_sub_f32 v117, v117, v20
v_cvt_pk_bf16_f32 v117, 0, v117
v_mul_f32 v117, v117, v22
v_cvt_pk_bf16_f32 v42, v116, v117
v_sub_f32 v118, v118, v20
v_cvt_pk_bf16_f32 v118, 0, v118
v_mul_f32 v118, v118, v22
v_sub_f32 v119, v119, v20
v_cvt_pk_bf16_f32 v119, 0, v119
v_mul_f32 v119, v119, v22
v_cvt_pk_bf16_f32 v43, v118, v119
buffer_store_dwordx4 v[40:43], v1, s[8:11], s22 offen offset:2048 sc1
v_sub_f32 v120, v120, v20
v_cvt_pk_bf16_f32 v120, 0, v120
v_mul_f32 v120, v120, v22
v_sub_f32 v121, v121, v20
v_cvt_pk_bf16_f32 v121, 0, v121
v_mul_f32 v121, v121, v22
v_cvt_pk_bf16_f32 v44, v120, v121
v_sub_f32 v122, v122, v20
v_cvt_pk_bf16_f32 v122, 0, v122
v_mul_f32 v122, v122, v22
v_sub_f32 v123, v123, v20
v_cvt_pk_bf16_f32 v123, 0, v123
v_mul_f32 v123, v123, v22
v_cvt_pk_bf16_f32 v45, v122, v123
v_sub_f32 v124, v124, v20
v_cvt_pk_bf16_f32 v124, 0, v124
v_mul_f32 v124, v124, v22
v_sub_f32 v125, v125, v20
v_cvt_pk_bf16_f32 v125, 0, v125
v_mul_f32 v125, v125, v22
v_cvt_pk_bf16_f32 v46, v124, v125
v_sub_f32 v126, v126, v20
v_cvt_pk_bf16_f32 v126, 0, v126
v_mul_f32 v126, v126, v22
v_sub_f32 v127, v127, v20
v_cvt_pk_bf16_f32 v127, 0, v127
v_mul_f32 v127, v127, v22
v_cvt_pk_bf16_f32 v47, v126, v127
buffer_store_dwordx4 v[44:47], v1, s[8:11], s22 offen offset:3072 sc1
s_add_u32 s22, s22, 4096
v_sub_f32 v128, v128, v20
v_cvt_pk_bf16_f32 v128, 0, v128
v_mul_f32 v128, v128, v22
v_sub_f32 v129, v129, v20
v_cvt_pk_bf16_f32 v129, 0, v129
v_mul_f32 v129, v129, v22
v_cvt_pk_bf16_f32 v48, v128, v129
v_sub_f32 v130, v130, v20
v_cvt_pk_bf16_f32 v130, 0, v130
v_mul_f32 v130, v130, v22
v_sub_f32 v131, v131, v20
v_cvt_pk_bf16_f32 v131, 0, v131
v_mul_f32 v131, v131, v22
v_cvt_pk_bf16_f32 v49, v130, v131
v_sub_f32 v132, v132, v20
v_cvt_pk_bf16_f32 v132, 0, v132
v_mul_f32 v132, v132, v22
v_sub_f32 v133, v133, v20
v_cvt_pk_bf16_f32 v133, 0, v133
v_mul_f32 v133, v133, v22
v_cvt_pk_bf16_f32 v50, v132, v133
v_sub_f32 v134, v134, v20
v_cvt_pk_bf16_f32 v134, 0, v134
v_mul_f32 v134, v134, v22
v_sub_f32 v135, v135, v20
v_cvt_pk_bf16_f32 v135, 0, v135
v_mul_f32 v135, v135, v22
v_cvt_pk_bf16_f32 v51, v134, v135
buffer_store_dwordx4 v[48:51], v1, s[8:11], s22 offen offset:0 sc1
v_sub_f32 v136, v136, v20
v_cvt_pk_bf16_f32 v136, 0, v136
v_mul_f32 v136, v136, v22
v_sub_f32 v137, v137, v20
v_cvt_pk_bf16_f32 v137, 0, v137
v_mul_f32 v137, v137, v22
v_cvt_pk_bf16_f32 v52, v136, v137
v_sub_f32 v138, v138, v20
v_cvt_pk_bf16_f32 v138, 0, v138
v_mul_f32 v138, v138, v22
v_sub_f32 v139, v139, v20
v_cvt_pk_bf16_f32 v139, 0, v139
v_mul_f32 v139, v139, v22
v_cvt_pk_bf16_f32 v53, v138, v139
v_sub_f32 v140, v140, v20
v_cvt_pk_bf16_f32 v140, 0, v140
v_mul_f32 v140, v140, v22
v_sub_f32 v141, v141, v20
v_cvt_pk_bf16_f32 v141, 0, v141
v_mul_f32 v141, v141, v22
v_cvt_pk_bf16_f32 v54, v140, v141
v_sub_f32 v142, v142, v20
v_cvt_pk_bf16_f32 v142, 0, v142
v_mul_f32 v142, v142, v22
v_sub_f32 v143, v143, v20
v_cvt_pk_bf16_f32 v143, 0, v143
v_mul_f32 v143, v143, v22
v_cvt_pk_bf16_f32 v55, v142, v143
buffer_store_dwordx4 v[52:55], v1, s[8:11], s22 offen offset:1024 sc1
v_sub_f32 v144, v144, v20
v_cvt_pk_bf16_f32 v144, 0, v144
v_mul_f32 v144, v144, v22
v_sub_f32 v145, v145, v20
v_cvt_pk_bf16_f32 v145, 0, v145
v_mul_f32 v145, v145, v22
v_cvt_pk_bf16_f32 v56, v144, v145
v_sub_f32 v146, v146, v20
v_cvt_pk_bf16_f32 v146, 0, v146
v_mul_f32 v146, v146, v22
v_sub_f32 v147, v147, v20
v_cvt_pk_bf16_f32 v147, 0, v147
v_mul_f32 v147, v147, v22
v_cvt_pk_bf16_f32 v57, v146, v147
v_sub_f32 v148, v148, v20
v_cvt_pk_bf16_f32 v148, 0, v148
v_mul_f32 v148, v148, v22
v_sub_f32 v149, v149, v20
v_cvt_pk_bf16_f32 v149, 0, v149
v_mul_f32 v149, v149, v22
v_cvt_pk_bf16_f32 v58, v148, v149
v_sub_f32 v150, v150, v20
v_cvt_pk_bf16_f32 v150, 0, v150
v_mul_f32 v150, v150, v22
v_sub_f32 v151, v151, v20
v_cvt_pk_bf16_f32 v151, 0, v151
v_mul_f32 v151, v151, v22
v_cvt_pk_bf16_f32 v59, v150, v151
buffer_store_dwordx4 v[56:59], v1, s[8:11], s22 offen offset:2048 sc1
v_sub_f32 v152, v152, v20
v_cvt_pk_bf16_f32 v152, 0, v152
v_mul_f32 v152, v152, v22
v_sub_f32 v153, v153, v20
v_cvt_pk_bf16_f32 v153, 0, v153
v_mul_f32 v153, v153, v22
v_cvt_pk_bf16_f32 v60, v152, v153
v_sub_f32 v154, v154, v20
v_cvt_pk_bf16_f32 v154, 0, v154
v_mul_f32 v154, v154, v22
v_sub_f32 v155, v155, v20
v_cvt_pk_bf16_f32 v155, 0, v155
v_mul_f32 v155, v155, v22
v_cvt_pk_bf16_f32 v61, v154, v155
v_sub_f32 v156, v156, v20
v_cvt_pk_bf16_f32 v156, 0, v156
v_mul_f32 v156, v156, v22
v_sub_f32 v157, v157, v20
v_cvt_pk_bf16_f32 v157, 0, v157
v_mul_f32 v157, v157, v22
v_cvt_pk_bf16_f32 v62, v156, v157
v_sub_f32 v158, v158, v20
v_cvt_pk_bf16_f32 v158, 0, v158
v_mul_f32 v158, v158, v22
v_sub_f32 v159, v159, v20
v_cvt_pk_bf16_f32 v159, 0, v159
v_mul_f32 v159, v159, v22
v_cvt_pk_bf16_f32 v63, v158, v159
buffer_store_dwordx4 v[60:63], v1, s[8:11], s22 offen offset:3072 sc1
s_add_u32 s22, s22, 4096
v_sub_f32 v160, v160, v20
v_cvt_pk_bf16_f32 v160, 0, v160
v_mul_f32 v160, v160, v22
v_sub_f32 v161, v161, v20
v_cvt_pk_bf16_f32 v161, 0, v161
v_mul_f32 v161, v161, v22
v_cvt_pk_bf16_f32 v64, v160, v161
v_sub_f32 v162, v162, v20
v_cvt_pk_bf16_f32 v162, 0, v162
v_mul_f32 v162, v162, v22
v_sub_f32 v163, v163, v20
v_cvt_pk_bf16_f32 v163, 0, v163
v_mul_f32 v163, v163, v22
v_cvt_pk_bf16_f32 v65, v162, v163
v_sub_f32 v164, v164, v20
v_cvt_pk_bf16_f32 v164, 0, v164
v_mul_f32 v164, v164, v22
v_sub_f32 v165, v165, v20
v_cvt_pk_bf16_f32 v165, 0, v165
v_mul_f32 v165, v165, v22
v_cvt_pk_bf16_f32 v66, v164, v165
v_sub_f32 v166, v166, v20
v_cvt_pk_bf16_f32 v166, 0, v166
v_mul_f32 v166, v166, v22
v_sub_f32 v167, v167, v20
v_cvt_pk_bf16_f32 v167, 0, v167
v_mul_f32 v167, v167, v22
v_cvt_pk_bf16_f32 v67, v166, v167
buffer_store_dwordx4 v[64:67], v1, s[8:11], s22 offen offset:0 sc1
v_sub_f32 v168, v168, v20
v_cvt_pk_bf16_f32 v168, 0, v168
v_mul_f32 v168, v168, v22
v_sub_f32 v169, v169, v20
v_cvt_pk_bf16_f32 v169, 0, v169
v_mul_f32 v169, v169, v22
v_cvt_pk_bf16_f32 v68, v168, v169
v_sub_f32 v170, v170, v20
v_cvt_pk_bf16_f32 v170, 0, v170
v_mul_f32 v170, v170, v22
v_sub_f32 v171, v171, v20
v_cvt_pk_bf16_f32 v171, 0, v171
v_mul_f32 v171, v171, v22
v_cvt_pk_bf16_f32 v69, v170, v171
v_sub_f32 v172, v172, v20
v_cvt_pk_bf16_f32 v172, 0, v172
v_mul_f32 v172, v172, v22
v_sub_f32 v173, v173, v20
v_cvt_pk_bf16_f32 v173, 0, v173
v_mul_f32 v173, v173, v22
v_cvt_pk_bf16_f32 v70, v172, v173
v_sub_f32 v174, v174, v20
v_cvt_pk_bf16_f32 v174, 0, v174
v_mul_f32 v174, v174, v22
v_sub_f32 v175, v175, v20
v_cvt_pk_bf16_f32 v175, 0, v175
v_mul_f32 v175, v175, v22
v_cvt_pk_bf16_f32 v71, v174, v175
buffer_store_dwordx4 v[68:71], v1, s[8:11], s22 offen offset:1024 sc1
v_sub_f32 v176, v176, v20
v_cvt_pk_bf16_f32 v176, 0, v176
v_mul_f32 v176, v176, v22
v_sub_f32 v177, v177, v20
v_cvt_pk_bf16_f32 v177, 0, v177
v_mul_f32 v177, v177, v22
v_cvt_pk_bf16_f32 v72, v176, v177
v_sub_f32 v178, v178, v20
v_cvt_pk_bf16_f32 v178, 0, v178
v_mul_f32 v178, v178, v22
v_sub_f32 v179, v179, v20
v_cvt_pk_bf16_f32 v179, 0, v179
v_mul_f32 v179, v179, v22
v_cvt_pk_bf16_f32 v73, v178, v179
v_sub_f32 v180, v180, v20
v_cvt_pk_bf16_f32 v180, 0, v180
v_mul_f32 v180, v180, v22
v_sub_f32 v181, v181, v20
v_cvt_pk_bf16_f32 v181, 0, v181
v_mul_f32 v181, v181, v22
v_cvt_pk_bf16_f32 v74, v180, v181
v_sub_f32 v182, v182, v20
v_cvt_pk_bf16_f32 v182, 0, v182
v_mul_f32 v182, v182, v22
v_sub_f32 v183, v183, v20
v_cvt_pk_bf16_f32 v183, 0, v183
v_mul_f32 v183, v183, v22
v_cvt_pk_bf16_f32 v75, v182, v183
buffer_store_dwordx4 v[72:75], v1, s[8:11], s22 offen offset:2048 sc1
v_sub_f32 v184, v184, v20
v_cvt_pk_bf16_f32 v184, 0, v184
v_mul_f32 v184, v184, v22
v_sub_f32 v185, v185, v20
v_cvt_pk_bf16_f32 v185, 0, v185
v_mul_f32 v185, v185, v22
v_cvt_pk_bf16_f32 v76, v184, v185
v_sub_f32 v186, v186, v20
v_cvt_pk_bf16_f32 v186, 0, v186
v_mul_f32 v186, v186, v22
v_sub_f32 v187, v187, v20
v_cvt_pk_bf16_f32 v187, 0, v187
v_mul_f32 v187, v187, v22
v_cvt_pk_bf16_f32 v77, v186, v187
v_sub_f32 v188, v188, v20
v_cvt_pk_bf16_f32 v188, 0, v188
v_mul_f32 v188, v188, v22
v_sub_f32 v189, v189, v20
v_cvt_pk_bf16_f32 v189, 0, v189
v_mul_f32 v189, v189, v22
v_cvt_pk_bf16_f32 v78, v188, v189
v_sub_f32 v190, v190, v20
v_cvt_pk_bf16_f32 v190, 0, v190
v_mul_f32 v190, v190, v22
v_sub_f32 v191, v191, v20
v_cvt_pk_bf16_f32 v191, 0, v191
v_mul_f32 v191, v191, v22
v_cvt_pk_bf16_f32 v79, v190, v191
buffer_store_dwordx4 v[76:79], v1, s[8:11], s22 offen offset:3072 sc1
s_add_u32 s22, s22, 4096
v_sub_f32 v192, v192, v20
v_cvt_pk_bf16_f32 v192, 0, v192
v_mul_f32 v192, v192, v22
v_sub_f32 v193, v193, v20
v_cvt_pk_bf16_f32 v193, 0, v193
v_mul_f32 v193, v193, v22
v_cvt_pk_bf16_f32 v80, v192, v193
v_sub_f32 v194, v194, v20
v_cvt_pk_bf16_f32 v194, 0, v194
v_mul_f32 v194, v194, v22
v_sub_f32 v195, v195, v20
v_cvt_pk_bf16_f32 v195, 0, v195
v_mul_f32 v195, v195, v22
v_cvt_pk_bf16_f32 v81, v194, v195
v_sub_f32 v196, v196, v20
v_cvt_pk_bf16_f32 v196, 0, v196
v_mul_f32 v196, v196, v22
v_sub_f32 v197, v197, v20
v_cvt_pk_bf16_f32 v197, 0, v197
v_mul_f32 v197, v197, v22
v_cvt_pk_bf16_f32 v82, v196, v197
v_sub_f32 v198, v198, v20
v_cvt_pk_bf16_f32 v198, 0, v198
v_mul_f32 v198, v198, v22
v_sub_f32 v199, v199, v20
v_cvt_pk_bf16_f32 v199, 0, v199
v_mul_f32 v199, v199, v22
v_cvt_pk_bf16_f32 v83, v198, v199
buffer_store_dwordx4 v[80:83], v1, s[8:11], s22 offen offset:0 sc1
v_sub_f32 v200, v200, v20
v_cvt_pk_bf16_f32 v200, 0, v200
v_mul_f32 v200, v200, v22
v_sub_f32 v201, v201, v20
v_cvt_pk_bf16_f32 v201, 0, v201
v_mul_f32 v201, v201, v22
v_cvt_pk_bf16_f32 v84, v200, v201
v_sub_f32 v202, v202, v20
v_cvt_pk_bf16_f32 v202, 0, v202
v_mul_f32 v202, v202, v22
v_sub_f32 v203, v203, v20
v_cvt_pk_bf16_f32 v203, 0, v203
v_mul_f32 v203, v203, v22
v_cvt_pk_bf16_f32 v85, v202, v203
v_sub_f32 v204, v204, v20
v_cvt_pk_bf16_f32 v204, 0, v204
v_mul_f32 v204, v204, v22
v_sub_f32 v205, v205, v20
v_cvt_pk_bf16_f32 v205, 0, v205
v_mul_f32 v205, v205, v22
v_cvt_pk_bf16_f32 v86, v204, v205
v_sub_f32 v206, v206, v20
v_cvt_pk_bf16_f32 v206, 0, v206
v_mul_f32 v206, v206, v22
v_sub_f32 v207, v207, v20
v_cvt_pk_bf16_f32 v207, 0, v207
v_mul_f32 v207, v207, v22
v_cvt_pk_bf16_f32 v87, v206, v207
buffer_store_dwordx4 v[84:87], v1, s[8:11], s22 offen offset:1024 sc1
v_sub_f32 v208, v208, v20
v_cvt_pk_bf16_f32 v208, 0, v208
v_mul_f32 v208, v208, v22
v_sub_f32 v209, v209, v20
v_cvt_pk_bf16_f32 v209, 0, v209
v_mul_f32 v209, v209, v22
v_cvt_pk_bf16_f32 v88, v208, v209
v_sub_f32 v210, v210, v20
v_cvt_pk_bf16_f32 v210, 0, v210
v_mul_f32 v210, v210, v22
v_sub_f32 v211, v211, v20
v_cvt_pk_bf16_f32 v211, 0, v211
v_mul_f32 v211, v211, v22
v_cvt_pk_bf16_f32 v89, v210, v211
v_sub_f32 v212, v212, v20
v_cvt_pk_bf16_f32 v212, 0, v212
v_mul_f32 v212, v212, v22
v_sub_f32 v213, v213, v20
v_cvt_pk_bf16_f32 v213, 0, v213
v_mul_f32 v213, v213, v22
v_cvt_pk_bf16_f32 v90, v212, v213
v_sub_f32 v214, v214, v20
v_cvt_pk_bf16_f32 v214, 0, v214
v_mul_f32 v214, v214, v22
v_sub_f32 v215, v215, v20
v_cvt_pk_bf16_f32 v215, 0, v215
v_mul_f32 v215, v215, v22
v_cvt_pk_bf16_f32 v91, v214, v215
buffer_store_dwordx4 v[88:91], v1, s[8:11], s22 offen offset:2048 sc1
v_sub_f32 v216, v216, v20
v_cvt_pk_bf16_f32 v216, 0, v216
v_mul_f32 v216, v216, v22
v_sub_f32 v217, v217, v20
v_cvt_pk_bf16_f32 v217, 0, v217
v_mul_f32 v217, v217, v22
v_cvt_pk_bf16_f32 v92, v216, v217
v_sub_f32 v218, v218, v20
v_cvt_pk_bf16_f32 v218, 0, v218
v_mul_f32 v218, v218, v22
v_sub_f32 v219, v219, v20
v_cvt_pk_bf16_f32 v219, 0, v219
v_mul_f32 v219, v219, v22
v_cvt_pk_bf16_f32 v93, v218, v219
v_sub_f32 v220, v220, v20
v_cvt_pk_bf16_f32 v220, 0, v220
v_mul_f32 v220, v220, v22
v_sub_f32 v221, v221, v20
v_cvt_pk_bf16_f32 v221, 0, v221
v_mul_f32 v221, v221, v22
v_cvt_pk_bf16_f32 v94, v220, v221
v_sub_f32 v222, v222, v20
v_cvt_pk_bf16_f32 v222, 0, v222
v_mul_f32 v222, v222, v22
v_sub_f32 v223, v223, v20
v_cvt_pk_bf16_f32 v223, 0, v223
v_mul_f32 v223, v223, v22
v_cvt_pk_bf16_f32 v95, v222, v223
buffer_store_dwordx4 v[92:95], v1, s[8:11], s22 offen offset:3072 sc1
s_add_u32 s22, s22, 4096
s_waitcnt vmcnt(0)
v_mov_b32 v30, 1
v_mov_b32 v31, 4
s_mov_b64 exec, 1
global_atomic_add v31, v30, s[4:5] sc1
s_mov_b64 exec, -1
s_branch L_o_ffn
L_o_tw:
s_load_dwordx2 s[92:93], s[0:1], 40
s_mov_b32 s94, 4194304
s_mov_b32 s95, 0x00020000
s_waitcnt lgkmcnt(0)
v_lshlrev_b32 v16, 6, v4
s_lshl_b32 s46, s20, 16
s_and_b32 s47, s18, 1
s_lshl_b32 s47, s47, 15
s_add_u32 s46, s46, s47
buffer_load_dword v17, v16, s[92:95], s46 offen
s_add_u32 s46, s46, 4096
buffer_load_dword v17, v16, s[92:95], s46 offen
s_add_u32 s46, s46, 4096
buffer_load_dword v17, v16, s[92:95], s46 offen
s_add_u32 s46, s46, 4096
buffer_load_dword v17, v16, s[92:95], s46 offen
s_add_u32 s46, s46, 4096
buffer_load_dword v17, v16, s[92:95], s46 offen
s_add_u32 s46, s46, 4096
buffer_load_dword v17, v16, s[92:95], s46 offen
s_add_u32 s46, s46, 4096
buffer_load_dword v17, v16, s[92:95], s46 offen
s_add_u32 s46, s46, 4096
buffer_load_dword v17, v16, s[92:95], s46 offen
s_add_u32 s46, s46, 4096
s_waitcnt vmcnt(0)
s_branch L_o_ffn
L_o_arm:
s_cmp_ge_u32 s20, 80
s_cbranch_scc1 L_o_ffn
s_cmp_lg_u32 s18, 0
s_cbranch_scc1 L_o_ffn
v_mov_b32 v32, 0
v_mov_b32 v33, 0
v_mov_b32 v34, 0
v_mov_b32 v35, 0
s_lshl_b32 s46, s20, 10
s_add_u32 s46, s46, 99549184
buffer_store_dwordx4 v[32:35], v1, s[8:11], s46 offen sc1
s_lshl_b32 s46, s20, 11
s_add_u32 s46, s46, 4294934528
buffer_store_dwordx4 v[32:35], v1, s[8:11], s46 offen offset:0 sc1
buffer_store_dwordx4 v[32:35], v1, s[8:11], s46 offen offset:1024 sc1
s_waitcnt vmcnt(0)
v_mov_b32 v30, 1
v_mov_b32 v31, 4
s_mov_b64 exec, 1
global_atomic_add v31, v30, s[4:5] sc1
s_mov_b64 exec, -1
L_o_ffn:
s_lshl_b32 s46, s20, 2
s_add_u32 s46, s46, s18
s_mul_i32 s47, s46, 2979
s_lshr_b32 s47, s47, 16
s_mul_i32 s48, s47, 22
s_sub_u32 s30, s46, s48
s_cmp_ge_u32 s47, 16
s_cbranch_scc1 L_o_ffn_done
s_lshl_b32 s22, s47, 17
s_add_u32 s22, s22, 13631488
s_mul_i32 s23, s47, 1441792
s_lshl_b32 s48, s30, 11
s_add_u32 s23, s23, s48
s_add_u32 s23, s23, 100794368
s_lshl_b32 s29, s30, 7
v_mul_u32_u24 v5, 22016, v2
v_lshl_add_u32 v5, v3, 3, v5
s_add_u32 s46, s29, 0
buffer_load_dwordx2 v[128:129], v5, s[12:15], s46 offen
buffer_load_dwordx2 v[130:131], v5, s[12:15], s46 offen offset:2752
s_add_u32 s46, s29, 5504
buffer_load_dwordx2 v[132:133], v5, s[12:15], s46 offen
buffer_load_dwordx2 v[134:135], v5, s[12:15], s46 offen offset:2752
s_add_u32 s46, s29, 11008
buffer_load_dwordx2 v[136:137], v5, s[12:15], s46 offen
buffer_load_dwordx2 v[138:139], v5, s[12:15], s46 offen offset:2752
s_add_u32 s46, s29, 16512
buffer_load_dwordx2 v[140:141], v5, s[12:15], s46 offen
buffer_load_dwordx2 v[142:143], v5, s[12:15], s46 offen offset:2752
s_add_u32 s46, s29, 88064
buffer_load_dwordx2 v[144:145], v5, s[12:15], s46 offen
buffer_load_dwordx2 v[146:147], v5, s[12:15], s46 offen offset:2752
s_add_u32 s46, s29, 93568
buffer_load_dwordx2 v[148:149], v5, s[12:15], s46 offen
buffer_load_dwordx2 v[150:151], v5, s[12:15], s46 offen offset:2752
s_add_u32 s46, s29, 99072
buffer_load_dwordx2 v[152:153], v5, s[12:15], s46 offen
buffer_load_dwordx2 v[154:155], v5, s[12:15], s46 offen offset:2752
s_add_u32 s46, s29, 104576
buffer_load_dwordx2 v[156:157], v5, s[12:15], s46 offen
buffer_load_dwordx2 v[158:159], v5, s[12:15], s46 offen offset:2752
s_add_u32 s46, s29, 176128
buffer_load_dwordx2 v[160:161], v5, s[12:15], s46 offen
buffer_load_dwordx2 v[162:163], v5, s[12:15], s46 offen offset:2752
s_add_u32 s46, s29, 181632
buffer_load_dwordx2 v[164:165], v5, s[12:15], s46 offen
buffer_load_dwordx2 v[166:167], v5, s[12:15], s46 offen offset:2752
s_add_u32 s46, s29, 187136
buffer_load_dwordx2 v[168:169], v5, s[12:15], s46 offen
buffer_load_dwordx2 v[170:171], v5, s[12:15], s46 offen offset:2752
s_add_u32 s46, s29, 192640
buffer_load_dwordx2 v[172:173], v5, s[12:15], s46 offen
buffer_load_dwordx2 v[174:175], v5, s[12:15], s46 offen offset:2752
s_add_u32 s46, s29, 264192
buffer_load_dwordx2 v[176:177], v5, s[12:15], s46 offen
buffer_load_dwordx2 v[178:179], v5, s[12:15], s46 offen offset:2752
s_add_u32 s46, s29, 269696
buffer_load_dwordx2 v[180:181], v5, s[12:15], s46 offen
buffer_load_dwordx2 v[182:183], v5, s[12:15], s46 offen offset:2752
s_add_u32 s46, s29, 275200
buffer_load_dwordx2 v[184:185], v5, s[12:15], s46 offen
buffer_load_dwordx2 v[186:187], v5, s[12:15], s46 offen offset:2752
s_add_u32 s46, s29, 280704
buffer_load_dwordx2 v[188:189], v5, s[12:15], s46 offen
buffer_load_dwordx2 v[190:191], v5, s[12:15], s46 offen offset:2752
s_add_u32 s46, s29, 352256
buffer_load_dwordx2 v[192:193], v5, s[12:15], s46 offen
buffer_load_dwordx2 v[194:195], v5, s[12:15], s46 offen offset:2752
s_add_u32 s46, s29, 357760
buffer_load_dwordx2 v[196:197], v5, s[12:15], s46 offen
buffer_load_dwordx2 v[198:199], v5, s[12:15], s46 offen offset:2752
s_add_u32 s46, s29, 363264
buffer_load_dwordx2 v[200:201], v5, s[12:15], s46 offen
buffer_load_dwordx2 v[202:203], v5, s[12:15], s46 offen offset:2752
s_add_u32 s46, s29, 368768
buffer_load_dwordx2 v[204:205], v5, s[12:15], s46 offen
buffer_load_dwordx2 v[206:207], v5, s[12:15], s46 offen offset:2752
s_add_u32 s46, s29, 440320
buffer_load_dwordx2 v[208:209], v5, s[12:15], s46 offen
buffer_load_dwordx2 v[210:211], v5, s[12:15], s46 offen offset:2752
s_add_u32 s46, s29, 445824
buffer_load_dwordx2 v[212:213], v5, s[12:15], s46 offen
buffer_load_dwordx2 v[214:215], v5, s[12:15], s46 offen offset:2752
s_add_u32 s46, s29, 451328
buffer_load_dwordx2 v[216:217], v5, s[12:15], s46 offen
buffer_load_dwordx2 v[218:219], v5, s[12:15], s46 offen offset:2752
s_add_u32 s46, s29, 456832
buffer_load_dwordx2 v[220:221], v5, s[12:15], s46 offen
buffer_load_dwordx2 v[222:223], v5, s[12:15], s46 offen offset:2752
s_add_u32 s46, s29, 528384
buffer_load_dwordx2 v[224:225], v5, s[12:15], s46 offen
buffer_load_dwordx2 v[226:227], v5, s[12:15], s46 offen offset:2752
s_add_u32 s46, s29, 533888
buffer_load_dwordx2 v[228:229], v5, s[12:15], s46 offen
buffer_load_dwordx2 v[230:231], v5, s[12:15], s46 offen offset:2752
s_add_u32 s46, s29, 539392
buffer_load_dwordx2 v[232:233], v5, s[12:15], s46 offen
buffer_load_dwordx2 v[234:235], v5, s[12:15], s46 offen offset:2752
s_add_u32 s46, s29, 544896
buffer_load_dwordx2 v[236:237], v5, s[12:15], s46 offen
buffer_load_dwordx2 v[238:239], v5, s[12:15], s46 offen offset:2752
s_waitcnt vmcnt(48)
s_add_u32 s46, s29, 616448
buffer_load_dwordx2 v[240:241], v5, s[12:15], s46 offen
buffer_load_dwordx2 v[242:243], v5, s[12:15], s46 offen offset:2752
s_add_u32 s46, s29, 621952
buffer_load_dwordx2 v[244:245], v5, s[12:15], s46 offen
buffer_load_dwordx2 v[246:247], v5, s[12:15], s46 offen offset:2752
s_add_u32 s46, s29, 627456
buffer_load_dwordx2 v[248:249], v5, s[12:15], s46 offen
buffer_load_dwordx2 v[250:251], v5, s[12:15], s46 offen offset:2752
s_add_u32 s46, s29, 632960
buffer_load_dwordx2 v[252:253], v5, s[12:15], s46 offen
buffer_load_dwordx2 v[254:255], v5, s[12:15], s46 offen offset:2752
v_perm_b32 v80, v130, v128, s50
v_perm_b32 v81, v134, v132, s50
v_perm_b32 v82, v138, v136, s50
v_perm_b32 v83, v142, v140, s50
v_accvgpr_write_b32 a0, v80
v_accvgpr_write_b32 a1, v81
v_accvgpr_write_b32 a2, v82
v_accvgpr_write_b32 a3, v83
v_perm_b32 v84, v130, v128, s51
v_perm_b32 v85, v134, v132, s51
v_perm_b32 v86, v138, v136, s51
v_perm_b32 v87, v142, v140, s51
v_accvgpr_write_b32 a4, v84
v_accvgpr_write_b32 a5, v85
v_accvgpr_write_b32 a6, v86
v_accvgpr_write_b32 a7, v87
v_perm_b32 v80, v131, v129, s50
v_perm_b32 v81, v135, v133, s50
v_perm_b32 v82, v139, v137, s50
v_perm_b32 v83, v143, v141, s50
v_accvgpr_write_b32 a8, v80
v_accvgpr_write_b32 a9, v81
v_accvgpr_write_b32 a10, v82
v_accvgpr_write_b32 a11, v83
v_perm_b32 v84, v131, v129, s51
v_perm_b32 v85, v135, v133, s51
v_perm_b32 v86, v139, v137, s51
v_perm_b32 v87, v143, v141, s51
v_accvgpr_write_b32 a12, v84
v_accvgpr_write_b32 a13, v85
v_accvgpr_write_b32 a14, v86
v_accvgpr_write_b32 a15, v87
s_waitcnt vmcnt(48)
s_add_u32 s46, s29, 704512
buffer_load_dwordx2 v[128:129], v5, s[12:15], s46 offen
buffer_load_dwordx2 v[130:131], v5, s[12:15], s46 offen offset:2752
s_add_u32 s46, s29, 710016
buffer_load_dwordx2 v[132:133], v5, s[12:15], s46 offen
buffer_load_dwordx2 v[134:135], v5, s[12:15], s46 offen offset:2752
s_add_u32 s46, s29, 715520
buffer_load_dwordx2 v[136:137], v5, s[12:15], s46 offen
buffer_load_dwordx2 v[138:139], v5, s[12:15], s46 offen offset:2752
s_add_u32 s46, s29, 721024
buffer_load_dwordx2 v[140:141], v5, s[12:15], s46 offen
buffer_load_dwordx2 v[142:143], v5, s[12:15], s46 offen offset:2752
v_perm_b32 v80, v146, v144, s50
v_perm_b32 v81, v150, v148, s50
v_perm_b32 v82, v154, v152, s50
v_perm_b32 v83, v158, v156, s50
v_accvgpr_write_b32 a16, v80
v_accvgpr_write_b32 a17, v81
v_accvgpr_write_b32 a18, v82
v_accvgpr_write_b32 a19, v83
v_perm_b32 v84, v146, v144, s51
v_perm_b32 v85, v150, v148, s51
v_perm_b32 v86, v154, v152, s51
v_perm_b32 v87, v158, v156, s51
v_accvgpr_write_b32 a20, v84
v_accvgpr_write_b32 a21, v85
v_accvgpr_write_b32 a22, v86
v_accvgpr_write_b32 a23, v87
v_perm_b32 v80, v147, v145, s50
v_perm_b32 v81, v151, v149, s50
v_perm_b32 v82, v155, v153, s50
v_perm_b32 v83, v159, v157, s50
v_accvgpr_write_b32 a24, v80
v_accvgpr_write_b32 a25, v81
v_accvgpr_write_b32 a26, v82
v_accvgpr_write_b32 a27, v83
v_perm_b32 v84, v147, v145, s51
v_perm_b32 v85, v151, v149, s51
v_perm_b32 v86, v155, v153, s51
v_perm_b32 v87, v159, v157, s51
v_accvgpr_write_b32 a28, v84
v_accvgpr_write_b32 a29, v85
v_accvgpr_write_b32 a30, v86
v_accvgpr_write_b32 a31, v87
s_waitcnt vmcnt(48)
s_add_u32 s46, s29, 792576
buffer_load_dwordx2 v[144:145], v5, s[12:15], s46 offen
buffer_load_dwordx2 v[146:147], v5, s[12:15], s46 offen offset:2752
s_add_u32 s46, s29, 798080
buffer_load_dwordx2 v[148:149], v5, s[12:15], s46 offen
buffer_load_dwordx2 v[150:151], v5, s[12:15], s46 offen offset:2752
s_add_u32 s46, s29, 803584
buffer_load_dwordx2 v[152:153], v5, s[12:15], s46 offen
buffer_load_dwordx2 v[154:155], v5, s[12:15], s46 offen offset:2752
s_add_u32 s46, s29, 809088
buffer_load_dwordx2 v[156:157], v5, s[12:15], s46 offen
buffer_load_dwordx2 v[158:159], v5, s[12:15], s46 offen offset:2752
v_perm_b32 v80, v162, v160, s50
v_perm_b32 v81, v166, v164, s50
v_perm_b32 v82, v170, v168, s50
v_perm_b32 v83, v174, v172, s50
v_accvgpr_write_b32 a32, v80
v_accvgpr_write_b32 a33, v81
v_accvgpr_write_b32 a34, v82
v_accvgpr_write_b32 a35, v83
v_perm_b32 v84, v162, v160, s51
v_perm_b32 v85, v166, v164, s51
v_perm_b32 v86, v170, v168, s51
v_perm_b32 v87, v174, v172, s51
v_accvgpr_write_b32 a36, v84
v_accvgpr_write_b32 a37, v85
v_accvgpr_write_b32 a38, v86
v_accvgpr_write_b32 a39, v87
v_perm_b32 v80, v163, v161, s50
v_perm_b32 v81, v167, v165, s50
v_perm_b32 v82, v171, v169, s50
v_perm_b32 v83, v175, v173, s50
v_accvgpr_write_b32 a40, v80
v_accvgpr_write_b32 a41, v81
v_accvgpr_write_b32 a42, v82
v_accvgpr_write_b32 a43, v83
v_perm_b32 v84, v163, v161, s51
v_perm_b32 v85, v167, v165, s51
v_perm_b32 v86, v171, v169, s51
v_perm_b32 v87, v175, v173, s51
v_accvgpr_write_b32 a44, v84
v_accvgpr_write_b32 a45, v85
v_accvgpr_write_b32 a46, v86
v_accvgpr_write_b32 a47, v87
s_waitcnt vmcnt(48)
s_add_u32 s46, s29, 880640
buffer_load_dwordx2 v[160:161], v5, s[12:15], s46 offen
buffer_load_dwordx2 v[162:163], v5, s[12:15], s46 offen offset:2752
s_add_u32 s46, s29, 886144
buffer_load_dwordx2 v[164:165], v5, s[12:15], s46 offen
buffer_load_dwordx2 v[166:167], v5, s[12:15], s46 offen offset:2752
s_add_u32 s46, s29, 891648
buffer_load_dwordx2 v[168:169], v5, s[12:15], s46 offen
buffer_load_dwordx2 v[170:171], v5, s[12:15], s46 offen offset:2752
s_add_u32 s46, s29, 897152
buffer_load_dwordx2 v[172:173], v5, s[12:15], s46 offen
buffer_load_dwordx2 v[174:175], v5, s[12:15], s46 offen offset:2752
v_perm_b32 v80, v178, v176, s50
v_perm_b32 v81, v182, v180, s50
v_perm_b32 v82, v186, v184, s50
v_perm_b32 v83, v190, v188, s50
v_accvgpr_write_b32 a48, v80
v_accvgpr_write_b32 a49, v81
v_accvgpr_write_b32 a50, v82
v_accvgpr_write_b32 a51, v83
v_perm_b32 v84, v178, v176, s51
v_perm_b32 v85, v182, v180, s51
v_perm_b32 v86, v186, v184, s51
v_perm_b32 v87, v190, v188, s51
v_accvgpr_write_b32 a52, v84
v_accvgpr_write_b32 a53, v85
v_accvgpr_write_b32 a54, v86
v_accvgpr_write_b32 a55, v87
v_perm_b32 v80, v179, v177, s50
v_perm_b32 v81, v183, v181, s50
v_perm_b32 v82, v187, v185, s50
v_perm_b32 v83, v191, v189, s50
v_accvgpr_write_b32 a56, v80
v_accvgpr_write_b32 a57, v81
v_accvgpr_write_b32 a58, v82
v_accvgpr_write_b32 a59, v83
v_perm_b32 v84, v179, v177, s51
v_perm_b32 v85, v183, v181, s51
v_perm_b32 v86, v187, v185, s51
v_perm_b32 v87, v191, v189, s51
v_accvgpr_write_b32 a60, v84
v_accvgpr_write_b32 a61, v85
v_accvgpr_write_b32 a62, v86
v_accvgpr_write_b32 a63, v87
s_waitcnt vmcnt(48)
s_add_u32 s46, s29, 968704
buffer_load_dwordx2 v[176:177], v5, s[12:15], s46 offen
buffer_load_dwordx2 v[178:179], v5, s[12:15], s46 offen offset:2752
s_add_u32 s46, s29, 974208
buffer_load_dwordx2 v[180:181], v5, s[12:15], s46 offen
buffer_load_dwordx2 v[182:183], v5, s[12:15], s46 offen offset:2752
s_add_u32 s46, s29, 979712
buffer_load_dwordx2 v[184:185], v5, s[12:15], s46 offen
buffer_load_dwordx2 v[186:187], v5, s[12:15], s46 offen offset:2752
s_add_u32 s46, s29, 985216
buffer_load_dwordx2 v[188:189], v5, s[12:15], s46 offen
buffer_load_dwordx2 v[190:191], v5, s[12:15], s46 offen offset:2752
v_perm_b32 v80, v194, v192, s50
v_perm_b32 v81, v198, v196, s50
v_perm_b32 v82, v202, v200, s50
v_perm_b32 v83, v206, v204, s50
v_accvgpr_write_b32 a64, v80
v_accvgpr_write_b32 a65, v81
v_accvgpr_write_b32 a66, v82
v_accvgpr_write_b32 a67, v83
v_perm_b32 v84, v194, v192, s51
v_perm_b32 v85, v198, v196, s51
v_perm_b32 v86, v202, v200, s51
v_perm_b32 v87, v206, v204, s51
v_accvgpr_write_b32 a68, v84
v_accvgpr_write_b32 a69, v85
v_accvgpr_write_b32 a70, v86
v_accvgpr_write_b32 a71, v87
v_perm_b32 v80, v195, v193, s50
v_perm_b32 v81, v199, v197, s50
v_perm_b32 v82, v203, v201, s50
v_perm_b32 v83, v207, v205, s50
v_accvgpr_write_b32 a72, v80
v_accvgpr_write_b32 a73, v81
v_accvgpr_write_b32 a74, v82
v_accvgpr_write_b32 a75, v83
v_perm_b32 v84, v195, v193, s51
v_perm_b32 v85, v199, v197, s51
v_perm_b32 v86, v203, v201, s51
v_perm_b32 v87, v207, v205, s51
v_accvgpr_write_b32 a76, v84
v_accvgpr_write_b32 a77, v85
v_accvgpr_write_b32 a78, v86
v_accvgpr_write_b32 a79, v87
s_waitcnt vmcnt(48)
s_add_u32 s46, s29, 1056768
buffer_load_dwordx2 v[192:193], v5, s[12:15], s46 offen
buffer_load_dwordx2 v[194:195], v5, s[12:15], s46 offen offset:2752
s_add_u32 s46, s29, 1062272
buffer_load_dwordx2 v[196:197], v5, s[12:15], s46 offen
buffer_load_dwordx2 v[198:199], v5, s[12:15], s46 offen offset:2752
s_add_u32 s46, s29, 1067776
buffer_load_dwordx2 v[200:201], v5, s[12:15], s46 offen
buffer_load_dwordx2 v[202:203], v5, s[12:15], s46 offen offset:2752
s_add_u32 s46, s29, 1073280
buffer_load_dwordx2 v[204:205], v5, s[12:15], s46 offen
buffer_load_dwordx2 v[206:207], v5, s[12:15], s46 offen offset:2752
v_perm_b32 v80, v210, v208, s50
v_perm_b32 v81, v214, v212, s50
v_perm_b32 v82, v218, v216, s50
v_perm_b32 v83, v222, v220, s50
v_accvgpr_write_b32 a80, v80
v_accvgpr_write_b32 a81, v81
v_accvgpr_write_b32 a82, v82
v_accvgpr_write_b32 a83, v83
v_perm_b32 v84, v210, v208, s51
v_perm_b32 v85, v214, v212, s51
v_perm_b32 v86, v218, v216, s51
v_perm_b32 v87, v222, v220, s51
v_accvgpr_write_b32 a84, v84
v_accvgpr_write_b32 a85, v85
v_accvgpr_write_b32 a86, v86
v_accvgpr_write_b32 a87, v87
v_perm_b32 v80, v211, v209, s50
v_perm_b32 v81, v215, v213, s50
v_perm_b32 v82, v219, v217, s50
v_perm_b32 v83, v223, v221, s50
v_accvgpr_write_b32 a88, v80
v_accvgpr_write_b32 a89, v81
v_accvgpr_write_b32 a90, v82
v_accvgpr_write_b32 a91, v83
v_perm_b32 v84, v211, v209, s51
v_perm_b32 v85, v215, v213, s51
v_perm_b32 v86, v219, v217, s51
v_perm_b32 v87, v223, v221, s51
v_accvgpr_write_b32 a92, v84
v_accvgpr_write_b32 a93, v85
v_accvgpr_write_b32 a94, v86
v_accvgpr_write_b32 a95, v87
s_waitcnt vmcnt(48)
s_add_u32 s46, s29, 1144832
buffer_load_dwordx2 v[208:209], v5, s[12:15], s46 offen
buffer_load_dwordx2 v[210:211], v5, s[12:15], s46 offen offset:2752
s_add_u32 s46, s29, 1150336
buffer_load_dwordx2 v[212:213], v5, s[12:15], s46 offen
buffer_load_dwordx2 v[214:215], v5, s[12:15], s46 offen offset:2752
s_add_u32 s46, s29, 1155840
buffer_load_dwordx2 v[216:217], v5, s[12:15], s46 offen
buffer_load_dwordx2 v[218:219], v5, s[12:15], s46 offen offset:2752
s_add_u32 s46, s29, 1161344
buffer_load_dwordx2 v[220:221], v5, s[12:15], s46 offen
buffer_load_dwordx2 v[222:223], v5, s[12:15], s46 offen offset:2752
v_perm_b32 v80, v226, v224, s50
v_perm_b32 v81, v230, v228, s50
v_perm_b32 v82, v234, v232, s50
v_perm_b32 v83, v238, v236, s50
v_accvgpr_write_b32 a96, v80
v_accvgpr_write_b32 a97, v81
v_accvgpr_write_b32 a98, v82
v_accvgpr_write_b32 a99, v83
v_perm_b32 v84, v226, v224, s51
v_perm_b32 v85, v230, v228, s51
v_perm_b32 v86, v234, v232, s51
v_perm_b32 v87, v238, v236, s51
v_accvgpr_write_b32 a100, v84
v_accvgpr_write_b32 a101, v85
v_accvgpr_write_b32 a102, v86
v_accvgpr_write_b32 a103, v87
v_perm_b32 v80, v227, v225, s50
v_perm_b32 v81, v231, v229, s50
v_perm_b32 v82, v235, v233, s50
v_perm_b32 v83, v239, v237, s50
v_accvgpr_write_b32 a104, v80
v_accvgpr_write_b32 a105, v81
v_accvgpr_write_b32 a106, v82
v_accvgpr_write_b32 a107, v83
v_perm_b32 v84, v227, v225, s51
v_perm_b32 v85, v231, v229, s51
v_perm_b32 v86, v235, v233, s51
v_perm_b32 v87, v239, v237, s51
v_accvgpr_write_b32 a108, v84
v_accvgpr_write_b32 a109, v85
v_accvgpr_write_b32 a110, v86
v_accvgpr_write_b32 a111, v87
s_waitcnt vmcnt(48)
s_add_u32 s46, s29, 1232896
buffer_load_dwordx2 v[224:225], v5, s[12:15], s46 offen
buffer_load_dwordx2 v[226:227], v5, s[12:15], s46 offen offset:2752
s_add_u32 s46, s29, 1238400
buffer_load_dwordx2 v[228:229], v5, s[12:15], s46 offen
buffer_load_dwordx2 v[230:231], v5, s[12:15], s46 offen offset:2752
s_add_u32 s46, s29, 1243904
buffer_load_dwordx2 v[232:233], v5, s[12:15], s46 offen
buffer_load_dwordx2 v[234:235], v5, s[12:15], s46 offen offset:2752
s_add_u32 s46, s29, 1249408
buffer_load_dwordx2 v[236:237], v5, s[12:15], s46 offen
buffer_load_dwordx2 v[238:239], v5, s[12:15], s46 offen offset:2752
v_perm_b32 v80, v242, v240, s50
v_perm_b32 v81, v246, v244, s50
v_perm_b32 v82, v250, v248, s50
v_perm_b32 v83, v254, v252, s50
v_accvgpr_write_b32 a112, v80
v_accvgpr_write_b32 a113, v81
v_accvgpr_write_b32 a114, v82
v_accvgpr_write_b32 a115, v83
v_perm_b32 v84, v242, v240, s51
v_perm_b32 v85, v246, v244, s51
v_perm_b32 v86, v250, v248, s51
v_perm_b32 v87, v254, v252, s51
v_accvgpr_write_b32 a116, v84
v_accvgpr_write_b32 a117, v85
v_accvgpr_write_b32 a118, v86
v_accvgpr_write_b32 a119, v87
v_perm_b32 v80, v243, v241, s50
v_perm_b32 v81, v247, v245, s50
v_perm_b32 v82, v251, v249, s50
v_perm_b32 v83, v255, v253, s50
v_accvgpr_write_b32 a120, v80
v_accvgpr_write_b32 a121, v81
v_accvgpr_write_b32 a122, v82
v_accvgpr_write_b32 a123, v83
v_perm_b32 v84, v243, v241, s51
v_perm_b32 v85, v247, v245, s51
v_perm_b32 v86, v251, v249, s51
v_perm_b32 v87, v255, v253, s51
v_accvgpr_write_b32 a124, v84
v_accvgpr_write_b32 a125, v85
v_accvgpr_write_b32 a126, v86
v_accvgpr_write_b32 a127, v87
s_waitcnt vmcnt(48)
s_add_u32 s46, s29, 1320960
buffer_load_dwordx2 v[240:241], v5, s[12:15], s46 offen
buffer_load_dwordx2 v[242:243], v5, s[12:15], s46 offen offset:2752
s_add_u32 s46, s29, 1326464
buffer_load_dwordx2 v[244:245], v5, s[12:15], s46 offen
buffer_load_dwordx2 v[246:247], v5, s[12:15], s46 offen offset:2752
s_add_u32 s46, s29, 1331968
buffer_load_dwordx2 v[248:249], v5, s[12:15], s46 offen
buffer_load_dwordx2 v[250:251], v5, s[12:15], s46 offen offset:2752
s_add_u32 s46, s29, 1337472
buffer_load_dwordx2 v[252:253], v5, s[12:15], s46 offen
buffer_load_dwordx2 v[254:255], v5, s[12:15], s46 offen offset:2752
v_perm_b32 v80, v130, v128, s50
v_perm_b32 v81, v134, v132, s50
v_perm_b32 v82, v138, v136, s50
v_perm_b32 v83, v142, v140, s50
v_accvgpr_write_b32 a128, v80
v_accvgpr_write_b32 a129, v81
v_accvgpr_write_b32 a130, v82
v_accvgpr_write_b32 a131, v83
v_perm_b32 v84, v130, v128, s51
v_perm_b32 v85, v134, v132, s51
v_perm_b32 v86, v138, v136, s51
v_perm_b32 v87, v142, v140, s51
v_accvgpr_write_b32 a132, v84
v_accvgpr_write_b32 a133, v85
v_accvgpr_write_b32 a134, v86
v_accvgpr_write_b32 a135, v87
v_perm_b32 v80, v131, v129, s50
v_perm_b32 v81, v135, v133, s50
v_perm_b32 v82, v139, v137, s50
v_perm_b32 v83, v143, v141, s50
v_accvgpr_write_b32 a136, v80
v_accvgpr_write_b32 a137, v81
v_accvgpr_write_b32 a138, v82
v_accvgpr_write_b32 a139, v83
v_perm_b32 v84, v131, v129, s51
v_perm_b32 v85, v135, v133, s51
v_perm_b32 v86, v139, v137, s51
v_perm_b32 v87, v143, v141, s51
v_accvgpr_write_b32 a140, v84
v_accvgpr_write_b32 a141, v85
v_accvgpr_write_b32 a142, v86
v_accvgpr_write_b32 a143, v87
s_waitcnt vmcnt(48)
v_perm_b32 v80, v146, v144, s50
v_perm_b32 v81, v150, v148, s50
v_perm_b32 v82, v154, v152, s50
v_perm_b32 v83, v158, v156, s50
v_accvgpr_write_b32 a144, v80
v_accvgpr_write_b32 a145, v81
v_accvgpr_write_b32 a146, v82
v_accvgpr_write_b32 a147, v83
v_perm_b32 v84, v146, v144, s51
v_perm_b32 v85, v150, v148, s51
v_perm_b32 v86, v154, v152, s51
v_perm_b32 v87, v158, v156, s51
v_accvgpr_write_b32 a148, v84
v_accvgpr_write_b32 a149, v85
v_accvgpr_write_b32 a150, v86
v_accvgpr_write_b32 a151, v87
v_perm_b32 v80, v147, v145, s50
v_perm_b32 v81, v151, v149, s50
v_perm_b32 v82, v155, v153, s50
v_perm_b32 v83, v159, v157, s50
v_accvgpr_write_b32 a152, v80
v_accvgpr_write_b32 a153, v81
v_accvgpr_write_b32 a154, v82
v_accvgpr_write_b32 a155, v83
v_perm_b32 v84, v147, v145, s51
v_perm_b32 v85, v151, v149, s51
v_perm_b32 v86, v155, v153, s51
v_perm_b32 v87, v159, v157, s51
v_accvgpr_write_b32 a156, v84
v_accvgpr_write_b32 a157, v85
v_accvgpr_write_b32 a158, v86
v_accvgpr_write_b32 a159, v87
s_waitcnt vmcnt(40)
v_perm_b32 v80, v162, v160, s50
v_perm_b32 v81, v166, v164, s50
v_perm_b32 v82, v170, v168, s50
v_perm_b32 v83, v174, v172, s50
v_accvgpr_write_b32 a160, v80
v_accvgpr_write_b32 a161, v81
v_accvgpr_write_b32 a162, v82
v_accvgpr_write_b32 a163, v83
v_perm_b32 v84, v162, v160, s51
v_perm_b32 v85, v166, v164, s51
v_perm_b32 v86, v170, v168, s51
v_perm_b32 v87, v174, v172, s51
v_accvgpr_write_b32 a164, v84
v_accvgpr_write_b32 a165, v85
v_accvgpr_write_b32 a166, v86
v_accvgpr_write_b32 a167, v87
v_perm_b32 v80, v163, v161, s50
v_perm_b32 v81, v167, v165, s50
v_perm_b32 v82, v171, v169, s50
v_perm_b32 v83, v175, v173, s50
v_accvgpr_write_b32 a168, v80
v_accvgpr_write_b32 a169, v81
v_accvgpr_write_b32 a170, v82
v_accvgpr_write_b32 a171, v83
v_perm_b32 v84, v163, v161, s51
v_perm_b32 v85, v167, v165, s51
v_perm_b32 v86, v171, v169, s51
v_perm_b32 v87, v175, v173, s51
v_accvgpr_write_b32 a172, v84
v_accvgpr_write_b32 a173, v85
v_accvgpr_write_b32 a174, v86
v_accvgpr_write_b32 a175, v87
s_waitcnt vmcnt(32)
v_perm_b32 v80, v178, v176, s50
v_perm_b32 v81, v182, v180, s50
v_perm_b32 v82, v186, v184, s50
v_perm_b32 v83, v190, v188, s50
v_accvgpr_write_b32 a176, v80
v_accvgpr_write_b32 a177, v81
v_accvgpr_write_b32 a178, v82
v_accvgpr_write_b32 a179, v83
v_perm_b32 v84, v178, v176, s51
v_perm_b32 v85, v182, v180, s51
v_perm_b32 v86, v186, v184, s51
v_perm_b32 v87, v190, v188, s51
v_accvgpr_write_b32 a180, v84
v_accvgpr_write_b32 a181, v85
v_accvgpr_write_b32 a182, v86
v_accvgpr_write_b32 a183, v87
v_perm_b32 v80, v179, v177, s50
v_perm_b32 v81, v183, v181, s50
v_perm_b32 v82, v187, v185, s50
v_perm_b32 v83, v191, v189, s50
v_accvgpr_write_b32 a184, v80
v_accvgpr_write_b32 a185, v81
v_accvgpr_write_b32 a186, v82
v_accvgpr_write_b32 a187, v83
v_perm_b32 v84, v179, v177, s51
v_perm_b32 v85, v183, v181, s51
v_perm_b32 v86, v187, v185, s51
v_perm_b32 v87, v191, v189, s51
v_accvgpr_write_b32 a188, v84
v_accvgpr_write_b32 a189, v85
v_accvgpr_write_b32 a190, v86
v_accvgpr_write_b32 a191, v87
s_waitcnt vmcnt(24)
v_perm_b32 v80, v194, v192, s50
v_perm_b32 v81, v198, v196, s50
v_perm_b32 v82, v202, v200, s50
v_perm_b32 v83, v206, v204, s50
v_accvgpr_write_b32 a192, v80
v_accvgpr_write_b32 a193, v81
v_accvgpr_write_b32 a194, v82
v_accvgpr_write_b32 a195, v83
v_perm_b32 v84, v194, v192, s51
v_perm_b32 v85, v198, v196, s51
v_perm_b32 v86, v202, v200, s51
v_perm_b32 v87, v206, v204, s51
v_accvgpr_write_b32 a196, v84
v_accvgpr_write_b32 a197, v85
v_accvgpr_write_b32 a198, v86
v_accvgpr_write_b32 a199, v87
v_perm_b32 v80, v195, v193, s50
v_perm_b32 v81, v199, v197, s50
v_perm_b32 v82, v203, v201, s50
v_perm_b32 v83, v207, v205, s50
v_accvgpr_write_b32 a200, v80
v_accvgpr_write_b32 a201, v81
v_accvgpr_write_b32 a202, v82
v_accvgpr_write_b32 a203, v83
v_perm_b32 v84, v195, v193, s51
v_perm_b32 v85, v199, v197, s51
v_perm_b32 v86, v203, v201, s51
v_perm_b32 v87, v207, v205, s51
v_accvgpr_write_b32 a204, v84
v_accvgpr_write_b32 a205, v85
v_accvgpr_write_b32 a206, v86
v_accvgpr_write_b32 a207, v87
s_waitcnt vmcnt(16)
v_perm_b32 v80, v210, v208, s50
v_perm_b32 v81, v214, v212, s50
v_perm_b32 v82, v218, v216, s50
v_perm_b32 v83, v222, v220, s50
v_accvgpr_write_b32 a208, v80
v_accvgpr_write_b32 a209, v81
v_accvgpr_write_b32 a210, v82
v_accvgpr_write_b32 a211, v83
v_perm_b32 v84, v210, v208, s51
v_perm_b32 v85, v214, v212, s51
v_perm_b32 v86, v218, v216, s51
v_perm_b32 v87, v222, v220, s51
v_accvgpr_write_b32 a212, v84
v_accvgpr_write_b32 a213, v85
v_accvgpr_write_b32 a214, v86
v_accvgpr_write_b32 a215, v87
v_perm_b32 v80, v211, v209, s50
v_perm_b32 v81, v215, v213, s50
v_perm_b32 v82, v219, v217, s50
v_perm_b32 v83, v223, v221, s50
v_accvgpr_write_b32 a216, v80
v_accvgpr_write_b32 a217, v81
v_accvgpr_write_b32 a218, v82
v_accvgpr_write_b32 a219, v83
v_perm_b32 v84, v211, v209, s51
v_perm_b32 v85, v215, v213, s51
v_perm_b32 v86, v219, v217, s51
v_perm_b32 v87, v223, v221, s51
v_accvgpr_write_b32 a220, v84
v_accvgpr_write_b32 a221, v85
v_accvgpr_write_b32 a222, v86
v_accvgpr_write_b32 a223, v87
s_waitcnt vmcnt(8)
v_perm_b32 v80, v226, v224, s50
v_perm_b32 v81, v230, v228, s50
v_perm_b32 v82, v234, v232, s50
v_perm_b32 v83, v238, v236, s50
v_accvgpr_write_b32 a224, v80
v_accvgpr_write_b32 a225, v81
v_accvgpr_write_b32 a226, v82
v_accvgpr_write_b32 a227, v83
v_perm_b32 v84, v226, v224, s51
v_perm_b32 v85, v230, v228, s51
v_perm_b32 v86, v234, v232, s51
v_perm_b32 v87, v238, v236, s51
v_accvgpr_write_b32 a228, v84
v_accvgpr_write_b32 a229, v85
v_accvgpr_write_b32 a230, v86
v_accvgpr_write_b32 a231, v87
v_perm_b32 v80, v227, v225, s50
v_perm_b32 v81, v231, v229, s50
v_perm_b32 v82, v235, v233, s50
v_perm_b32 v83, v239, v237, s50
v_accvgpr_write_b32 a232, v80
v_accvgpr_write_b32 a233, v81
v_accvgpr_write_b32 a234, v82
v_accvgpr_write_b32 a235, v83
v_perm_b32 v84, v227, v225, s51
v_perm_b32 v85, v231, v229, s51
v_perm_b32 v86, v235, v233, s51
v_perm_b32 v87, v239, v237, s51
v_accvgpr_write_b32 a236, v84
v_accvgpr_write_b32 a237, v85
v_accvgpr_write_b32 a238, v86
v_accvgpr_write_b32 a239, v87
s_waitcnt vmcnt(0)
v_perm_b32 v80, v242, v240, s50
v_perm_b32 v81, v246, v244, s50
v_perm_b32 v82, v250, v248, s50
v_perm_b32 v83, v254, v252, s50
v_accvgpr_write_b32 a240, v80
v_accvgpr_write_b32 a241, v81
v_accvgpr_write_b32 a242, v82
v_accvgpr_write_b32 a243, v83
v_perm_b32 v84, v242, v240, s51
v_perm_b32 v85, v246, v244, s51
v_perm_b32 v86, v250, v248, s51
v_perm_b32 v87, v254, v252, s51
v_accvgpr_write_b32 a244, v84
v_accvgpr_write_b32 a245, v85
v_accvgpr_write_b32 a246, v86
v_accvgpr_write_b32 a247, v87
v_perm_b32 v80, v243, v241, s50
v_perm_b32 v81, v247, v245, s50
v_perm_b32 v82, v251, v249, s50
v_perm_b32 v83, v255, v253, s50
v_accvgpr_write_b32 a248, v80
v_accvgpr_write_b32 a249, v81
v_accvgpr_write_b32 a250, v82
v_accvgpr_write_b32 a251, v83
v_perm_b32 v84, v243, v241, s51
v_perm_b32 v85, v247, v245, s51
v_perm_b32 v86, v251, v249, s51
v_perm_b32 v87, v255, v253, s51
v_accvgpr_write_b32 a252, v84
v_accvgpr_write_b32 a253, v85
v_accvgpr_write_b32 a254, v86
v_accvgpr_write_b32 a255, v87
s_cmp_lg_u32 s18, 0
s_cbranch_scc1 L_o_cx_ok
v_mov_b32 v18, 4
L_o_cx:
global_load_dword v16, v18, s[4:5] sc1
s_waitcnt vmcnt(0)
v_cmp_gt_u32 vcc, 144, v16
s_cbranch_vccnz L_o_cx_re
L_o_cx_ok:
s_barrier
buffer_load_dwordx4 v[16:19], v1, s[8:11], s22 offen offset:0
buffer_load_dwordx4 v[20:23], v1, s[8:11], s22 offen offset:1024
buffer_load_dwordx4 v[24:27], v1, s[8:11], s22 offen offset:2048
buffer_load_dwordx4 v[28:31], v1, s[8:11], s22 offen offset:3072
s_add_u32 s22, s22, 4096
buffer_load_dwordx4 v[32:35], v1, s[8:11], s22 offen offset:0
buffer_load_dwordx4 v[36:39], v1, s[8:11], s22 offen offset:1024
buffer_load_dwordx4 v[40:43], v1, s[8:11], s22 offen offset:2048
buffer_load_dwordx4 v[44:47], v1, s[8:11], s22 offen offset:3072
s_add_u32 s22, s22, 4096
buffer_load_dwordx4 v[48:51], v1, s[8:11], s22 offen offset:0
buffer_load_dwordx4 v[52:55], v1, s[8:11], s22 offen offset:1024
buffer_load_dwordx4 v[56:59], v1, s[8:11], s22 offen offset:2048
buffer_load_dwordx4 v[60:63], v1, s[8:11], s22 offen offset:3072
s_add_u32 s22, s22, 4096
buffer_load_dwordx4 v[64:67], v1, s[8:11], s22 offen offset:0
buffer_load_dwordx4 v[68:71], v1, s[8:11], s22 offen offset:1024
buffer_load_dwordx4 v[72:75], v1, s[8:11], s22 offen offset:2048
buffer_load_dwordx4 v[76:79], v1, s[8:11], s22 offen offset:3072
s_add_u32 s22, s22, 4096
s_mov_b32 s28, 8
s_waitcnt vmcnt(0)
L_o_f1:
s_waitcnt vmcnt(17)
v_mfma_f32_16x16x32_bf16 v[80:83], a[0:3], v[16:19], 0
v_mfma_f32_16x16x32_bf16 v[84:87], a[4:7], v[16:19], 0
v_mfma_f32_16x16x32_bf16 v[88:91], a[8:11], v[16:19], 0
v_mfma_f32_16x16x32_bf16 v[92:95], a[12:15], v[16:19], 0
buffer_load_dwordx4 v[16:19], v1, s[8:11], s22 offen offset:0
s_waitcnt vmcnt(17)
v_mfma_f32_16x16x32_bf16 v[80:83], a[16:19], v[20:23], v[80:83]
v_mfma_f32_16x16x32_bf16 v[84:87], a[20:23], v[20:23], v[84:87]
v_mfma_f32_16x16x32_bf16 v[88:91], a[24:27], v[20:23], v[88:91]
v_mfma_f32_16x16x32_bf16 v[92:95], a[28:31], v[20:23], v[92:95]
buffer_load_dwordx4 v[20:23], v1, s[8:11], s22 offen offset:1024
s_waitcnt vmcnt(17)
v_mfma_f32_16x16x32_bf16 v[80:83], a[32:35], v[24:27], v[80:83]
v_mfma_f32_16x16x32_bf16 v[84:87], a[36:39], v[24:27], v[84:87]
v_mfma_f32_16x16x32_bf16 v[88:91], a[40:43], v[24:27], v[88:91]
v_mfma_f32_16x16x32_bf16 v[92:95], a[44:47], v[24:27], v[92:95]
buffer_load_dwordx4 v[24:27], v1, s[8:11], s22 offen offset:2048
s_waitcnt vmcnt(17)
v_mfma_f32_16x16x32_bf16 v[80:83], a[48:51], v[28:31], v[80:83]
v_mfma_f32_16x16x32_bf16 v[84:87], a[52:55], v[28:31], v[84:87]
v_mfma_f32_16x16x32_bf16 v[88:91], a[56:59], v[28:31], v[88:91]
v_mfma_f32_16x16x32_bf16 v[92:95], a[60:63], v[28:31], v[92:95]
buffer_load_dwordx4 v[28:31], v1, s[8:11], s22 offen offset:3072
s_add_u32 s22, s22, 4096
s_waitcnt vmcnt(17)
v_mfma_f32_16x16x32_bf16 v[80:83], a[64:67], v[32:35], v[80:83]
v_mfma_f32_16x16x32_bf16 v[84:87], a[68:71], v[32:35], v[84:87]
v_mfma_f32_16x16x32_bf16 v[88:91], a[72:75], v[32:35], v[88:91]
v_mfma_f32_16x16x32_bf16 v[92:95], a[76:79], v[32:35], v[92:95]
buffer_load_dwordx4 v[32:35], v1, s[8:11], s22 offen offset:0
s_waitcnt vmcnt(17)
v_mfma_f32_16x16x32_bf16 v[80:83], a[80:83], v[36:39], v[80:83]
v_mfma_f32_16x16x32_bf16 v[84:87], a[84:87], v[36:39], v[84:87]
v_mfma_f32_16x16x32_bf16 v[88:91], a[88:91], v[36:39], v[88:91]
v_mfma_f32_16x16x32_bf16 v[92:95], a[92:95], v[36:39], v[92:95]
buffer_load_dwordx4 v[36:39], v1, s[8:11], s22 offen offset:1024
s_waitcnt vmcnt(17)
v_mfma_f32_16x16x32_bf16 v[80:83], a[96:99], v[40:43], v[80:83]
v_mfma_f32_16x16x32_bf16 v[84:87], a[100:103], v[40:43], v[84:87]
v_mfma_f32_16x16x32_bf16 v[88:91], a[104:107], v[40:43], v[88:91]
v_mfma_f32_16x16x32_bf16 v[92:95], a[108:111], v[40:43], v[92:95]
buffer_load_dwordx4 v[40:43], v1, s[8:11], s22 offen offset:2048
s_waitcnt vmcnt(17)
v_mfma_f32_16x16x32_bf16 v[80:83], a[112:115], v[44:47], v[80:83]
v_mfma_f32_16x16x32_bf16 v[84:87], a[116:119], v[44:47], v[84:87]
v_mfma_f32_16x16x32_bf16 v[88:91], a[120:123], v[44:47], v[88:91]
v_mfma_f32_16x16x32_bf16 v[92:95], a[124:127], v[44:47], v[92:95]
buffer_load_dwordx4 v[44:47], v1, s[8:11], s22 offen offset:3072
s_add_u32 s22, s22, 4096
s_waitcnt vmcnt(17)
v_mfma_f32_16x16x32_bf16 v[80:83], a[128:131], v[48:51], v[80:83]
v_mfma_f32_16x16x32_bf16 v[84:87], a[132:135], v[48:51], v[84:87]
v_mfma_f32_16x16x32_bf16 v[88:91], a[136:139], v[48:51], v[88:91]
v_mfma_f32_16x16x32_bf16 v[92:95], a[140:143], v[48:51], v[92:95]
buffer_load_dwordx4 v[48:51], v1, s[8:11], s22 offen offset:0
s_waitcnt vmcnt(17)
v_mfma_f32_16x16x32_bf16 v[80:83], a[144:147], v[52:55], v[80:83]
v_mfma_f32_16x16x32_bf16 v[84:87], a[148:151], v[52:55], v[84:87]
v_mfma_f32_16x16x32_bf16 v[88:91], a[152:155], v[52:55], v[88:91]
v_mfma_f32_16x16x32_bf16 v[92:95], a[156:159], v[52:55], v[92:95]
buffer_load_dwordx4 v[52:55], v1, s[8:11], s22 offen offset:1024
s_waitcnt vmcnt(17)
v_mfma_f32_16x16x32_bf16 v[80:83], a[160:163], v[56:59], v[80:83]
v_mfma_f32_16x16x32_bf16 v[84:87], a[164:167], v[56:59], v[84:87]
v_mfma_f32_16x16x32_bf16 v[88:91], a[168:171], v[56:59], v[88:91]
v_mfma_f32_16x16x32_bf16 v[92:95], a[172:175], v[56:59], v[92:95]
buffer_load_dwordx4 v[56:59], v1, s[8:11], s22 offen offset:2048
s_waitcnt vmcnt(17)
v_mfma_f32_16x16x32_bf16 v[80:83], a[176:179], v[60:63], v[80:83]
v_mfma_f32_16x16x32_bf16 v[84:87], a[180:183], v[60:63], v[84:87]
v_mfma_f32_16x16x32_bf16 v[88:91], a[184:187], v[60:63], v[88:91]
v_mfma_f32_16x16x32_bf16 v[92:95], a[188:191], v[60:63], v[92:95]
buffer_load_dwordx4 v[60:63], v1, s[8:11], s22 offen offset:3072
s_add_u32 s22, s22, 4096
s_waitcnt vmcnt(17)
v_mfma_f32_16x16x32_bf16 v[80:83], a[192:195], v[64:67], v[80:83]
v_mfma_f32_16x16x32_bf16 v[84:87], a[196:199], v[64:67], v[84:87]
v_mfma_f32_16x16x32_bf16 v[88:91], a[200:203], v[64:67], v[88:91]
v_mfma_f32_16x16x32_bf16 v[92:95], a[204:207], v[64:67], v[92:95]
buffer_load_dwordx4 v[64:67], v1, s[8:11], s22 offen offset:0
s_waitcnt vmcnt(17)
v_mfma_f32_16x16x32_bf16 v[80:83], a[208:211], v[68:71], v[80:83]
v_mfma_f32_16x16x32_bf16 v[84:87], a[212:215], v[68:71], v[84:87]
v_mfma_f32_16x16x32_bf16 v[88:91], a[216:219], v[68:71], v[88:91]
v_mfma_f32_16x16x32_bf16 v[92:95], a[220:223], v[68:71], v[92:95]
buffer_load_dwordx4 v[68:71], v1, s[8:11], s22 offen offset:1024
s_waitcnt vmcnt(17)
v_mfma_f32_16x16x32_bf16 v[80:83], a[224:227], v[72:75], v[80:83]
v_mfma_f32_16x16x32_bf16 v[84:87], a[228:231], v[72:75], v[84:87]
v_mfma_f32_16x16x32_bf16 v[88:91], a[232:235], v[72:75], v[88:91]
v_mfma_f32_16x16x32_bf16 v[92:95], a[236:239], v[72:75], v[92:95]
buffer_load_dwordx4 v[72:75], v1, s[8:11], s22 offen offset:2048
s_waitcnt vmcnt(17)
v_mfma_f32_16x16x32_bf16 v[80:83], a[240:243], v[76:79], v[80:83]
v_mfma_f32_16x16x32_bf16 v[84:87], a[244:247], v[76:79], v[84:87]
v_mfma_f32_16x16x32_bf16 v[88:91], a[248:251], v[76:79], v[88:91]
v_mfma_f32_16x16x32_bf16 v[92:95], a[252:255], v[76:79], v[92:95]
buffer_load_dwordx4 v[76:79], v1, s[8:11], s22 offen offset:3072
s_add_u32 s22, s22, 4096
s_nop 0
v_max_f32 v80, 0, v80
v_max_f32 v81, 0, v81
v_max_f32 v82, 0, v82
v_max_f32 v83, 0, v83
v_max_f32 v84, 0, v84
v_max_f32 v85, 0, v85
v_max_f32 v86, 0, v86
v_max_f32 v87, 0, v87
v_max_f32 v88, 0, v88
v_max_f32 v89, 0, v89
v_max_f32 v90, 0, v90
v_max_f32 v91, 0, v91
v_max_f32 v92, 0, v92
v_max_f32 v93, 0, v93
v_max_f32 v94, 0, v94
v_max_f32 v95, 0, v95
v_cvt_pk_bf16_f32 v96, v80, v84
v_cvt_pk_bf16_f32 v97, v88, v92
v_cvt_pk_bf16_f32 v98, v81, v85
v_cvt_pk_bf16_f32 v99, v89, v93
v_cvt_pk_bf16_f32 v100, v82, v86
v_cvt_pk_bf16_f32 v101, v90, v94
v_cvt_pk_bf16_f32 v102, v83, v87
v_cvt_pk_bf16_f32 v103, v91, v95
buffer_store_dwordx4 v[96:99], v1, s[8:11], s23 offen offset:0 sc1
buffer_store_dwordx4 v[100:103], v1, s[8:11], s23 offen offset:1024 sc1
s_add_u32 s23, s23, 180224
s_sub_u32 s28, s28, 1
s_cmp_lg_u32 s28, 0
s_cbranch_scc1 L_o_f1
L_o_ffn_done:
s_waitcnt vmcnt(0)
s_barrier
s_cmp_lg_u32 s18, 0
s_cbranch_scc1 L_o_w
v_mov_b32 v30, 1
v_mov_b32 v31, 8
s_mov_b64 exec, 1
global_atomic_add v31, v30, s[4:5] sc1
s_mov_b64 exec, -1
L_o_w:
s_and_b32 s24, s17, 15
s_lshr_b32 s25, s20, 4
s_lshl_b32 s29, s18, 20
s_lshl_b32 s24, s24, 6
s_add_u32 s29, s29, s24
v_lshlrev_b32 v5, 13, v2
v_lshl_add_u32 v5, v3, 2, v5
s_load_dwordx2 s[12:13], s[0:1], 40
s_mov_b32 s14, 4194304
s_mov_b32 s15, 0x00020000
s_waitcnt lgkmcnt(0)
s_add_u32 s46, s29, 0
buffer_load_dword v32, v5, s[12:15], s46 offen
buffer_load_dword v33, v5, s[12:15], s46 offen offset:1024
buffer_load_dword v34, v5, s[12:15], s46 offen offset:2048
buffer_load_dword v35, v5, s[12:15], s46 offen offset:3072
s_add_u32 s46, s29, 4096
buffer_load_dword v36, v5, s[12:15], s46 offen
buffer_load_dword v37, v5, s[12:15], s46 offen offset:1024
buffer_load_dword v38, v5, s[12:15], s46 offen offset:2048
buffer_load_dword v39, v5, s[12:15], s46 offen offset:3072
s_add_u32 s46, s29, 32768
buffer_load_dword v40, v5, s[12:15], s46 offen
buffer_load_dword v41, v5, s[12:15], s46 offen offset:1024
buffer_load_dword v42, v5, s[12:15], s46 offen offset:2048
buffer_load_dword v43, v5, s[12:15], s46 offen offset:3072
s_add_u32 s46, s29, 36864
buffer_load_dword v44, v5, s[12:15], s46 offen
buffer_load_dword v45, v5, s[12:15], s46 offen offset:1024
buffer_load_dword v46, v5, s[12:15], s46 offen offset:2048
buffer_load_dword v47, v5, s[12:15], s46 offen offset:3072
s_add_u32 s46, s29, 65536
buffer_load_dword v48, v5, s[12:15], s46 offen
buffer_load_dword v49, v5, s[12:15], s46 offen offset:1024
buffer_load_dword v50, v5, s[12:15], s46 offen offset:2048
buffer_load_dword v51, v5, s[12:15], s46 offen offset:3072
s_add_u32 s46, s29, 69632
buffer_load_dword v52, v5, s[12:15], s46 offen
buffer_load_dword v53, v5, s[12:15], s46 offen offset:1024
buffer_load_dword v54, v5, s[12:15], s46 offen offset:2048
buffer_load_dword v55, v5, s[12:15], s46 offen offset:3072
s_add_u32 s46, s29, 98304
buffer_load_dword v56, v5, s[12:15], s46 offen
buffer_load_dword v57, v5, s[12:15], s46 offen offset:1024
buffer_load_dword v58, v5, s[12:15], s46 offen offset:2048
buffer_load_dword v59, v5, s[12:15], s46 offen offset:3072
s_add_u32 s46, s29, 102400
buffer_load_dword v60, v5, s[12:15], s46 offen
buffer_load_dword v61, v5, s[12:15], s46 offen offset:1024
buffer_load_dword v62, v5, s[12:15], s46 offen offset:2048
buffer_load_dword v63, v5, s[12:15], s46 offen offset:3072
s_add_u32 s46, s29, 131072
buffer_load_dword v64, v5, s[12:15], s46 offen
buffer_load_dword v65, v5, s[12:15], s46 offen offset:1024
buffer_load_dword v66, v5, s[12:15], s46 offen offset:2048
buffer_load_dword v67, v5, s[12:15], s46 offen offset:3072
s_add_u32 s46, s29, 135168
buffer_load_dword v68, v5, s[12:15], s46 offen
buffer_load_dword v69, v5, s[12:15], s46 offen offset:1024
buffer_load_dword v70, v5, s[12:15], s46 offen offset:2048
buffer_load_dword v71, v5, s[12:15], s46 offen offset:3072
s_add_u32 s46, s29, 163840
buffer_load_dword v72, v5, s[12:15], s46 offen
buffer_load_dword v73, v5, s[12:15], s46 offen offset:1024
buffer_load_dword v74, v5, s[12:15], s46 offen offset:2048
buffer_load_dword v75, v5, s[12:15], s46 offen offset:3072
s_add_u32 s46, s29, 167936
buffer_load_dword v76, v5, s[12:15], s46 offen
buffer_load_dword v77, v5, s[12:15], s46 offen offset:1024
buffer_load_dword v78, v5, s[12:15], s46 offen offset:2048
buffer_load_dword v79, v5, s[12:15], s46 offen offset:3072
s_add_u32 s46, s29, 196608
buffer_load_dword v80, v5, s[12:15], s46 offen
buffer_load_dword v81, v5, s[12:15], s46 offen offset:1024
buffer_load_dword v82, v5, s[12:15], s46 offen offset:2048
buffer_load_dword v83, v5, s[12:15], s46 offen offset:3072
s_add_u32 s46, s29, 200704
buffer_load_dword v84, v5, s[12:15], s46 offen
buffer_load_dword v85, v5, s[12:15], s46 offen offset:1024
buffer_load_dword v86, v5, s[12:15], s46 offen offset:2048
buffer_load_dword v87, v5, s[12:15], s46 offen offset:3072
s_waitcnt vmcnt(48)
s_add_u32 s46, s29, 229376
buffer_load_dword v88, v5, s[12:15], s46 offen
buffer_load_dword v89, v5, s[12:15], s46 offen offset:1024
buffer_load_dword v90, v5, s[12:15], s46 offen offset:2048
buffer_load_dword v91, v5, s[12:15], s46 offen offset:3072
s_add_u32 s46, s29, 233472
buffer_load_dword v92, v5, s[12:15], s46 offen
buffer_load_dword v93, v5, s[12:15], s46 offen offset:1024
buffer_load_dword v94, v5, s[12:15], s46 offen offset:2048
buffer_load_dword v95, v5, s[12:15], s46 offen offset:3072
v_perm_b32 v16, v33, v32, s50
v_perm_b32 v17, v35, v34, s50
v_perm_b32 v18, v37, v36, s50
v_perm_b32 v19, v39, v38, s50
v_accvgpr_write_b32 a0, v16
v_accvgpr_write_b32 a1, v17
v_accvgpr_write_b32 a2, v18
v_accvgpr_write_b32 a3, v19
v_perm_b32 v20, v33, v32, s51
v_perm_b32 v21, v35, v34, s51
v_perm_b32 v22, v37, v36, s51
v_perm_b32 v23, v39, v38, s51
v_accvgpr_write_b32 a4, v20
v_accvgpr_write_b32 a5, v21
v_accvgpr_write_b32 a6, v22
v_accvgpr_write_b32 a7, v23
s_waitcnt vmcnt(48)
s_add_u32 s46, s29, 262144
buffer_load_dword v32, v5, s[12:15], s46 offen
buffer_load_dword v33, v5, s[12:15], s46 offen offset:1024
buffer_load_dword v34, v5, s[12:15], s46 offen offset:2048
buffer_load_dword v35, v5, s[12:15], s46 offen offset:3072
s_add_u32 s46, s29, 266240
buffer_load_dword v36, v5, s[12:15], s46 offen
buffer_load_dword v37, v5, s[12:15], s46 offen offset:1024
buffer_load_dword v38, v5, s[12:15], s46 offen offset:2048
buffer_load_dword v39, v5, s[12:15], s46 offen offset:3072
v_perm_b32 v16, v41, v40, s50
v_perm_b32 v17, v43, v42, s50
v_perm_b32 v18, v45, v44, s50
v_perm_b32 v19, v47, v46, s50
v_accvgpr_write_b32 a8, v16
v_accvgpr_write_b32 a9, v17
v_accvgpr_write_b32 a10, v18
v_accvgpr_write_b32 a11, v19
v_perm_b32 v20, v41, v40, s51
v_perm_b32 v21, v43, v42, s51
v_perm_b32 v22, v45, v44, s51
v_perm_b32 v23, v47, v46, s51
v_accvgpr_write_b32 a12, v20
v_accvgpr_write_b32 a13, v21
v_accvgpr_write_b32 a14, v22
v_accvgpr_write_b32 a15, v23
s_waitcnt vmcnt(48)
s_add_u32 s46, s29, 294912
buffer_load_dword v40, v5, s[12:15], s46 offen
buffer_load_dword v41, v5, s[12:15], s46 offen offset:1024
buffer_load_dword v42, v5, s[12:15], s46 offen offset:2048
buffer_load_dword v43, v5, s[12:15], s46 offen offset:3072
s_add_u32 s46, s29, 299008
buffer_load_dword v44, v5, s[12:15], s46 offen
buffer_load_dword v45, v5, s[12:15], s46 offen offset:1024
buffer_load_dword v46, v5, s[12:15], s46 offen offset:2048
buffer_load_dword v47, v5, s[12:15], s46 offen offset:3072
v_perm_b32 v16, v49, v48, s50
v_perm_b32 v17, v51, v50, s50
v_perm_b32 v18, v53, v52, s50
v_perm_b32 v19, v55, v54, s50
v_accvgpr_write_b32 a16, v16
v_accvgpr_write_b32 a17, v17
v_accvgpr_write_b32 a18, v18
v_accvgpr_write_b32 a19, v19
v_perm_b32 v20, v49, v48, s51
v_perm_b32 v21, v51, v50, s51
v_perm_b32 v22, v53, v52, s51
v_perm_b32 v23, v55, v54, s51
v_accvgpr_write_b32 a20, v20
v_accvgpr_write_b32 a21, v21
v_accvgpr_write_b32 a22, v22
v_accvgpr_write_b32 a23, v23
s_waitcnt vmcnt(48)
s_add_u32 s46, s29, 327680
buffer_load_dword v48, v5, s[12:15], s46 offen
buffer_load_dword v49, v5, s[12:15], s46 offen offset:1024
buffer_load_dword v50, v5, s[12:15], s46 offen offset:2048
buffer_load_dword v51, v5, s[12:15], s46 offen offset:3072
s_add_u32 s46, s29, 331776
buffer_load_dword v52, v5, s[12:15], s46 offen
buffer_load_dword v53, v5, s[12:15], s46 offen offset:1024
buffer_load_dword v54, v5, s[12:15], s46 offen offset:2048
buffer_load_dword v55, v5, s[12:15], s46 offen offset:3072
v_perm_b32 v16, v57, v56, s50
v_perm_b32 v17, v59, v58, s50
v_perm_b32 v18, v61, v60, s50
v_perm_b32 v19, v63, v62, s50
v_accvgpr_write_b32 a24, v16
v_accvgpr_write_b32 a25, v17
v_accvgpr_write_b32 a26, v18
v_accvgpr_write_b32 a27, v19
v_perm_b32 v20, v57, v56, s51
v_perm_b32 v21, v59, v58, s51
v_perm_b32 v22, v61, v60, s51
v_perm_b32 v23, v63, v62, s51
v_accvgpr_write_b32 a28, v20
v_accvgpr_write_b32 a29, v21
v_accvgpr_write_b32 a30, v22
v_accvgpr_write_b32 a31, v23
s_waitcnt vmcnt(48)
s_add_u32 s46, s29, 360448
buffer_load_dword v56, v5, s[12:15], s46 offen
buffer_load_dword v57, v5, s[12:15], s46 offen offset:1024
buffer_load_dword v58, v5, s[12:15], s46 offen offset:2048
buffer_load_dword v59, v5, s[12:15], s46 offen offset:3072
s_add_u32 s46, s29, 364544
buffer_load_dword v60, v5, s[12:15], s46 offen
buffer_load_dword v61, v5, s[12:15], s46 offen offset:1024
buffer_load_dword v62, v5, s[12:15], s46 offen offset:2048
buffer_load_dword v63, v5, s[12:15], s46 offen offset:3072
v_perm_b32 v16, v65, v64, s50
v_perm_b32 v17, v67, v66, s50
v_perm_b32 v18, v69, v68, s50
v_perm_b32 v19, v71, v70, s50
v_accvgpr_write_b32 a32, v16
v_accvgpr_write_b32 a33, v17
v_accvgpr_write_b32 a34, v18
v_accvgpr_write_b32 a35, v19
v_perm_b32 v20, v65, v64, s51
v_perm_b32 v21, v67, v66, s51
v_perm_b32 v22, v69, v68, s51
v_perm_b32 v23, v71, v70, s51
v_accvgpr_write_b32 a36, v20
v_accvgpr_write_b32 a37, v21
v_accvgpr_write_b32 a38, v22
v_accvgpr_write_b32 a39, v23
s_waitcnt vmcnt(48)
s_add_u32 s46, s29, 393216
buffer_load_dword v64, v5, s[12:15], s46 offen
buffer_load_dword v65, v5, s[12:15], s46 offen offset:1024
buffer_load_dword v66, v5, s[12:15], s46 offen offset:2048
buffer_load_dword v67, v5, s[12:15], s46 offen offset:3072
s_add_u32 s46, s29, 397312
buffer_load_dword v68, v5, s[12:15], s46 offen
buffer_load_dword v69, v5, s[12:15], s46 offen offset:1024
buffer_load_dword v70, v5, s[12:15], s46 offen offset:2048
buffer_load_dword v71, v5, s[12:15], s46 offen offset:3072
v_perm_b32 v16, v73, v72, s50
v_perm_b32 v17, v75, v74, s50
v_perm_b32 v18, v77, v76, s50
v_perm_b32 v19, v79, v78, s50
v_accvgpr_write_b32 a40, v16
v_accvgpr_write_b32 a41, v17
v_accvgpr_write_b32 a42, v18
v_accvgpr_write_b32 a43, v19
v_perm_b32 v20, v73, v72, s51
v_perm_b32 v21, v75, v74, s51
v_perm_b32 v22, v77, v76, s51
v_perm_b32 v23, v79, v78, s51
v_accvgpr_write_b32 a44, v20
v_accvgpr_write_b32 a45, v21
v_accvgpr_write_b32 a46, v22
v_accvgpr_write_b32 a47, v23
s_waitcnt vmcnt(48)
s_add_u32 s46, s29, 425984
buffer_load_dword v72, v5, s[12:15], s46 offen
buffer_load_dword v73, v5, s[12:15], s46 offen offset:1024
buffer_load_dword v74, v5, s[12:15], s46 offen offset:2048
buffer_load_dword v75, v5, s[12:15], s46 offen offset:3072
s_add_u32 s46, s29, 430080
buffer_load_dword v76, v5, s[12:15], s46 offen
buffer_load_dword v77, v5, s[12:15], s46 offen offset:1024
buffer_load_dword v78, v5, s[12:15], s46 offen offset:2048
buffer_load_dword v79, v5, s[12:15], s46 offen offset:3072
v_perm_b32 v16, v81, v80, s50
v_perm_b32 v17, v83, v82, s50
v_perm_b32 v18, v85, v84, s50
v_perm_b32 v19, v87, v86, s50
v_accvgpr_write_b32 a48, v16
v_accvgpr_write_b32 a49, v17
v_accvgpr_write_b32 a50, v18
v_accvgpr_write_b32 a51, v19
v_perm_b32 v20, v81, v80, s51
v_perm_b32 v21, v83, v82, s51
v_perm_b32 v22, v85, v84, s51
v_perm_b32 v23, v87, v86, s51
v_accvgpr_write_b32 a52, v20
v_accvgpr_write_b32 a53, v21
v_accvgpr_write_b32 a54, v22
v_accvgpr_write_b32 a55, v23
s_waitcnt vmcnt(48)
s_add_u32 s46, s29, 458752
buffer_load_dword v80, v5, s[12:15], s46 offen
buffer_load_dword v81, v5, s[12:15], s46 offen offset:1024
buffer_load_dword v82, v5, s[12:15], s46 offen offset:2048
buffer_load_dword v83, v5, s[12:15], s46 offen offset:3072
s_add_u32 s46, s29, 462848
buffer_load_dword v84, v5, s[12:15], s46 offen
buffer_load_dword v85, v5, s[12:15], s46 offen offset:1024
buffer_load_dword v86, v5, s[12:15], s46 offen offset:2048
buffer_load_dword v87, v5, s[12:15], s46 offen offset:3072
v_perm_b32 v16, v89, v88, s50
v_perm_b32 v17, v91, v90, s50
v_perm_b32 v18, v93, v92, s50
v_perm_b32 v19, v95, v94, s50
v_accvgpr_write_b32 a56, v16
v_accvgpr_write_b32 a57, v17
v_accvgpr_write_b32 a58, v18
v_accvgpr_write_b32 a59, v19
v_perm_b32 v20, v89, v88, s51
v_perm_b32 v21, v91, v90, s51
v_perm_b32 v22, v93, v92, s51
v_perm_b32 v23, v95, v94, s51
v_accvgpr_write_b32 a60, v20
v_accvgpr_write_b32 a61, v21
v_accvgpr_write_b32 a62, v22
v_accvgpr_write_b32 a63, v23
s_waitcnt vmcnt(48)
s_add_u32 s46, s29, 491520
buffer_load_dword v88, v5, s[12:15], s46 offen
buffer_load_dword v89, v5, s[12:15], s46 offen offset:1024
buffer_load_dword v90, v5, s[12:15], s46 offen offset:2048
buffer_load_dword v91, v5, s[12:15], s46 offen offset:3072
s_add_u32 s46, s29, 495616
buffer_load_dword v92, v5, s[12:15], s46 offen
buffer_load_dword v93, v5, s[12:15], s46 offen offset:1024
buffer_load_dword v94, v5, s[12:15], s46 offen offset:2048
buffer_load_dword v95, v5, s[12:15], s46 offen offset:3072
v_perm_b32 v16, v33, v32, s50
v_perm_b32 v17, v35, v34, s50
v_perm_b32 v18, v37, v36, s50
v_perm_b32 v19, v39, v38, s50
v_accvgpr_write_b32 a64, v16
v_accvgpr_write_b32 a65, v17
v_accvgpr_write_b32 a66, v18
v_accvgpr_write_b32 a67, v19
v_perm_b32 v20, v33, v32, s51
v_perm_b32 v21, v35, v34, s51
v_perm_b32 v22, v37, v36, s51
v_perm_b32 v23, v39, v38, s51
v_accvgpr_write_b32 a68, v20
v_accvgpr_write_b32 a69, v21
v_accvgpr_write_b32 a70, v22
v_accvgpr_write_b32 a71, v23
s_waitcnt vmcnt(48)
s_add_u32 s46, s29, 524288
buffer_load_dword v32, v5, s[12:15], s46 offen
buffer_load_dword v33, v5, s[12:15], s46 offen offset:1024
buffer_load_dword v34, v5, s[12:15], s46 offen offset:2048
buffer_load_dword v35, v5, s[12:15], s46 offen offset:3072
s_add_u32 s46, s29, 528384
buffer_load_dword v36, v5, s[12:15], s46 offen
buffer_load_dword v37, v5, s[12:15], s46 offen offset:1024
buffer_load_dword v38, v5, s[12:15], s46 offen offset:2048
buffer_load_dword v39, v5, s[12:15], s46 offen offset:3072
v_perm_b32 v16, v41, v40, s50
v_perm_b32 v17, v43, v42, s50
v_perm_b32 v18, v45, v44, s50
v_perm_b32 v19, v47, v46, s50
v_accvgpr_write_b32 a72, v16
v_accvgpr_write_b32 a73, v17
v_accvgpr_write_b32 a74, v18
v_accvgpr_write_b32 a75, v19
v_perm_b32 v20, v41, v40, s51
v_perm_b32 v21, v43, v42, s51
v_perm_b32 v22, v45, v44, s51
v_perm_b32 v23, v47, v46, s51
v_accvgpr_write_b32 a76, v20
v_accvgpr_write_b32 a77, v21
v_accvgpr_write_b32 a78, v22
v_accvgpr_write_b32 a79, v23
s_waitcnt vmcnt(48)
s_add_u32 s46, s29, 557056
buffer_load_dword v40, v5, s[12:15], s46 offen
buffer_load_dword v41, v5, s[12:15], s46 offen offset:1024
buffer_load_dword v42, v5, s[12:15], s46 offen offset:2048
buffer_load_dword v43, v5, s[12:15], s46 offen offset:3072
s_add_u32 s46, s29, 561152
buffer_load_dword v44, v5, s[12:15], s46 offen
buffer_load_dword v45, v5, s[12:15], s46 offen offset:1024
buffer_load_dword v46, v5, s[12:15], s46 offen offset:2048
buffer_load_dword v47, v5, s[12:15], s46 offen offset:3072
v_perm_b32 v16, v49, v48, s50
v_perm_b32 v17, v51, v50, s50
v_perm_b32 v18, v53, v52, s50
v_perm_b32 v19, v55, v54, s50
v_accvgpr_write_b32 a80, v16
v_accvgpr_write_b32 a81, v17
v_accvgpr_write_b32 a82, v18
v_accvgpr_write_b32 a83, v19
v_perm_b32 v20, v49, v48, s51
v_perm_b32 v21, v51, v50, s51
v_perm_b32 v22, v53, v52, s51
v_perm_b32 v23, v55, v54, s51
v_accvgpr_write_b32 a84, v20
v_accvgpr_write_b32 a85, v21
v_accvgpr_write_b32 a86, v22
v_accvgpr_write_b32 a87, v23
s_waitcnt vmcnt(48)
s_add_u32 s46, s29, 589824
buffer_load_dword v48, v5, s[12:15], s46 offen
buffer_load_dword v49, v5, s[12:15], s46 offen offset:1024
buffer_load_dword v50, v5, s[12:15], s46 offen offset:2048
buffer_load_dword v51, v5, s[12:15], s46 offen offset:3072
s_add_u32 s46, s29, 593920
buffer_load_dword v52, v5, s[12:15], s46 offen
buffer_load_dword v53, v5, s[12:15], s46 offen offset:1024
buffer_load_dword v54, v5, s[12:15], s46 offen offset:2048
buffer_load_dword v55, v5, s[12:15], s46 offen offset:3072
v_perm_b32 v16, v57, v56, s50
v_perm_b32 v17, v59, v58, s50
v_perm_b32 v18, v61, v60, s50
v_perm_b32 v19, v63, v62, s50
v_accvgpr_write_b32 a88, v16
v_accvgpr_write_b32 a89, v17
v_accvgpr_write_b32 a90, v18
v_accvgpr_write_b32 a91, v19
v_perm_b32 v20, v57, v56, s51
v_perm_b32 v21, v59, v58, s51
v_perm_b32 v22, v61, v60, s51
v_perm_b32 v23, v63, v62, s51
v_accvgpr_write_b32 a92, v20
v_accvgpr_write_b32 a93, v21
v_accvgpr_write_b32 a94, v22
v_accvgpr_write_b32 a95, v23
s_waitcnt vmcnt(48)
s_add_u32 s46, s29, 622592
buffer_load_dword v56, v5, s[12:15], s46 offen
buffer_load_dword v57, v5, s[12:15], s46 offen offset:1024
buffer_load_dword v58, v5, s[12:15], s46 offen offset:2048
buffer_load_dword v59, v5, s[12:15], s46 offen offset:3072
s_add_u32 s46, s29, 626688
buffer_load_dword v60, v5, s[12:15], s46 offen
buffer_load_dword v61, v5, s[12:15], s46 offen offset:1024
buffer_load_dword v62, v5, s[12:15], s46 offen offset:2048
buffer_load_dword v63, v5, s[12:15], s46 offen offset:3072
v_perm_b32 v16, v65, v64, s50
v_perm_b32 v17, v67, v66, s50
v_perm_b32 v18, v69, v68, s50
v_perm_b32 v19, v71, v70, s50
v_accvgpr_write_b32 a96, v16
v_accvgpr_write_b32 a97, v17
v_accvgpr_write_b32 a98, v18
v_accvgpr_write_b32 a99, v19
v_perm_b32 v20, v65, v64, s51
v_perm_b32 v21, v67, v66, s51
v_perm_b32 v22, v69, v68, s51
v_perm_b32 v23, v71, v70, s51
v_accvgpr_write_b32 a100, v20
v_accvgpr_write_b32 a101, v21
v_accvgpr_write_b32 a102, v22
v_accvgpr_write_b32 a103, v23
s_waitcnt vmcnt(48)
s_add_u32 s46, s29, 655360
buffer_load_dword v64, v5, s[12:15], s46 offen
buffer_load_dword v65, v5, s[12:15], s46 offen offset:1024
buffer_load_dword v66, v5, s[12:15], s46 offen offset:2048
buffer_load_dword v67, v5, s[12:15], s46 offen offset:3072
s_add_u32 s46, s29, 659456
buffer_load_dword v68, v5, s[12:15], s46 offen
buffer_load_dword v69, v5, s[12:15], s46 offen offset:1024
buffer_load_dword v70, v5, s[12:15], s46 offen offset:2048
buffer_load_dword v71, v5, s[12:15], s46 offen offset:3072
v_perm_b32 v16, v73, v72, s50
v_perm_b32 v17, v75, v74, s50
v_perm_b32 v18, v77, v76, s50
v_perm_b32 v19, v79, v78, s50
v_accvgpr_write_b32 a104, v16
v_accvgpr_write_b32 a105, v17
v_accvgpr_write_b32 a106, v18
v_accvgpr_write_b32 a107, v19
v_perm_b32 v20, v73, v72, s51
v_perm_b32 v21, v75, v74, s51
v_perm_b32 v22, v77, v76, s51
v_perm_b32 v23, v79, v78, s51
v_accvgpr_write_b32 a108, v20
v_accvgpr_write_b32 a109, v21
v_accvgpr_write_b32 a110, v22
v_accvgpr_write_b32 a111, v23
s_waitcnt vmcnt(48)
s_add_u32 s46, s29, 688128
buffer_load_dword v72, v5, s[12:15], s46 offen
buffer_load_dword v73, v5, s[12:15], s46 offen offset:1024
buffer_load_dword v74, v5, s[12:15], s46 offen offset:2048
buffer_load_dword v75, v5, s[12:15], s46 offen offset:3072
s_add_u32 s46, s29, 692224
buffer_load_dword v76, v5, s[12:15], s46 offen
buffer_load_dword v77, v5, s[12:15], s46 offen offset:1024
buffer_load_dword v78, v5, s[12:15], s46 offen offset:2048
buffer_load_dword v79, v5, s[12:15], s46 offen offset:3072
v_perm_b32 v16, v81, v80, s50
v_perm_b32 v17, v83, v82, s50
v_perm_b32 v18, v85, v84, s50
v_perm_b32 v19, v87, v86, s50
v_accvgpr_write_b32 a112, v16
v_accvgpr_write_b32 a113, v17
v_accvgpr_write_b32 a114, v18
v_accvgpr_write_b32 a115, v19
v_perm_b32 v20, v81, v80, s51
v_perm_b32 v21, v83, v82, s51
v_perm_b32 v22, v85, v84, s51
v_perm_b32 v23, v87, v86, s51
v_accvgpr_write_b32 a116, v20
v_accvgpr_write_b32 a117, v21
v_accvgpr_write_b32 a118, v22
v_accvgpr_write_b32 a119, v23
s_waitcnt vmcnt(48)
s_add_u32 s46, s29, 720896
buffer_load_dword v80, v5, s[12:15], s46 offen
buffer_load_dword v81, v5, s[12:15], s46 offen offset:1024
buffer_load_dword v82, v5, s[12:15], s46 offen offset:2048
buffer_load_dword v83, v5, s[12:15], s46 offen offset:3072
s_add_u32 s46, s29, 724992
buffer_load_dword v84, v5, s[12:15], s46 offen
buffer_load_dword v85, v5, s[12:15], s46 offen offset:1024
buffer_load_dword v86, v5, s[12:15], s46 offen offset:2048
buffer_load_dword v87, v5, s[12:15], s46 offen offset:3072
v_perm_b32 v16, v89, v88, s50
v_perm_b32 v17, v91, v90, s50
v_perm_b32 v18, v93, v92, s50
v_perm_b32 v19, v95, v94, s50
v_accvgpr_write_b32 a120, v16
v_accvgpr_write_b32 a121, v17
v_accvgpr_write_b32 a122, v18
v_accvgpr_write_b32 a123, v19
v_perm_b32 v20, v89, v88, s51
v_perm_b32 v21, v91, v90, s51
v_perm_b32 v22, v93, v92, s51
v_perm_b32 v23, v95, v94, s51
v_accvgpr_write_b32 a124, v20
v_accvgpr_write_b32 a125, v21
v_accvgpr_write_b32 a126, v22
v_accvgpr_write_b32 a127, v23
s_waitcnt vmcnt(48)
s_add_u32 s46, s29, 753664
buffer_load_dword v88, v5, s[12:15], s46 offen
buffer_load_dword v89, v5, s[12:15], s46 offen offset:1024
buffer_load_dword v90, v5, s[12:15], s46 offen offset:2048
buffer_load_dword v91, v5, s[12:15], s46 offen offset:3072
s_add_u32 s46, s29, 757760
buffer_load_dword v92, v5, s[12:15], s46 offen
buffer_load_dword v93, v5, s[12:15], s46 offen offset:1024
buffer_load_dword v94, v5, s[12:15], s46 offen offset:2048
buffer_load_dword v95, v5, s[12:15], s46 offen offset:3072
v_perm_b32 v16, v33, v32, s50
v_perm_b32 v17, v35, v34, s50
v_perm_b32 v18, v37, v36, s50
v_perm_b32 v19, v39, v38, s50
v_accvgpr_write_b32 a128, v16
v_accvgpr_write_b32 a129, v17
v_accvgpr_write_b32 a130, v18
v_accvgpr_write_b32 a131, v19
v_perm_b32 v20, v33, v32, s51
v_perm_b32 v21, v35, v34, s51
v_perm_b32 v22, v37, v36, s51
v_perm_b32 v23, v39, v38, s51
v_accvgpr_write_b32 a132, v20
v_accvgpr_write_b32 a133, v21
v_accvgpr_write_b32 a134, v22
v_accvgpr_write_b32 a135, v23
s_waitcnt vmcnt(48)
s_add_u32 s46, s29, 786432
buffer_load_dword v32, v5, s[12:15], s46 offen
buffer_load_dword v33, v5, s[12:15], s46 offen offset:1024
buffer_load_dword v34, v5, s[12:15], s46 offen offset:2048
buffer_load_dword v35, v5, s[12:15], s46 offen offset:3072
s_add_u32 s46, s29, 790528
buffer_load_dword v36, v5, s[12:15], s46 offen
buffer_load_dword v37, v5, s[12:15], s46 offen offset:1024
buffer_load_dword v38, v5, s[12:15], s46 offen offset:2048
buffer_load_dword v39, v5, s[12:15], s46 offen offset:3072
v_perm_b32 v16, v41, v40, s50
v_perm_b32 v17, v43, v42, s50
v_perm_b32 v18, v45, v44, s50
v_perm_b32 v19, v47, v46, s50
v_accvgpr_write_b32 a136, v16
v_accvgpr_write_b32 a137, v17
v_accvgpr_write_b32 a138, v18
v_accvgpr_write_b32 a139, v19
v_perm_b32 v20, v41, v40, s51
v_perm_b32 v21, v43, v42, s51
v_perm_b32 v22, v45, v44, s51
v_perm_b32 v23, v47, v46, s51
v_accvgpr_write_b32 a140, v20
v_accvgpr_write_b32 a141, v21
v_accvgpr_write_b32 a142, v22
v_accvgpr_write_b32 a143, v23
s_waitcnt vmcnt(48)
s_add_u32 s46, s29, 819200
buffer_load_dword v40, v5, s[12:15], s46 offen
buffer_load_dword v41, v5, s[12:15], s46 offen offset:1024
buffer_load_dword v42, v5, s[12:15], s46 offen offset:2048
buffer_load_dword v43, v5, s[12:15], s46 offen offset:3072
s_add_u32 s46, s29, 823296
buffer_load_dword v44, v5, s[12:15], s46 offen
buffer_load_dword v45, v5, s[12:15], s46 offen offset:1024
buffer_load_dword v46, v5, s[12:15], s46 offen offset:2048
buffer_load_dword v47, v5, s[12:15], s46 offen offset:3072
v_perm_b32 v16, v49, v48, s50
v_perm_b32 v17, v51, v50, s50
v_perm_b32 v18, v53, v52, s50
v_perm_b32 v19, v55, v54, s50
v_accvgpr_write_b32 a144, v16
v_accvgpr_write_b32 a145, v17
v_accvgpr_write_b32 a146, v18
v_accvgpr_write_b32 a147, v19
v_perm_b32 v20, v49, v48, s51
v_perm_b32 v21, v51, v50, s51
v_perm_b32 v22, v53, v52, s51
v_perm_b32 v23, v55, v54, s51
v_accvgpr_write_b32 a148, v20
v_accvgpr_write_b32 a149, v21
v_accvgpr_write_b32 a150, v22
v_accvgpr_write_b32 a151, v23
s_waitcnt vmcnt(48)
s_add_u32 s46, s29, 851968
buffer_load_dword v48, v5, s[12:15], s46 offen
buffer_load_dword v49, v5, s[12:15], s46 offen offset:1024
buffer_load_dword v50, v5, s[12:15], s46 offen offset:2048
buffer_load_dword v51, v5, s[12:15], s46 offen offset:3072
s_add_u32 s46, s29, 856064
buffer_load_dword v52, v5, s[12:15], s46 offen
buffer_load_dword v53, v5, s[12:15], s46 offen offset:1024
buffer_load_dword v54, v5, s[12:15], s46 offen offset:2048
buffer_load_dword v55, v5, s[12:15], s46 offen offset:3072
v_perm_b32 v16, v57, v56, s50
v_perm_b32 v17, v59, v58, s50
v_perm_b32 v18, v61, v60, s50
v_perm_b32 v19, v63, v62, s50
v_accvgpr_write_b32 a152, v16
v_accvgpr_write_b32 a153, v17
v_accvgpr_write_b32 a154, v18
v_accvgpr_write_b32 a155, v19
v_perm_b32 v20, v57, v56, s51
v_perm_b32 v21, v59, v58, s51
v_perm_b32 v22, v61, v60, s51
v_perm_b32 v23, v63, v62, s51
v_accvgpr_write_b32 a156, v20
v_accvgpr_write_b32 a157, v21
v_accvgpr_write_b32 a158, v22
v_accvgpr_write_b32 a159, v23
s_waitcnt vmcnt(48)
s_add_u32 s46, s29, 884736
buffer_load_dword v56, v5, s[12:15], s46 offen
buffer_load_dword v57, v5, s[12:15], s46 offen offset:1024
buffer_load_dword v58, v5, s[12:15], s46 offen offset:2048
buffer_load_dword v59, v5, s[12:15], s46 offen offset:3072
s_add_u32 s46, s29, 888832
buffer_load_dword v60, v5, s[12:15], s46 offen
buffer_load_dword v61, v5, s[12:15], s46 offen offset:1024
buffer_load_dword v62, v5, s[12:15], s46 offen offset:2048
buffer_load_dword v63, v5, s[12:15], s46 offen offset:3072
v_perm_b32 v16, v65, v64, s50
v_perm_b32 v17, v67, v66, s50
v_perm_b32 v18, v69, v68, s50
v_perm_b32 v19, v71, v70, s50
v_accvgpr_write_b32 a160, v16
v_accvgpr_write_b32 a161, v17
v_accvgpr_write_b32 a162, v18
v_accvgpr_write_b32 a163, v19
v_perm_b32 v20, v65, v64, s51
v_perm_b32 v21, v67, v66, s51
v_perm_b32 v22, v69, v68, s51
v_perm_b32 v23, v71, v70, s51
v_accvgpr_write_b32 a164, v20
v_accvgpr_write_b32 a165, v21
v_accvgpr_write_b32 a166, v22
v_accvgpr_write_b32 a167, v23
s_waitcnt vmcnt(48)
s_add_u32 s46, s29, 917504
buffer_load_dword v64, v5, s[12:15], s46 offen
buffer_load_dword v65, v5, s[12:15], s46 offen offset:1024
buffer_load_dword v66, v5, s[12:15], s46 offen offset:2048
buffer_load_dword v67, v5, s[12:15], s46 offen offset:3072
s_add_u32 s46, s29, 921600
buffer_load_dword v68, v5, s[12:15], s46 offen
buffer_load_dword v69, v5, s[12:15], s46 offen offset:1024
buffer_load_dword v70, v5, s[12:15], s46 offen offset:2048
buffer_load_dword v71, v5, s[12:15], s46 offen offset:3072
v_perm_b32 v16, v73, v72, s50
v_perm_b32 v17, v75, v74, s50
v_perm_b32 v18, v77, v76, s50
v_perm_b32 v19, v79, v78, s50
v_accvgpr_write_b32 a168, v16
v_accvgpr_write_b32 a169, v17
v_accvgpr_write_b32 a170, v18
v_accvgpr_write_b32 a171, v19
v_perm_b32 v20, v73, v72, s51
v_perm_b32 v21, v75, v74, s51
v_perm_b32 v22, v77, v76, s51
v_perm_b32 v23, v79, v78, s51
v_accvgpr_write_b32 a172, v20
v_accvgpr_write_b32 a173, v21
v_accvgpr_write_b32 a174, v22
v_accvgpr_write_b32 a175, v23
s_waitcnt vmcnt(48)
s_add_u32 s46, s29, 950272
buffer_load_dword v72, v5, s[12:15], s46 offen
buffer_load_dword v73, v5, s[12:15], s46 offen offset:1024
buffer_load_dword v74, v5, s[12:15], s46 offen offset:2048
buffer_load_dword v75, v5, s[12:15], s46 offen offset:3072
s_add_u32 s46, s29, 954368
buffer_load_dword v76, v5, s[12:15], s46 offen
buffer_load_dword v77, v5, s[12:15], s46 offen offset:1024
buffer_load_dword v78, v5, s[12:15], s46 offen offset:2048
buffer_load_dword v79, v5, s[12:15], s46 offen offset:3072
v_perm_b32 v16, v81, v80, s50
v_perm_b32 v17, v83, v82, s50
v_perm_b32 v18, v85, v84, s50
v_perm_b32 v19, v87, v86, s50
v_accvgpr_write_b32 a176, v16
v_accvgpr_write_b32 a177, v17
v_accvgpr_write_b32 a178, v18
v_accvgpr_write_b32 a179, v19
v_perm_b32 v20, v81, v80, s51
v_perm_b32 v21, v83, v82, s51
v_perm_b32 v22, v85, v84, s51
v_perm_b32 v23, v87, v86, s51
v_accvgpr_write_b32 a180, v20
v_accvgpr_write_b32 a181, v21
v_accvgpr_write_b32 a182, v22
v_accvgpr_write_b32 a183, v23
s_waitcnt vmcnt(48)
s_add_u32 s46, s29, 983040
buffer_load_dword v80, v5, s[12:15], s46 offen
buffer_load_dword v81, v5, s[12:15], s46 offen offset:1024
buffer_load_dword v82, v5, s[12:15], s46 offen offset:2048
buffer_load_dword v83, v5, s[12:15], s46 offen offset:3072
s_add_u32 s46, s29, 987136
buffer_load_dword v84, v5, s[12:15], s46 offen
buffer_load_dword v85, v5, s[12:15], s46 offen offset:1024
buffer_load_dword v86, v5, s[12:15], s46 offen offset:2048
buffer_load_dword v87, v5, s[12:15], s46 offen offset:3072
v_perm_b32 v16, v89, v88, s50
v_perm_b32 v17, v91, v90, s50
v_perm_b32 v18, v93, v92, s50
v_perm_b32 v19, v95, v94, s50
v_accvgpr_write_b32 a184, v16
v_accvgpr_write_b32 a185, v17
v_accvgpr_write_b32 a186, v18
v_accvgpr_write_b32 a187, v19
v_perm_b32 v20, v89, v88, s51
v_perm_b32 v21, v91, v90, s51
v_perm_b32 v22, v93, v92, s51
v_perm_b32 v23, v95, v94, s51
v_accvgpr_write_b32 a188, v20
v_accvgpr_write_b32 a189, v21
v_accvgpr_write_b32 a190, v22
v_accvgpr_write_b32 a191, v23
s_waitcnt vmcnt(48)
s_add_u32 s46, s29, 1015808
buffer_load_dword v88, v5, s[12:15], s46 offen
buffer_load_dword v89, v5, s[12:15], s46 offen offset:1024
buffer_load_dword v90, v5, s[12:15], s46 offen offset:2048
buffer_load_dword v91, v5, s[12:15], s46 offen offset:3072
s_add_u32 s46, s29, 1019904
buffer_load_dword v92, v5, s[12:15], s46 offen
buffer_load_dword v93, v5, s[12:15], s46 offen offset:1024
buffer_load_dword v94, v5, s[12:15], s46 offen offset:2048
buffer_load_dword v95, v5, s[12:15], s46 offen offset:3072
v_perm_b32 v16, v33, v32, s50
v_perm_b32 v17, v35, v34, s50
v_perm_b32 v18, v37, v36, s50
v_perm_b32 v19, v39, v38, s50
v_accvgpr_write_b32 a192, v16
v_accvgpr_write_b32 a193, v17
v_accvgpr_write_b32 a194, v18
v_accvgpr_write_b32 a195, v19
v_perm_b32 v20, v33, v32, s51
v_perm_b32 v21, v35, v34, s51
v_perm_b32 v22, v37, v36, s51
v_perm_b32 v23, v39, v38, s51
v_accvgpr_write_b32 a196, v20
v_accvgpr_write_b32 a197, v21
v_accvgpr_write_b32 a198, v22
v_accvgpr_write_b32 a199, v23
s_waitcnt vmcnt(48)
v_perm_b32 v16, v41, v40, s50
v_perm_b32 v17, v43, v42, s50
v_perm_b32 v18, v45, v44, s50
v_perm_b32 v19, v47, v46, s50
v_accvgpr_write_b32 a200, v16
v_accvgpr_write_b32 a201, v17
v_accvgpr_write_b32 a202, v18
v_accvgpr_write_b32 a203, v19
v_perm_b32 v20, v41, v40, s51
v_perm_b32 v21, v43, v42, s51
v_perm_b32 v22, v45, v44, s51
v_perm_b32 v23, v47, v46, s51
v_accvgpr_write_b32 a204, v20
v_accvgpr_write_b32 a205, v21
v_accvgpr_write_b32 a206, v22
v_accvgpr_write_b32 a207, v23
s_waitcnt vmcnt(40)
v_perm_b32 v16, v49, v48, s50
v_perm_b32 v17, v51, v50, s50
v_perm_b32 v18, v53, v52, s50
v_perm_b32 v19, v55, v54, s50
v_accvgpr_write_b32 a208, v16
v_accvgpr_write_b32 a209, v17
v_accvgpr_write_b32 a210, v18
v_accvgpr_write_b32 a211, v19
v_perm_b32 v20, v49, v48, s51
v_perm_b32 v21, v51, v50, s51
v_perm_b32 v22, v53, v52, s51
v_perm_b32 v23, v55, v54, s51
v_accvgpr_write_b32 a212, v20
v_accvgpr_write_b32 a213, v21
v_accvgpr_write_b32 a214, v22
v_accvgpr_write_b32 a215, v23
s_waitcnt vmcnt(32)
v_perm_b32 v16, v57, v56, s50
v_perm_b32 v17, v59, v58, s50
v_perm_b32 v18, v61, v60, s50
v_perm_b32 v19, v63, v62, s50
v_accvgpr_write_b32 a216, v16
v_accvgpr_write_b32 a217, v17
v_accvgpr_write_b32 a218, v18
v_accvgpr_write_b32 a219, v19
v_perm_b32 v20, v57, v56, s51
v_perm_b32 v21, v59, v58, s51
v_perm_b32 v22, v61, v60, s51
v_perm_b32 v23, v63, v62, s51
v_accvgpr_write_b32 a220, v20
v_accvgpr_write_b32 a221, v21
v_accvgpr_write_b32 a222, v22
v_accvgpr_write_b32 a223, v23
s_waitcnt vmcnt(24)
v_perm_b32 v16, v65, v64, s50
v_perm_b32 v17, v67, v66, s50
v_perm_b32 v18, v69, v68, s50
v_perm_b32 v19, v71, v70, s50
v_accvgpr_write_b32 a224, v16
v_accvgpr_write_b32 a225, v17
v_accvgpr_write_b32 a226, v18
v_accvgpr_write_b32 a227, v19
v_perm_b32 v20, v65, v64, s51
v_perm_b32 v21, v67, v66, s51
v_perm_b32 v22, v69, v68, s51
v_perm_b32 v23, v71, v70, s51
v_accvgpr_write_b32 a228, v20
v_accvgpr_write_b32 a229, v21
v_accvgpr_write_b32 a230, v22
v_accvgpr_write_b32 a231, v23
s_waitcnt vmcnt(16)
v_perm_b32 v16, v73, v72, s50
v_perm_b32 v17, v75, v74, s50
v_perm_b32 v18, v77, v76, s50
v_perm_b32 v19, v79, v78, s50
v_accvgpr_write_b32 a232, v16
v_accvgpr_write_b32 a233, v17
v_accvgpr_write_b32 a234, v18
v_accvgpr_write_b32 a235, v19
v_perm_b32 v20, v73, v72, s51
v_perm_b32 v21, v75, v74, s51
v_perm_b32 v22, v77, v76, s51
v_perm_b32 v23, v79, v78, s51
v_accvgpr_write_b32 a236, v20
v_accvgpr_write_b32 a237, v21
v_accvgpr_write_b32 a238, v22
v_accvgpr_write_b32 a239, v23
s_waitcnt vmcnt(8)
v_perm_b32 v16, v81, v80, s50
v_perm_b32 v17, v83, v82, s50
v_perm_b32 v18, v85, v84, s50
v_perm_b32 v19, v87, v86, s50
v_accvgpr_write_b32 a240, v16
v_accvgpr_write_b32 a241, v17
v_accvgpr_write_b32 a242, v18
v_accvgpr_write_b32 a243, v19
v_perm_b32 v20, v81, v80, s51
v_perm_b32 v21, v83, v82, s51
v_perm_b32 v22, v85, v84, s51
v_perm_b32 v23, v87, v86, s51
v_accvgpr_write_b32 a244, v20
v_accvgpr_write_b32 a245, v21
v_accvgpr_write_b32 a246, v22
v_accvgpr_write_b32 a247, v23
s_waitcnt vmcnt(0)
v_perm_b32 v16, v89, v88, s50
v_perm_b32 v17, v91, v90, s50
v_perm_b32 v18, v93, v92, s50
v_perm_b32 v19, v95, v94, s50
v_accvgpr_write_b32 a248, v16
v_accvgpr_write_b32 a249, v17
v_accvgpr_write_b32 a250, v18
v_accvgpr_write_b32 a251, v19
v_perm_b32 v20, v89, v88, s51
v_perm_b32 v21, v91, v90, s51
v_perm_b32 v22, v93, v92, s51
v_perm_b32 v23, v95, v94, s51
v_accvgpr_write_b32 a252, v20
v_accvgpr_write_b32 a253, v21
v_accvgpr_write_b32 a254, v22
v_accvgpr_write_b32 a255, v23
v_lshlrev_b32 v5, 14, v2
v_lshl_add_u32 v5, v3, 2, v5
s_load_dwordx2 s[12:13], s[0:1], 72
s_mov_b32 s14, 1409024
s_mov_b32 s15, 0x00020000
s_waitcnt lgkmcnt(0)
s_mul_i32 s47, s18, 11
s_add_u32 s47, s47, 0
s_and_b32 s48, s47, 1
s_lshl_b32 s47, s47, 15
s_mul_i32 s48, s48, 24576
s_sub_u32 s47, s47, s48
s_add_u32 s29, s47, s24
s_add_u32 s46, s29, 0
buffer_load_dword v32, v5, s[12:15], s46 offen
buffer_load_dword v33, v5, s[12:15], s46 offen offset:1024
buffer_load_dword v34, v5, s[12:15], s46 offen offset:2048
buffer_load_dword v35, v5, s[12:15], s46 offen offset:3072
s_add_u32 s46, s29, 4096
buffer_load_dword v36, v5, s[12:15], s46 offen
buffer_load_dword v37, v5, s[12:15], s46 offen offset:1024
buffer_load_dword v38, v5, s[12:15], s46 offen offset:2048
buffer_load_dword v39, v5, s[12:15], s46 offen offset:3072
s_mul_i32 s47, s18, 11
s_add_u32 s47, s47, 1
s_and_b32 s48, s47, 1
s_lshl_b32 s47, s47, 15
s_mul_i32 s48, s48, 24576
s_sub_u32 s47, s47, s48
s_add_u32 s29, s47, s24
s_add_u32 s46, s29, 0
buffer_load_dword v40, v5, s[12:15], s46 offen
buffer_load_dword v41, v5, s[12:15], s46 offen offset:1024
buffer_load_dword v42, v5, s[12:15], s46 offen offset:2048
buffer_load_dword v43, v5, s[12:15], s46 offen offset:3072
s_add_u32 s46, s29, 4096
buffer_load_dword v44, v5, s[12:15], s46 offen
buffer_load_dword v45, v5, s[12:15], s46 offen offset:1024
buffer_load_dword v46, v5, s[12:15], s46 offen offset:2048
buffer_load_dword v47, v5, s[12:15], s46 offen offset:3072
s_mul_i32 s47, s18, 11
s_add_u32 s47, s47, 2
s_and_b32 s48, s47, 1
s_lshl_b32 s47, s47, 15
s_mul_i32 s48, s48, 24576
s_sub_u32 s47, s47, s48
s_add_u32 s29, s47, s24
s_add_u32 s46, s29, 0
buffer_load_dword v48, v5, s[12:15], s46 offen
buffer_load_dword v49, v5, s[12:15], s46 offen offset:1024
buffer_load_dword v50, v5, s[12:15], s46 offen offset:2048
buffer_load_dword v51, v5, s[12:15], s46 offen offset:3072
s_add_u32 s46, s29, 4096
buffer_load_dword v52, v5, s[12:15], s46 offen
buffer_load_dword v53, v5, s[12:15], s46 offen offset:1024
buffer_load_dword v54, v5, s[12:15], s46 offen offset:2048
buffer_load_dword v55, v5, s[12:15], s46 offen offset:3072
s_mul_i32 s47, s18, 11
s_add_u32 s47, s47, 3
s_and_b32 s48, s47, 1
s_lshl_b32 s47, s47, 15
s_mul_i32 s48, s48, 24576
s_sub_u32 s47, s47, s48
s_add_u32 s29, s47, s24
s_add_u32 s46, s29, 0
buffer_load_dword v56, v5, s[12:15], s46 offen
buffer_load_dword v57, v5, s[12:15], s46 offen offset:1024
buffer_load_dword v58, v5, s[12:15], s46 offen offset:2048
buffer_load_dword v59, v5, s[12:15], s46 offen offset:3072
s_add_u32 s46, s29, 4096
buffer_load_dword v60, v5, s[12:15], s46 offen
buffer_load_dword v61, v5, s[12:15], s46 offen offset:1024
buffer_load_dword v62, v5, s[12:15], s46 offen offset:2048
buffer_load_dword v63, v5, s[12:15], s46 offen offset:3072
s_mul_i32 s47, s18, 11
s_add_u32 s47, s47, 4
s_and_b32 s48, s47, 1
s_lshl_b32 s47, s47, 15
s_mul_i32 s48, s48, 24576
s_sub_u32 s47, s47, s48
s_add_u32 s29, s47, s24
s_add_u32 s46, s29, 0
buffer_load_dword v64, v5, s[12:15], s46 offen
buffer_load_dword v65, v5, s[12:15], s46 offen offset:1024
buffer_load_dword v66, v5, s[12:15], s46 offen offset:2048
buffer_load_dword v67, v5, s[12:15], s46 offen offset:3072
s_add_u32 s46, s29, 4096
buffer_load_dword v68, v5, s[12:15], s46 offen
buffer_load_dword v69, v5, s[12:15], s46 offen offset:1024
buffer_load_dword v70, v5, s[12:15], s46 offen offset:2048
buffer_load_dword v71, v5, s[12:15], s46 offen offset:3072
s_mul_i32 s47, s18, 11
s_add_u32 s47, s47, 5
s_and_b32 s48, s47, 1
s_lshl_b32 s47, s47, 15
s_mul_i32 s48, s48, 24576
s_sub_u32 s47, s47, s48
s_add_u32 s29, s47, s24
s_add_u32 s46, s29, 0
buffer_load_dword v72, v5, s[12:15], s46 offen
buffer_load_dword v73, v5, s[12:15], s46 offen offset:1024
buffer_load_dword v74, v5, s[12:15], s46 offen offset:2048
buffer_load_dword v75, v5, s[12:15], s46 offen offset:3072
s_add_u32 s46, s29, 4096
buffer_load_dword v76, v5, s[12:15], s46 offen
buffer_load_dword v77, v5, s[12:15], s46 offen offset:1024
buffer_load_dword v78, v5, s[12:15], s46 offen offset:2048
buffer_load_dword v79, v5, s[12:15], s46 offen offset:3072
s_mul_i32 s47, s18, 11
s_add_u32 s47, s47, 6
s_and_b32 s48, s47, 1
s_lshl_b32 s47, s47, 15
s_mul_i32 s48, s48, 24576
s_sub_u32 s47, s47, s48
s_add_u32 s29, s47, s24
s_add_u32 s46, s29, 0
buffer_load_dword v80, v5, s[12:15], s46 offen
buffer_load_dword v81, v5, s[12:15], s46 offen offset:1024
buffer_load_dword v82, v5, s[12:15], s46 offen offset:2048
buffer_load_dword v83, v5, s[12:15], s46 offen offset:3072
s_add_u32 s46, s29, 4096
buffer_load_dword v84, v5, s[12:15], s46 offen
buffer_load_dword v85, v5, s[12:15], s46 offen offset:1024
buffer_load_dword v86, v5, s[12:15], s46 offen offset:2048
buffer_load_dword v87, v5, s[12:15], s46 offen offset:3072
s_waitcnt vmcnt(48)
s_mul_i32 s47, s18, 11
s_add_u32 s47, s47, 7
s_and_b32 s48, s47, 1
s_lshl_b32 s47, s47, 15
s_mul_i32 s48, s48, 24576
s_sub_u32 s47, s47, s48
s_add_u32 s29, s47, s24
s_add_u32 s46, s29, 0
buffer_load_dword v88, v5, s[12:15], s46 offen
buffer_load_dword v89, v5, s[12:15], s46 offen offset:1024
buffer_load_dword v90, v5, s[12:15], s46 offen offset:2048
buffer_load_dword v91, v5, s[12:15], s46 offen offset:3072
s_add_u32 s46, s29, 4096
buffer_load_dword v92, v5, s[12:15], s46 offen
buffer_load_dword v93, v5, s[12:15], s46 offen offset:1024
buffer_load_dword v94, v5, s[12:15], s46 offen offset:2048
buffer_load_dword v95, v5, s[12:15], s46 offen offset:3072
v_perm_b32 v168, v33, v32, s50
v_perm_b32 v169, v35, v34, s50
v_perm_b32 v170, v37, v36, s50
v_perm_b32 v171, v39, v38, s50
v_perm_b32 v172, v33, v32, s51
v_perm_b32 v173, v35, v34, s51
v_perm_b32 v174, v37, v36, s51
v_perm_b32 v175, v39, v38, s51
s_waitcnt vmcnt(48)
s_mul_i32 s47, s18, 11
s_add_u32 s47, s47, 8
s_and_b32 s48, s47, 1
s_lshl_b32 s47, s47, 15
s_mul_i32 s48, s48, 24576
s_sub_u32 s47, s47, s48
s_add_u32 s29, s47, s24
s_add_u32 s46, s29, 0
buffer_load_dword v32, v5, s[12:15], s46 offen
buffer_load_dword v33, v5, s[12:15], s46 offen offset:1024
buffer_load_dword v34, v5, s[12:15], s46 offen offset:2048
buffer_load_dword v35, v5, s[12:15], s46 offen offset:3072
s_add_u32 s46, s29, 4096
buffer_load_dword v36, v5, s[12:15], s46 offen
buffer_load_dword v37, v5, s[12:15], s46 offen offset:1024
buffer_load_dword v38, v5, s[12:15], s46 offen offset:2048
buffer_load_dword v39, v5, s[12:15], s46 offen offset:3072
v_perm_b32 v176, v41, v40, s50
v_perm_b32 v177, v43, v42, s50
v_perm_b32 v178, v45, v44, s50
v_perm_b32 v179, v47, v46, s50
v_perm_b32 v180, v41, v40, s51
v_perm_b32 v181, v43, v42, s51
v_perm_b32 v182, v45, v44, s51
v_perm_b32 v183, v47, v46, s51
s_waitcnt vmcnt(48)
s_mul_i32 s47, s18, 11
s_add_u32 s47, s47, 9
s_and_b32 s48, s47, 1
s_lshl_b32 s47, s47, 15
s_mul_i32 s48, s48, 24576
s_sub_u32 s47, s47, s48
s_add_u32 s29, s47, s24
s_add_u32 s46, s29, 0
buffer_load_dword v40, v5, s[12:15], s46 offen
buffer_load_dword v41, v5, s[12:15], s46 offen offset:1024
buffer_load_dword v42, v5, s[12:15], s46 offen offset:2048
buffer_load_dword v43, v5, s[12:15], s46 offen offset:3072
s_add_u32 s46, s29, 4096
buffer_load_dword v44, v5, s[12:15], s46 offen
buffer_load_dword v45, v5, s[12:15], s46 offen offset:1024
buffer_load_dword v46, v5, s[12:15], s46 offen offset:2048
buffer_load_dword v47, v5, s[12:15], s46 offen offset:3072
v_perm_b32 v184, v49, v48, s50
v_perm_b32 v185, v51, v50, s50
v_perm_b32 v186, v53, v52, s50
v_perm_b32 v187, v55, v54, s50
v_perm_b32 v188, v49, v48, s51
v_perm_b32 v189, v51, v50, s51
v_perm_b32 v190, v53, v52, s51
v_perm_b32 v191, v55, v54, s51
s_waitcnt vmcnt(48)
s_mul_i32 s47, s18, 11
s_add_u32 s47, s47, 10
s_and_b32 s48, s47, 1
s_lshl_b32 s47, s47, 15
s_mul_i32 s48, s48, 24576
s_sub_u32 s47, s47, s48
s_add_u32 s29, s47, s24
s_add_u32 s46, s29, 0
buffer_load_dword v48, v5, s[12:15], s46 offen
buffer_load_dword v49, v5, s[12:15], s46 offen offset:1024
buffer_load_dword v50, v5, s[12:15], s46 offen offset:2048
buffer_load_dword v51, v5, s[12:15], s46 offen offset:3072
s_add_u32 s46, s29, 4096
buffer_load_dword v52, v5, s[12:15], s46 offen
buffer_load_dword v53, v5, s[12:15], s46 offen offset:1024
buffer_load_dword v54, v5, s[12:15], s46 offen offset:2048
buffer_load_dword v55, v5, s[12:15], s46 offen offset:3072
v_perm_b32 v192, v57, v56, s50
v_perm_b32 v193, v59, v58, s50
v_perm_b32 v194, v61, v60, s50
v_perm_b32 v195, v63, v62, s50
v_perm_b32 v196, v57, v56, s51
v_perm_b32 v197, v59, v58, s51
v_perm_b32 v198, v61, v60, s51
v_perm_b32 v199, v63, v62, s51
s_waitcnt vmcnt(48)
v_perm_b32 v200, v65, v64, s50
v_perm_b32 v201, v67, v66, s50
v_perm_b32 v202, v69, v68, s50
v_perm_b32 v203, v71, v70, s50
v_perm_b32 v204, v65, v64, s51
v_perm_b32 v205, v67, v66, s51
v_perm_b32 v206, v69, v68, s51
v_perm_b32 v207, v71, v70, s51
s_waitcnt vmcnt(40)
v_perm_b32 v208, v73, v72, s50
v_perm_b32 v209, v75, v74, s50
v_perm_b32 v210, v77, v76, s50
v_perm_b32 v211, v79, v78, s50
v_perm_b32 v212, v73, v72, s51
v_perm_b32 v213, v75, v74, s51
v_perm_b32 v214, v77, v76, s51
v_perm_b32 v215, v79, v78, s51
s_waitcnt vmcnt(32)
v_perm_b32 v216, v81, v80, s50
v_perm_b32 v217, v83, v82, s50
v_perm_b32 v218, v85, v84, s50
v_perm_b32 v219, v87, v86, s50
v_perm_b32 v220, v81, v80, s51
v_perm_b32 v221, v83, v82, s51
v_perm_b32 v222, v85, v84, s51
v_perm_b32 v223, v87, v86, s51
s_waitcnt vmcnt(24)
v_perm_b32 v224, v89, v88, s50
v_perm_b32 v225, v91, v90, s50
v_perm_b32 v226, v93, v92, s50
v_perm_b32 v227, v95, v94, s50
v_perm_b32 v228, v89, v88, s51
v_perm_b32 v229, v91, v90, s51
v_perm_b32 v230, v93, v92, s51
v_perm_b32 v231, v95, v94, s51
s_waitcnt vmcnt(16)
v_perm_b32 v232, v33, v32, s50
v_perm_b32 v233, v35, v34, s50
v_perm_b32 v234, v37, v36, s50
v_perm_b32 v235, v39, v38, s50
v_perm_b32 v236, v33, v32, s51
v_perm_b32 v237, v35, v34, s51
v_perm_b32 v238, v37, v36, s51
v_perm_b32 v239, v39, v38, s51
s_waitcnt vmcnt(8)
v_perm_b32 v240, v41, v40, s50
v_perm_b32 v241, v43, v42, s50
v_perm_b32 v242, v45, v44, s50
v_perm_b32 v243, v47, v46, s50
v_perm_b32 v244, v41, v40, s51
v_perm_b32 v245, v43, v42, s51
v_perm_b32 v246, v45, v44, s51
v_perm_b32 v247, v47, v46, s51
s_waitcnt vmcnt(0)
v_perm_b32 v248, v49, v48, s50
v_perm_b32 v249, v51, v50, s50
v_perm_b32 v250, v53, v52, s50
v_perm_b32 v251, v55, v54, s50
v_perm_b32 v252, v49, v48, s51
v_perm_b32 v253, v51, v50, s51
v_perm_b32 v254, v53, v52, s51
v_perm_b32 v255, v55, v54, s51
s_lshl_b32 s46, s18, 12
v_add_u32 v7, s46, v1
v_mov_b32 v8, v1
v_lshlrev_b32 v9, 2, v3
s_mul_i32 s23, s25, 180224
s_add_u32 s23, s23, 100663296
s_lshl_b32 s26, s25, 8
s_lshl_b32 s46, s18, 6
s_add_u32 s26, s26, s46
s_add_u32 s26, s26, 98304
s_cmp_lg_u32 s18, 0
s_cbranch_scc1 L_o_ch_ok
v_mov_b32 v166, 4
L_o_ch:
global_load_dwordx2 v[164:165], v166, s[4:5] sc1
s_waitcnt vmcnt(0)
v_cmp_gt_u32 vcc, 144, v164
s_cbranch_vccnz L_o_ch_re
v_cmp_gt_u32 vcc, 96, v165
s_cbranch_vccnz L_o_ch_re
L_o_ch_ok:
s_barrier
L_o_u:
s_lshr_b32 s27, s25, 1
s_lshl_b32 s27, s27, 15
s_and_b32 s46, s25, 1
s_lshl_b32 s46, s46, 12
s_add_u32 s27, s27, s46
s_add_u32 s27, s27, s24
s_mul_i32 s46, s18, 11264
s_add_u32 s46, s46, s23
s_add_u32 s46, s46, 131072
buffer_load_dwordx4 v[32:35], v1, s[8:11], s46 offen offset:0
buffer_load_dwordx4 v[36:39], v1, s[8:11], s46 offen offset:1024
buffer_load_dwordx4 v[40:43], v1, s[8:11], s46 offen offset:2048
buffer_load_dwordx4 v[44:47], v1, s[8:11], s46 offen offset:3072
s_add_u32 s46, s46, 4096
buffer_load_dwordx4 v[48:51], v1, s[8:11], s46 offen offset:0
buffer_load_dwordx4 v[52:55], v1, s[8:11], s46 offen offset:1024
buffer_load_dwordx4 v[56:59], v1, s[8:11], s46 offen offset:2048
buffer_load_dwordx4 v[60:63], v1, s[8:11], s46 offen offset:3072
s_add_u32 s46, s46, 4096
buffer_load_dwordx4 v[64:67], v1, s[8:11], s46 offen offset:0
buffer_load_dwordx4 v[68:71], v1, s[8:11], s46 offen offset:1024
buffer_load_dwordx4 v[72:75], v1, s[8:11], s46 offen offset:2048
buffer_load_dwordx4 v[160:163], v6, s[84:87], s27 offen
s_waitcnt vmcnt(11)
v_mfma_f32_16x16x32_bf16 v[24:27], v[168:171], v[32:35], 0
v_mfma_f32_16x16x32_bf16 v[28:31], v[172:175], v[32:35], 0
s_waitcnt vmcnt(10)
v_mfma_f32_16x16x32_bf16 v[24:27], v[176:179], v[36:39], v[24:27]
v_mfma_f32_16x16x32_bf16 v[28:31], v[180:183], v[36:39], v[28:31]
s_waitcnt vmcnt(9)
v_mfma_f32_16x16x32_bf16 v[24:27], v[184:187], v[40:43], v[24:27]
v_mfma_f32_16x16x32_bf16 v[28:31], v[188:191], v[40:43], v[28:31]
s_waitcnt vmcnt(8)
v_mfma_f32_16x16x32_bf16 v[24:27], v[192:195], v[44:47], v[24:27]
v_mfma_f32_16x16x32_bf16 v[28:31], v[196:199], v[44:47], v[28:31]
s_waitcnt vmcnt(7)
v_mfma_f32_16x16x32_bf16 v[24:27], v[200:203], v[48:51], v[24:27]
v_mfma_f32_16x16x32_bf16 v[28:31], v[204:207], v[48:51], v[28:31]
s_waitcnt vmcnt(6)
v_mfma_f32_16x16x32_bf16 v[24:27], v[208:211], v[52:55], v[24:27]
v_mfma_f32_16x16x32_bf16 v[28:31], v[212:215], v[52:55], v[28:31]
s_waitcnt vmcnt(5)
v_mfma_f32_16x16x32_bf16 v[24:27], v[216:219], v[56:59], v[24:27]
v_mfma_f32_16x16x32_bf16 v[28:31], v[220:223], v[56:59], v[28:31]
s_waitcnt vmcnt(4)
v_mfma_f32_16x16x32_bf16 v[24:27], v[224:227], v[60:63], v[24:27]
v_mfma_f32_16x16x32_bf16 v[28:31], v[228:231], v[60:63], v[28:31]
s_waitcnt vmcnt(3)
v_mfma_f32_16x16x32_bf16 v[24:27], v[232:235], v[64:67], v[24:27]
v_mfma_f32_16x16x32_bf16 v[28:31], v[236:239], v[64:67], v[28:31]
s_waitcnt vmcnt(2)
v_mfma_f32_16x16x32_bf16 v[24:27], v[240:243], v[68:71], v[24:27]
v_mfma_f32_16x16x32_bf16 v[28:31], v[244:247], v[68:71], v[28:31]
s_waitcnt vmcnt(1)
v_mfma_f32_16x16x32_bf16 v[24:27], v[248:251], v[72:75], v[24:27]
v_mfma_f32_16x16x32_bf16 v[28:31], v[252:255], v[72:75], v[28:31]
s_lshl_b32 s46, s18, 15
s_add_u32 s46, s46, s23
s_nop 4
ds_write_b128 v7, v[24:27] offset:2048
ds_write_b128 v7, v[28:31] offset:3072
L_o_fo:
buffer_load_dword v164, v9, s[8:11], s26 offen sc1
s_waitcnt vmcnt(0)
v_cmp_eq_u32 vcc, 0, v164
s_cbranch_vccnz L_o_fo_re
L_o_fo_ok:
buffer_load_dwordx4 v[32:35], v1, s[8:11], s46 offen offset:0
buffer_load_dwordx4 v[36:39], v1, s[8:11], s46 offen offset:1024
buffer_load_dwordx4 v[40:43], v1, s[8:11], s46 offen offset:2048
buffer_load_dwordx4 v[44:47], v1, s[8:11], s46 offen offset:3072
s_add_u32 s46, s46, 4096
buffer_load_dwordx4 v[48:51], v1, s[8:11], s46 offen offset:0
buffer_load_dwordx4 v[52:55], v1, s[8:11], s46 offen offset:1024
buffer_load_dwordx4 v[56:59], v1, s[8:11], s46 offen offset:2048
buffer_load_dwordx4 v[60:63], v1, s[8:11], s46 offen offset:3072
s_add_u32 s46, s46, 4096
buffer_load_dwordx4 v[64:67], v1, s[8:11], s46 offen offset:0
buffer_load_dwordx4 v[68:71], v1, s[8:11], s46 offen offset:1024
buffer_load_dwordx4 v[72:75], v1, s[8:11], s46 offen offset:2048
buffer_load_dwordx4 v[76:79], v1, s[8:11], s46 offen offset:3072
s_add_u32 s46, s46, 4096
buffer_load_dwordx4 v[80:83], v1, s[8:11], s46 offen offset:0
buffer_load_dwordx4 v[84:87], v1, s[8:11], s46 offen offset:1024
buffer_load_dwordx4 v[88:91], v1, s[8:11], s46 offen offset:2048
buffer_load_dwordx4 v[92:95], v1, s[8:11], s46 offen offset:3072
s_add_u32 s46, s46, 4096
buffer_load_dwordx4 v[96:99], v1, s[8:11], s46 offen offset:0
buffer_load_dwordx4 v[100:103], v1, s[8:11], s46 offen offset:1024
buffer_load_dwordx4 v[104:107], v1, s[8:11], s46 offen offset:2048
buffer_load_dwordx4 v[108:111], v1, s[8:11], s46 offen offset:3072
s_add_u32 s46, s46, 4096
buffer_load_dwordx4 v[112:115], v1, s[8:11], s46 offen offset:0
buffer_load_dwordx4 v[116:119], v1, s[8:11], s46 offen offset:1024
buffer_load_dwordx4 v[120:123], v1, s[8:11], s46 offen offset:2048
buffer_load_dwordx4 v[124:127], v1, s[8:11], s46 offen offset:3072
s_add_u32 s46, s46, 4096
buffer_load_dwordx4 v[128:131], v1, s[8:11], s46 offen offset:0
buffer_load_dwordx4 v[132:135], v1, s[8:11], s46 offen offset:1024
buffer_load_dwordx4 v[136:139], v1, s[8:11], s46 offen offset:2048
buffer_load_dwordx4 v[140:143], v1, s[8:11], s46 offen offset:3072
s_add_u32 s46, s46, 4096
buffer_load_dwordx4 v[144:147], v1, s[8:11], s46 offen offset:0
buffer_load_dwordx4 v[148:151], v1, s[8:11], s46 offen offset:1024
buffer_load_dwordx4 v[152:155], v1, s[8:11], s46 offen offset:2048
buffer_load_dwordx4 v[156:159], v1, s[8:11], s46 offen offset:3072
s_add_u32 s46, s46, 4096
s_waitcnt vmcnt(31)
v_mfma_f32_16x16x32_bf16 v[16:19], a[0:3], v[32:35], 0
v_mfma_f32_16x16x32_bf16 v[20:23], a[4:7], v[32:35], 0
s_waitcnt vmcnt(30)
v_mfma_f32_16x16x32_bf16 v[16:19], a[8:11], v[36:39], v[16:19]
v_mfma_f32_16x16x32_bf16 v[20:23], a[12:15], v[36:39], v[20:23]
s_waitcnt vmcnt(29)
v_mfma_f32_16x16x32_bf16 v[16:19], a[16:19], v[40:43], v[16:19]
v_mfma_f32_16x16x32_bf16 v[20:23], a[20:23], v[40:43], v[20:23]
s_waitcnt vmcnt(28)
v_mfma_f32_16x16x32_bf16 v[16:19], a[24:27], v[44:47], v[16:19]
v_mfma_f32_16x16x32_bf16 v[20:23], a[28:31], v[44:47], v[20:23]
s_waitcnt vmcnt(27)
v_mfma_f32_16x16x32_bf16 v[16:19], a[32:35], v[48:51], v[16:19]
v_mfma_f32_16x16x32_bf16 v[20:23], a[36:39], v[48:51], v[20:23]
s_waitcnt vmcnt(26)
v_mfma_f32_16x16x32_bf16 v[16:19], a[40:43], v[52:55], v[16:19]
v_mfma_f32_16x16x32_bf16 v[20:23], a[44:47], v[52:55], v[20:23]
s_waitcnt vmcnt(25)
v_mfma_f32_16x16x32_bf16 v[16:19], a[48:51], v[56:59], v[16:19]
v_mfma_f32_16x16x32_bf16 v[20:23], a[52:55], v[56:59], v[20:23]
s_waitcnt vmcnt(24)
v_mfma_f32_16x16x32_bf16 v[16:19], a[56:59], v[60:63], v[16:19]
v_mfma_f32_16x16x32_bf16 v[20:23], a[60:63], v[60:63], v[20:23]
s_waitcnt vmcnt(23)
v_mfma_f32_16x16x32_bf16 v[16:19], a[64:67], v[64:67], v[16:19]
v_mfma_f32_16x16x32_bf16 v[20:23], a[68:71], v[64:67], v[20:23]
s_waitcnt vmcnt(22)
v_mfma_f32_16x16x32_bf16 v[16:19], a[72:75], v[68:71], v[16:19]
v_mfma_f32_16x16x32_bf16 v[20:23], a[76:79], v[68:71], v[20:23]
s_waitcnt vmcnt(21)
v_mfma_f32_16x16x32_bf16 v[16:19], a[80:83], v[72:75], v[16:19]
v_mfma_f32_16x16x32_bf16 v[20:23], a[84:87], v[72:75], v[20:23]
s_waitcnt vmcnt(20)
v_mfma_f32_16x16x32_bf16 v[16:19], a[88:91], v[76:79], v[16:19]
v_mfma_f32_16x16x32_bf16 v[20:23], a[92:95], v[76:79], v[20:23]
s_waitcnt vmcnt(19)
v_mfma_f32_16x16x32_bf16 v[16:19], a[96:99], v[80:83], v[16:19]
v_mfma_f32_16x16x32_bf16 v[20:23], a[100:103], v[80:83], v[20:23]
s_waitcnt vmcnt(18)
v_mfma_f32_16x16x32_bf16 v[16:19], a[104:107], v[84:87], v[16:19]
v_mfma_f32_16x16x32_bf16 v[20:23], a[108:111], v[84:87], v[20:23]
s_waitcnt vmcnt(17)
v_mfma_f32_16x16x32_bf16 v[16:19], a[112:115], v[88:91], v[16:19]
v_mfma_f32_16x16x32_bf16 v[20:23], a[116:119], v[88:91], v[20:23]
s_waitcnt vmcnt(16)
v_mfma_f32_16x16x32_bf16 v[16:19], a[120:123], v[92:95], v[16:19]
v_mfma_f32_16x16x32_bf16 v[20:23], a[124:127], v[92:95], v[20:23]
s_waitcnt vmcnt(15)
v_mfma_f32_16x16x32_bf16 v[16:19], a[128:131], v[96:99], v[16:19]
v_mfma_f32_16x16x32_bf16 v[20:23], a[132:135], v[96:99], v[20:23]
s_waitcnt vmcnt(14)
v_mfma_f32_16x16x32_bf16 v[16:19], a[136:139], v[100:103], v[16:19]
v_mfma_f32_16x16x32_bf16 v[20:23], a[140:143], v[100:103], v[20:23]
s_waitcnt vmcnt(13)
v_mfma_f32_16x16x32_bf16 v[16:19], a[144:147], v[104:107], v[16:19]
v_mfma_f32_16x16x32_bf16 v[20:23], a[148:151], v[104:107], v[20:23]
s_waitcnt vmcnt(12)
v_mfma_f32_16x16x32_bf16 v[16:19], a[152:155], v[108:111], v[16:19]
v_mfma_f32_16x16x32_bf16 v[20:23], a[156:159], v[108:111], v[20:23]
s_waitcnt vmcnt(11)
v_mfma_f32_16x16x32_bf16 v[16:19], a[160:163], v[112:115], v[16:19]
v_mfma_f32_16x16x32_bf16 v[20:23], a[164:167], v[112:115], v[20:23]
s_waitcnt vmcnt(10)
v_mfma_f32_16x16x32_bf16 v[16:19], a[168:171], v[116:119], v[16:19]
v_mfma_f32_16x16x32_bf16 v[20:23], a[172:175], v[116:119], v[20:23]
s_waitcnt vmcnt(9)
v_mfma_f32_16x16x32_bf16 v[16:19], a[176:179], v[120:123], v[16:19]
v_mfma_f32_16x16x32_bf16 v[20:23], a[180:183], v[120:123], v[20:23]
s_waitcnt vmcnt(8)
v_mfma_f32_16x16x32_bf16 v[16:19], a[184:187], v[124:127], v[16:19]
v_mfma_f32_16x16x32_bf16 v[20:23], a[188:191], v[124:127], v[20:23]
s_waitcnt vmcnt(7)
v_mfma_f32_16x16x32_bf16 v[16:19], a[192:195], v[128:131], v[16:19]
v_mfma_f32_16x16x32_bf16 v[20:23], a[196:199], v[128:131], v[20:23]
s_waitcnt vmcnt(6)
v_mfma_f32_16x16x32_bf16 v[16:19], a[200:203], v[132:135], v[16:19]
v_mfma_f32_16x16x32_bf16 v[20:23], a[204:207], v[132:135], v[20:23]
s_waitcnt vmcnt(5)
v_mfma_f32_16x16x32_bf16 v[16:19], a[208:211], v[136:139], v[16:19]
v_mfma_f32_16x16x32_bf16 v[20:23], a[212:215], v[136:139], v[20:23]
s_waitcnt vmcnt(4)
v_mfma_f32_16x16x32_bf16 v[16:19], a[216:219], v[140:143], v[16:19]
v_mfma_f32_16x16x32_bf16 v[20:23], a[220:223], v[140:143], v[20:23]
s_waitcnt vmcnt(3)
v_mfma_f32_16x16x32_bf16 v[16:19], a[224:227], v[144:147], v[16:19]
v_mfma_f32_16x16x32_bf16 v[20:23], a[228:231], v[144:147], v[20:23]
s_waitcnt vmcnt(2)
v_mfma_f32_16x16x32_bf16 v[16:19], a[232:235], v[148:151], v[16:19]
v_mfma_f32_16x16x32_bf16 v[20:23], a[236:239], v[148:151], v[20:23]
s_waitcnt vmcnt(1)
v_mfma_f32_16x16x32_bf16 v[16:19], a[240:243], v[152:155], v[16:19]
v_mfma_f32_16x16x32_bf16 v[20:23], a[244:247], v[152:155], v[20:23]
s_waitcnt vmcnt(0)
v_mfma_f32_16x16x32_bf16 v[16:19], a[248:251], v[156:159], v[16:19]
v_mfma_f32_16x16x32_bf16 v[20:23], a[252:255], v[156:159], v[20:23]
s_nop 6
ds_write_b128 v7, v[16:19] offset:0
ds_write_b128 v7, v[20:23] offset:1024
s_waitcnt lgkmcnt(0)
s_barrier
s_cmp_lg_u32 s18, 3
s_cbranch_scc1 L_o_nx
ds_read_b128 v[32:35], v8 offset:0
ds_read_b128 v[36:39], v8 offset:1024
ds_read_b128 v[40:43], v8 offset:2048
ds_read_b128 v[44:47], v8 offset:3072
ds_read_b128 v[48:51], v8 offset:4096
ds_read_b128 v[52:55], v8 offset:5120
ds_read_b128 v[56:59], v8 offset:6144
ds_read_b128 v[60:63], v8 offset:7168
ds_read_b128 v[64:67], v8 offset:8192
ds_read_b128 v[68:71], v8 offset:9216
ds_read_b128 v[72:75], v8 offset:10240
ds_read_b128 v[76:79], v8 offset:11264
s_mov_b32 s48, 0xffff0000
v_lshlrev_b32 v80, 16, v160
v_and_b32 v84, s48, v160
v_lshlrev_b32 v81, 16, v161
v_and_b32 v85, s48, v161
v_lshlrev_b32 v82, 16, v162
v_and_b32 v86, s48, v162
v_lshlrev_b32 v83, 16, v163
v_and_b32 v87, s48, v163
s_waitcnt lgkmcnt(8)
v_add_f32 v16, v16, v32
v_add_f32 v17, v17, v33
v_add_f32 v18, v18, v34
v_add_f32 v19, v19, v35
v_add_f32 v20, v20, v36
v_add_f32 v21, v21, v37
v_add_f32 v22, v22, v38
v_add_f32 v23, v23, v39
v_add_f32 v24, v24, v40
v_add_f32 v25, v25, v41
v_add_f32 v26, v26, v42
v_add_f32 v27, v27, v43
v_add_f32 v28, v28, v44
v_add_f32 v29, v29, v45
v_add_f32 v30, v30, v46
v_add_f32 v31, v31, v47
s_waitcnt lgkmcnt(4)
v_add_f32 v16, v16, v48
v_add_f32 v17, v17, v49
v_add_f32 v18, v18, v50
v_add_f32 v19, v19, v51
v_add_f32 v20, v20, v52
v_add_f32 v21, v21, v53
v_add_f32 v22, v22, v54
v_add_f32 v23, v23, v55
v_add_f32 v24, v24, v56
v_add_f32 v25, v25, v57
v_add_f32 v26, v26, v58
v_add_f32 v27, v27, v59
v_add_f32 v28, v28, v60
v_add_f32 v29, v29, v61
v_add_f32 v30, v30, v62
v_add_f32 v31, v31, v63
s_waitcnt lgkmcnt(0)
v_add_f32 v16, v16, v64
v_add_f32 v17, v17, v65
v_add_f32 v18, v18, v66
v_add_f32 v19, v19, v67
v_add_f32 v20, v20, v68
v_add_f32 v21, v21, v69
v_add_f32 v22, v22, v70
v_add_f32 v23, v23, v71
v_add_f32 v24, v24, v72
v_add_f32 v25, v25, v73
v_add_f32 v26, v26, v74
v_add_f32 v27, v27, v75
v_add_f32 v28, v28, v76
v_add_f32 v29, v29, v77
v_add_f32 v30, v30, v78
v_add_f32 v31, v31, v79
v_cvt_pk_bf16_f32 v16, 0, v16
v_cvt_pk_bf16_f32 v17, 0, v17
v_cvt_pk_bf16_f32 v18, 0, v18
v_cvt_pk_bf16_f32 v19, 0, v19
v_cvt_pk_bf16_f32 v20, 0, v20
v_cvt_pk_bf16_f32 v21, 0, v21
v_cvt_pk_bf16_f32 v22, 0, v22
v_cvt_pk_bf16_f32 v23, 0, v23
v_cvt_pk_bf16_f32 v24, 0, v24
v_cvt_pk_bf16_f32 v25, 0, v25
v_cvt_pk_bf16_f32 v26, 0, v26
v_cvt_pk_bf16_f32 v27, 0, v27
v_cvt_pk_bf16_f32 v28, 0, v28
v_cvt_pk_bf16_f32 v29, 0, v29
v_cvt_pk_bf16_f32 v30, 0, v30
v_cvt_pk_bf16_f32 v31, 0, v31
v_add_f32 v16, v16, v80
v_add_f32 v17, v17, v81
v_add_f32 v18, v18, v82
v_add_f32 v19, v19, v83
v_add_f32 v20, v20, v84
v_add_f32 v21, v21, v85
v_add_f32 v22, v22, v86
v_add_f32 v23, v23, v87
v_cvt_pk_bf16_f32 v16, 0, v16
v_cvt_pk_bf16_f32 v17, 0, v17
v_cvt_pk_bf16_f32 v18, 0, v18
v_cvt_pk_bf16_f32 v19, 0, v19
v_cvt_pk_bf16_f32 v20, 0, v20
v_cvt_pk_bf16_f32 v21, 0, v21
v_cvt_pk_bf16_f32 v22, 0, v22
v_cvt_pk_bf16_f32 v23, 0, v23
v_add_f32 v16, v16, v24
v_add_f32 v17, v17, v25
v_add_f32 v18, v18, v26
v_add_f32 v19, v19, v27
v_add_f32 v20, v20, v28
v_add_f32 v21, v21, v29
v_add_f32 v22, v22, v30
v_add_f32 v23, v23, v31
v_cvt_pk_bf16_f32 v164, v16, v20
v_cvt_pk_bf16_f32 v165, v17, v21
v_cvt_pk_bf16_f32 v166, v18, v22
v_cvt_pk_bf16_f32 v167, v19, v23
buffer_store_dwordx4 v[164:167], v6, s[88:91], s27 offen
s_nop 1
L_o_nx:
v_xor_b32 v7, 0x4000, v7
v_xor_b32 v8, 0x4000, v8
s_add_u32 s23, s23, 1081344
s_add_u32 s26, s26, 1536
s_add_u32 s25, s25, 6
s_cmp_lt_u32 s25, 128
s_cbranch_scc1 L_o_u
s_endpgm
L_o_cx_re:
s_nop 15
s_nop 15
s_nop 15
s_nop 15
s_nop 15
s_nop 15
s_nop 15
s_nop 15
s_nop 15
s_nop 15
s_nop 15
s_nop 15
s_nop 15
s_nop 15
s_nop 15
s_nop 15
s_nop 15
s_nop 15
s_nop 15
s_nop 15
s_nop 15
s_nop 15
s_nop 15
s_nop 15
s_nop 15
s_nop 15
s_nop 15
s_nop 15
s_nop 15
s_nop 15
s_nop 15
s_nop 15
s_nop 15
s_nop 15
s_nop 15
s_nop 15
s_nop 15
s_nop 15
s_nop 15
s_nop 15
s_nop 15
s_nop 15
s_nop 15
s_nop 15
s_nop 15
s_nop 15
s_nop 15
s_nop 15
s_nop 15
s_nop 15
s_nop 15
s_nop 15
s_nop 15
s_nop 15
s_nop 15
s_nop 15
s_nop 15
s_nop 15
s_nop 15
s_nop 15
s_nop 15
s_nop 15
s_nop 15
s_nop 15
s_sub_u32 s36, s36, 1
s_cbranch_scc0 L_o_cx
s_mov_b32 s36, 0
s_branch L_o_cx_ok
L_o_ch_re:
s_nop 15
s_nop 15
s_nop 15
s_nop 15
s_nop 15
s_nop 15
s_nop 15
s_nop 15
s_nop 15
s_nop 15
s_nop 15
s_nop 15
s_nop 15
s_nop 15
s_nop 15
s_nop 15
s_nop 15
s_nop 15
s_nop 15
s_nop 15
s_nop 15
s_nop 15
s_nop 15
s_nop 15
s_nop 15
s_nop 15
s_nop 15
s_nop 15
s_nop 15
s_nop 15
s_nop 15
s_nop 15
s_nop 15
s_nop 15
s_nop 15
s_nop 15
s_nop 15
s_nop 15
s_nop 15
s_nop 15
s_nop 15
s_nop 15
s_nop 15
s_nop 15
s_nop 15
s_nop 15
s_nop 15
s_nop 15
s_nop 15
s_nop 15
s_nop 15
s_nop 15
s_nop 15
s_nop 15
s_nop 15
s_nop 15
s_nop 15
s_nop 15
s_nop 15
s_nop 15
s_nop 15
s_nop 15
s_nop 15
s_nop 15
s_sub_u32 s36, s36, 1
s_cbranch_scc0 L_o_ch
s_mov_b32 s36, 0
s_branch L_o_ch_ok
L_o_fo_re:
s_sub_u32 s36, s36, 1
s_cbranch_scc0 L_o_fo
s_mov_b32 s36, 0
s_branch L_o_fo_ok
.section .rodata,"a"
.p2align 6
.amdhsa_kernel parallel_sum__memory_aug_recurrent_mem_tr__dense_activation_relu__prompt_kernel
.amdhsa_next_free_vgpr 512
.amdhsa_next_free_sgpr 102
.amdhsa_accum_offset 256
.amdhsa_group_segment_fixed_size 0
.amdhsa_kernarg_size 104
.amdhsa_user_sgpr_count 2
.amdhsa_user_sgpr_kernarg_segment_ptr 1
.amdhsa_system_sgpr_workgroup_id_x 1
.end_amdhsa_kernel
```
